```python
import torch

def _softmax(x, axis=-1):
    return torch.softmax(x, dim=axis)
def _gelu(x):
    return torch.nn.functional.gelu(x, approximate="tanh")
def _silu(x):
    return torch.nn.functional.silu(x)
def _sigmoid(x):
    return torch.sigmoid(x)
def _layernorm(x, axis=-1, eps=1e-5):
    m = x.mean(dim=axis, keepdim=True)
    v = x.var(dim=axis, keepdim=True, unbiased=False)
    return (x - m) / torch.sqrt(v + eps)
def _scatter_add(tgt, idx, src, axis=0):
    return tgt.clone().index_add_(axis, idx, src)
def _segment_sum(src, seg, n):
    out = torch.zeros((n,) + src.shape[1:], dtype=src.dtype)
    return out.index_add_(0, seg, src)
def _pad(x, pw):
    flat = tuple(v for pair in reversed(pw) for v in pair)
    return torch.nn.functional.pad(x, flat)

kernel_name = 'recurrent_scan__sliding_local_dilated__glu_gated_reglu__prompt'

def setup_inputs():

    _w = (lambda a: (lambda t: t.to(torch.bfloat16) if t.is_floating_point() else t)(torch.as_tensor(a)))
    def _A_setup():
        B, S, D = 1, 2048, 640
        return {
            "x": _w((lambda *s: torch.randn(*s, dtype=torch.bfloat16) * 0.05)(B, S, D)),
            "wqkv": _w((lambda *s: torch.randn(*s, dtype=torch.bfloat16) * 0.2)(D, 3 * D)),
            "wo": _w((lambda *s: torch.randn(*s, dtype=torch.bfloat16) * 0.2)(D, D)),
        }
    _A_in = _A_setup()

    def _B_setup():
        B, S, D, F = 1, 2048, 640, 1536
        return {
            "x": _w((lambda *s: torch.randn(*s, dtype=torch.bfloat16) * 0.05)(B, S, D)),
            "W_gate": _w((lambda *s: torch.randn(*s, dtype=torch.bfloat16) * 0.1)(D, F) * (2.0 / D) ** 0.5),
            "W_up": _w((lambda *s: torch.randn(*s, dtype=torch.bfloat16) * 0.1)(D, F) * (2.0 / D) ** 0.5),
            "W_down": _w((lambda *s: torch.randn(*s, dtype=torch.bfloat16) * 0.1)(F, D) * (1.0 / F) ** 0.5),
        }
    _B_in = _B_setup()

    return {
        "A_x": _A_in["x"],
        "A_wqkv": _A_in["wqkv"],
        "A_wo": _A_in["wo"],
        "B_x": _B_in["x"],
        "B_W_gate": _B_in["W_gate"],
        "B_W_up": _B_in["W_up"],
        "B_W_down": _B_in["W_down"],
    }

def reference(A_x, A_wqkv, A_wo, B_x, B_W_gate, B_W_up, B_W_down):
    def _A_ref(x, wqkv, wo):
        B, S, D = x.shape
        H = 32; Dh = D // H
        W, dil = 8, 2
        qkv = (lambda x, *d: x.permute(*d))((x @ wqkv).reshape(B, S, 3, H, Dh), 2, 0, 3, 1, 4)
        q, k, v = qkv[0], qkv[1], qkv[2]
        scale = Dh ** -0.5
        pos = torch.arange(S)
        off = torch.arange(W) * dil
        idx = pos[:, None] - off[None, :]
        mask = idx >= 0
        idx_c = torch.where(mask, idx, 0).reshape(-1)
        kg = k[:, :, idx_c, :].reshape(B, H, S, W, Dh)
        vg = v[:, :, idx_c, :].reshape(B, H, S, W, Dh)
        logits = torch.einsum("bhsd,bhswd->bhsw", q, kg) * scale
        logits = torch.where(mask[None, None, :, :], logits, -1e9)
        attn = _softmax(logits, axis=-1)
        o = torch.einsum("bhsw,bhswd->bhsd", attn, vg)
        return (lambda x, *d: x.permute(*d))(o, 0, 2, 1, 3).reshape(B, S, D) @ wo

    def _B_ref(x, W_gate, W_up, W_down):
        gate = torch.einsum("bsd,df->bsf", x, W_gate)
        up = torch.einsum("bsd,df->bsf", x, W_up)
        gate = gate * (lambda x, dt: x.to(dt))(gate > 0, gate.dtype)
        h = gate * up
        return torch.einsum("bsf,fd->bsd", h, W_down)

    x = A_x
    xn = _layernorm(x, axis=-1)
    s = _A_ref(xn, A_wqkv, A_wo)
    g = _silu(_B_ref(xn, B_W_gate, B_W_up, B_W_down))
    return x + s * g
```

```asm
; @launch grid=(256,1,1) block=(256,1,1) lds=163840
.amdgcn_target "amdgcn-amd-amdhsa--gfx950"
.text
.globl recurrent_scan__sliding_local_dilated__glu_gated_reglu__prompt_kernel
.p2align 8
.type recurrent_scan__sliding_local_dilated__glu_gated_reglu__prompt_kernel,@function
recurrent_scan__sliding_local_dilated__glu_gated_reglu__prompt_kernel:
L_start:
    s_load_dwordx16 s[64:79], s[0:1], 0
    s_load_dwordx4 s[80:83], s[0:1], 64
    s_cmp_lt_u32 s2, 128
    s_cbranch_scc1 L_A

L_F:
    s_cmp_ge_u32 s2, 256
    s_cbranch_scc1 L_done
    s_getpc_b64 s[4:5]
L_pcF:
    s_sub_u32 s4, s4, (L_pcF-L_start)
    s_subb_u32 s5, s5, 0
    s_lshr_b32 s29, s2, 3
    s_and_b32 s28, s29, 3
    s_lshl_b32 s28, s28, 14
    v_lshlrev_b32 v2, 6, v0
    v_add_u32 v2, s28, v2
    v_min_u32 v2, (L_end-L_start-4), v2

    global_load_dword v61, v2, s[4:5]
    v_lshrrev_b32 v2, 6, v0
    v_and_b32 v1, 63, v0
    s_and_b32 s28, s2, 7
    v_readfirstlane_b32 s24, v2
    s_and_b32 s31, s28, 1
    s_lshl_b32 s25, s31, 3
    s_and_b32 s30, s29, 7
    s_add_u32 s25, s25, s30
    s_bfe_u32 s27, s2, 0x10006
    s_and_b32 s26, s28, 6
    s_add_u32 s26, s26, s27
    s_mul_i32 s27, s31, 5
    s_add_u32 s27, s27, s30
    s_cmp_lt_u32 s30, 5
    s_cselect_b32 s27, s27, 0

    v_lshrrev_b32 v28, 3, v1
    s_lshl_b32 s28, s24, 5
    v_add_u32 v29, s28, v28
    v_mul_u32_u24 v29, 1280, v29
    v_lshrrev_b32 v30, 4, v1
    v_and_b32 v31, 7, v1
    v_xor_b32 v31, v31, v30
    v_lshl_add_u32 v12, v31, 4, v29
    v_xor_b32 v32, 4, v31
    v_lshl_add_u32 v13, v32, 4, v29
    v_add_u32 v13, 9216, v13
    v_add_u32 v14, 18432, v12
    v_add_u32 v15, 18432, v13
    s_mul_i32 s32, s25, 163840
    s_lshl_b32 s36, s24, 12
    s_lshl_b32 s28, s24, 3

    v_add_u32 v28, 0, v1
    v_mul_u32_u24 v29, 2731, v28
    v_lshrrev_b32 v29, 16, v29
    v_mul_u32_u24 v30, 24, v29
    v_sub_u32 v30, v28, v30
    v_and_b32 v31, 2, v29
    v_xor_b32 v30, v30, v31
    v_add_u32 v29, s28, v29
    v_mul_u32_u24 v29, 3072, v29
    v_subrev_u32 v29, 0, v29
    v_lshl_add_u32 v17, v30, 4, v29
    v_xor_b32 v30, 4, v30
    v_lshl_add_u32 v20, v30, 4, v29

    v_add_u32 v28, 64, v1
    v_mul_u32_u24 v29, 2731, v28
    v_lshrrev_b32 v29, 16, v29
    v_mul_u32_u24 v30, 24, v29
    v_sub_u32 v30, v28, v30
    v_and_b32 v31, 2, v29
    v_xor_b32 v30, v30, v31
    v_add_u32 v29, s28, v29
    v_mul_u32_u24 v29, 3072, v29
    v_subrev_u32 v29, 1024, v29
    v_lshl_add_u32 v18, v30, 4, v29
    v_xor_b32 v30, 4, v30
    v_lshl_add_u32 v21, v30, 4, v29

    v_add_u32 v28, 128, v1
    v_mul_u32_u24 v29, 2731, v28
    v_lshrrev_b32 v29, 16, v29
    v_mul_u32_u24 v30, 24, v29
    v_sub_u32 v30, v28, v30
    v_and_b32 v31, 2, v29
    v_xor_b32 v30, v30, v31
    v_add_u32 v29, s28, v29
    v_mul_u32_u24 v29, 3072, v29
    v_subrev_u32 v29, 2048, v29
    v_lshl_add_u32 v19, v30, 4, v29
    v_xor_b32 v30, 4, v30
    v_lshl_add_u32 v22, v30, 4, v29

    s_mul_i32 s35, s24, 3072
    s_add_u32 s35, s35, 49152
    s_mul_i32 s34, s26, 384
    s_waitcnt lgkmcnt(0)
    s_mov_b32 s8, s64
    s_and_b32 s9, s65, 0xffff
    s_mov_b32 s10, 2621440
    s_mov_b32 s11, 0x00020000
    s_mov_b32 s38, s27
    s_lshl_b32 s38, s38, 7
    s_add_u32 m0, s36, 0
    s_add_u32 s38, s38, s32
    buffer_load_dwordx4 v12, s[8:11], s38 offen offset:0 lds
    buffer_load_dwordx4 v13, s[8:11], s38 offen offset:1024 lds
    buffer_load_dwordx4 v14, s[8:11], s38 offen offset:2048 lds
    buffer_load_dwordx4 v15, s[8:11], s38 offen offset:3072 lds
    s_mov_b32 s12, s72
    s_and_b32 s13, s73, 0xffff
    s_mov_b32 s14, 1966080
    s_mov_b32 s15, 0x00020000
    s_mov_b32 s16, s74
    s_and_b32 s17, s75, 0xffff
    s_mov_b32 s18, 1966080
    s_mov_b32 s19, 0x00020000
    s_mov_b32 s40, s27
    s_mul_i32 s40, s40, 196608
    s_add_u32 m0, s35, 0
    s_add_u32 s40, s40, s34
    buffer_load_dwordx4 v17, s[12:15], s40 offen offset:0 lds
    buffer_load_dwordx4 v18, s[12:15], s40 offen offset:1024 lds
    buffer_load_dwordx4 v19, s[12:15], s40 offen offset:2048 lds
    s_add_u32 m0, s35, 12288
    s_nop 0
    buffer_load_dwordx4 v20, s[16:19], s40 offen offset:0 lds
    buffer_load_dwordx4 v21, s[16:19], s40 offen offset:1024 lds
    buffer_load_dwordx4 v22, s[16:19], s40 offen offset:2048 lds
    v_and_b32 v28, 31, v1
    v_lshrrev_b32 v29, 5, v1
    v_bfe_u32 v30, v1, 1, 3
    v_xor_b32 v30, v30, v29
    v_lshlrev_b32 v28, 7, v28

    v_xor_b32 v31, 0, v30
    v_lshl_add_u32 v2, v31, 4, v28
    v_xor_b32 v31, 2, v30
    v_lshl_add_u32 v3, v31, 4, v28
    v_xor_b32 v31, 4, v30
    v_lshl_add_u32 v4, v31, 4, v28
    v_xor_b32 v31, 6, v30
    v_lshl_add_u32 v5, v31, 4, v28
    v_bfe_u32 v28, v1, 4, 1
    v_bfe_u32 v30, v1, 2, 2
    v_lshl_add_u32 v29, v29, 3, v30
    v_mul_u32_u24 v29, 384, v29
    v_mul_u32_u24 v31, 12288, v28
    v_add_u32 v29, v29, v31
    v_and_b32 v31, 1, v1
    v_lshl_add_u32 v29, v31, 3, v29
    v_add_u32 v29, 49152, v29
    v_and_b32 v30, 2, v30
    v_lshlrev_b32 v28, 2, v28
    v_xor_b32 v30, v30, v28
    v_bfe_u32 v31, v1, 1, 1
    s_mul_i32 s28, s24, 6
    v_add_u32 v31, s28, v31

    v_add_u32 v28, 0, v31
    v_xor_b32 v28, v28, v30
    v_lshl_add_u32 v6, v28, 4, v29
    v_add_u32 v9, 49152, v6

    v_add_u32 v28, 2, v31
    v_xor_b32 v28, v28, v30
    v_lshl_add_u32 v7, v28, 4, v29
    v_add_u32 v10, 49152, v7

    v_add_u32 v28, 4, v31
    v_xor_b32 v28, v28, v30
    v_lshl_add_u32 v8, v28, 4, v29
    v_add_u32 v11, 49152, v8

    v_mov_b32 v24, 0x3f803f80
    v_mov_b32 v25, 0x3f803f80
    v_mov_b32 v26, 0x3f803f80
    v_mov_b32 v27, 0x3f803f80
    s_add_u32 m0, s35, 24576
    s_add_u32 s40, s40, 98304
    buffer_load_dwordx4 v17, s[12:15], s40 offen offset:0 lds
    buffer_load_dwordx4 v18, s[12:15], s40 offen offset:1024 lds
    buffer_load_dwordx4 v19, s[12:15], s40 offen offset:2048 lds
    s_add_u32 m0, s35, 36864
    s_nop 0
    buffer_load_dwordx4 v20, s[16:19], s40 offen offset:0 lds
    buffer_load_dwordx4 v21, s[16:19], s40 offen offset:1024 lds
    buffer_load_dwordx4 v22, s[16:19], s40 offen offset:2048 lds
    s_mov_b32 s20, s82
    s_and_b32 s21, s83, 0xffff
    s_mov_b32 s22, 12632192
    s_mov_b32 s23, 0x00020000
    s_mov_b32 s56, s78
    s_and_b32 s57, s79, 0xffff
    s_mov_b32 s58, 2621440
    s_mov_b32 s59, 0x00020000
    s_mov_b32 s45, 0xffff0000
    v_lshlrev_b32 v62, 4, v1
    v_add_u32 v63, 1024, v62
    v_lshrrev_b32 v28, 5, v1
    v_mul_u32_u24 v28, 1280, v28
    v_and_b32 v29, 31, v1
    v_lshl_add_u32 v28, v29, 4, v28
    v_cmp_gt_u32 vcc, 16, v29
    v_mov_b32 v31, 2146435072
    v_mov_b32 v32, 0
    v_cndmask_b32 v30, v31, v28, vcc
    s_lshl_b32 s83, s25, 4
    s_add_u32 s83, s83, s26
    s_add_u32 s83, s83, 8
    s_lshl_b32 s28, s83, 2
    s_add_u32 s28, s28, s24
    s_mul_i32 s29, s28, 2560
    s_mov_b32 s30, 12632064
    s_waitcnt vmcnt(6) lgkmcnt(0)
    s_barrier
    ds_read_b128 a[0:3], v2 offset:0
    ds_read_b64_tr_b16 a[16:17], v6 offset:0
    ds_read_b64_tr_b16 a[18:19], v6 offset:1536
    ds_read_b64_tr_b16 a[20:21], v7 offset:0
    ds_read_b64_tr_b16 a[22:23], v7 offset:1536
    ds_read_b64_tr_b16 a[24:25], v8 offset:0
    ds_read_b64_tr_b16 a[26:27], v8 offset:1536
    ds_read_b128 a[4:7], v2 offset:4096
    ds_read_b128 a[8:11], v2 offset:8192
    ds_read_b128 a[12:15], v2 offset:12288
    s_waitcnt lgkmcnt(0)
    v_mfma_f32_32x32x16_bf16 v[192:207], a[16:19], a[0:3], 0
    ds_read_b128 a[28:31], v3 offset:0
    ds_read_b64_tr_b16 a[44:45], v6 offset:6144
    s_cmp_ge_u32 s27, 1
    s_cselect_b32 s38, 0, 1
    v_mfma_f32_32x32x16_bf16 v[128:143], a[20:23], a[0:3], 0
    ds_read_b64_tr_b16 a[46:47], v6 offset:7680
    ds_read_b64_tr_b16 a[48:49], v7 offset:6144
    s_lshl_b32 s38, s38, 7
    s_add_u32 m0, s36, 16384
    s_add_u32 s38, s38, s32
    buffer_load_dwordx4 v12, s[8:11], s38 offen offset:0 lds
    v_mfma_f32_32x32x16_bf16 v[64:79], a[24:27], a[0:3], 0
    ds_read_b64_tr_b16 a[50:51], v7 offset:7680
    ds_read_b64_tr_b16 a[52:53], v8 offset:6144
    buffer_load_dwordx4 v13, s[8:11], s38 offen offset:1024 lds
    v_mfma_f32_32x32x16_bf16 v[80:95], a[24:27], a[4:7], 0
    ds_read_b64_tr_b16 a[54:55], v8 offset:7680
    ds_read_b128 a[32:35], v3 offset:4096
    buffer_load_dwordx4 v14, s[8:11], s38 offen offset:2048 lds
    v_mfma_f32_32x32x16_bf16 v[144:159], a[20:23], a[4:7], 0
    ds_read_b128 a[36:39], v3 offset:8192
    ds_read_b128 a[40:43], v3 offset:12288
    buffer_load_dwordx4 v15, s[8:11], s38 offen offset:3072 lds
    s_cmp_ge_u32 s27, 1
    s_cselect_b32 s40, 0, 1
    v_mfma_f32_32x32x16_bf16 v[208:223], a[16:19], a[4:7], 0
    s_mul_i32 s40, s40, 196608
    s_add_u32 m0, s35, 49152
    s_add_u32 s40, s40, s34
    buffer_load_dword v35, v32, s[20:23], s30 offen sc1
    v_mfma_f32_32x32x16_bf16 v[224:239], a[16:19], a[8:11], 0
    v_mfma_f32_32x32x16_bf16 v[160:175], a[20:23], a[8:11], 0
    v_mfma_f32_32x32x16_bf16 v[96:111], a[24:27], a[8:11], 0
    buffer_load_dwordx4 v17, s[12:15], s40 offen offset:0 lds
    v_mfma_f32_32x32x16_bf16 v[112:127], a[24:27], a[12:15], 0
    v_mfma_f32_32x32x16_bf16 v[176:191], a[20:23], a[12:15], 0
    buffer_load_dwordx4 v18, s[12:15], s40 offen offset:1024 lds
    v_mfma_f32_32x32x16_bf16 v[240:255], a[16:19], a[12:15], 0
    v_mfma_f32_32x32x16_bf16 a[56:71], v[24:27], a[16:19], 0
    buffer_load_dwordx4 v19, s[12:15], s40 offen offset:2048 lds
    s_add_u32 m0, s35, 61440
    s_nop 0
    v_mfma_f32_32x32x16_bf16 a[72:87], v[24:27], a[20:23], 0
    v_mfma_f32_32x32x16_bf16 a[88:103], v[24:27], a[24:27], 0
    buffer_load_dwordx4 v20, s[16:19], s40 offen offset:0 lds
    s_waitcnt lgkmcnt(0)
    v_mfma_f32_32x32x16_bf16 v[192:207], a[44:47], a[28:31], v[192:207]
    s_waitcnt vmcnt(9) lgkmcnt(0)
    s_barrier
    v_mfma_f32_32x32x16_bf16 v[128:143], a[48:51], a[28:31], v[128:143]
    ds_read_b128 a[0:3], v4 offset:0
    ds_read_b64_tr_b16 a[16:17], v6 offset:24576
    s_waitcnt vmcnt(4)
    v_add_u32 v35, 1, v35
    buffer_load_dwordx4 v21, s[16:19], s40 offen offset:1024 lds
    v_mfma_f32_32x32x16_bf16 v[64:79], a[52:55], a[28:31], v[64:79]
    ds_read_b64_tr_b16 a[18:19], v6 offset:26112
    ds_read_b64_tr_b16 a[20:21], v7 offset:24576
    s_nop 0
    v_readfirstlane_b32 s52, v35
    buffer_load_dwordx4 v22, s[16:19], s40 offen offset:2048 lds
    v_mfma_f32_32x32x16_bf16 v[80:95], a[52:55], a[32:35], v[80:95]
    ds_read_b64_tr_b16 a[22:23], v7 offset:26112
    ds_read_b64_tr_b16 a[24:25], v8 offset:24576
    s_and_b32 s4, s2, 7
    s_lshr_b32 s5, s2, 3
    v_mfma_f32_32x32x16_bf16 v[144:159], a[48:51], a[32:35], v[144:159]
    ds_read_b64_tr_b16 a[26:27], v8 offset:26112
    ds_read_b128 a[4:7], v4 offset:4096
    s_lshl_b32 s43, s4, 2
    s_and_b32 s44, s5, 1
    v_mfma_f32_32x32x16_bf16 v[208:223], a[44:47], a[32:35], v[208:223]
    ds_read_b128 a[8:11], v4 offset:8192
    ds_read_b128 a[12:15], v4 offset:12288
    s_lshl_b32 s44, s44, 1
    s_add_u32 s43, s43, s44
    v_mfma_f32_32x32x16_bf16 v[224:239], a[44:47], a[36:39], v[224:239]
    s_lshr_b32 s44, s5, 4
    s_xor_b32 s44, s44, 1
    s_add_u32 s43, s43, s44
    s_bfe_u32 s44, s5, 0x30001
    v_mfma_f32_32x32x16_bf16 v[160:175], a[48:51], a[36:39], v[160:175]
    s_mul_i32 s4, s43, 278528
    s_mul_i32 s5, s24, 49152
    s_add_u32 s47, s4, s5
    s_add_u32 s47, s47, 81920
    v_mfma_f32_32x32x16_bf16 v[96:111], a[52:55], a[36:39], v[96:111]
    s_mul_i32 s5, s24, 20480
    s_add_u32 s55, s4, s5
    s_mul_i32 s4, s44, 5120
    s_add_u32 s4, s4, 8912896
    v_mfma_f32_32x32x16_bf16 v[112:127], a[52:55], a[40:43], v[112:127]
    s_mul_i32 s5, s24, 491520
    s_add_u32 s46, s4, s5
    s_add_u32 s46, s46, 819200
    s_mul_i32 s5, s24, 204800
    v_mfma_f32_32x32x16_bf16 v[176:191], a[48:51], a[40:43], v[176:191]
    s_add_u32 s50, s4, s5
    s_lshl_b32 s4, s44, 1
    s_add_u32 s4, s4, s43
    s_and_b32 s4, s4, 2
    v_mfma_f32_32x32x16_bf16 v[240:255], a[44:47], a[40:43], v[240:255]
    s_and_b32 s7, s4, 3
    s_mul_i32 s6, s7, 3
    s_mul_i32 s3, s6, 40960
    s_add_u32 s46, s46, s3
    v_mfma_f32_32x32x16_bf16 a[56:71], v[24:27], a[44:47], a[56:71]
    s_mul_i32 s3, s7, 40960
    s_add_u32 s50, s50, s3
    s_lshl_b32 s3, s6, 12
    s_add_u32 s47, s47, s3
    v_mfma_f32_32x32x16_bf16 a[72:87], v[24:27], a[48:51], a[72:87]
    s_lshl_b32 s3, s7, 12
    s_add_u32 s55, s55, s3
    s_lshl_b32 s48, s43, 6
    s_lshl_b32 s5, s24, 4
    v_mfma_f32_32x32x16_bf16 a[88:103], v[24:27], a[52:55], a[88:103]
    s_add_u32 s48, s48, s5
    s_lshl_b32 s42, s48, 4
    s_add_u32 s42, s42, 11698176
    s_mul_i32 s48, s48, 1280
    s_waitcnt lgkmcnt(0)
    v_mfma_f32_32x32x16_bf16 v[192:207], a[16:19], a[0:3], v[192:207]
    ds_read_b128 a[28:31], v5 offset:0
    ds_read_b64_tr_b16 a[44:45], v6 offset:30720
    s_mul_i32 s5, s44, 160
    s_add_u32 s48, s48, s5
    v_mfma_f32_32x32x16_bf16 v[128:143], a[20:23], a[0:3], v[128:143]
    ds_read_b64_tr_b16 a[46:47], v6 offset:32256
    ds_read_b64_tr_b16 a[48:49], v7 offset:30720
    s_add_u32 m0, s35, 73728
    s_add_u32 s40, s40, 98304
    buffer_load_dwordx4 v17, s[12:15], s40 offen offset:0 lds
    v_mfma_f32_32x32x16_bf16 v[64:79], a[24:27], a[0:3], v[64:79]
    ds_read_b64_tr_b16 a[50:51], v7 offset:32256
    ds_read_b64_tr_b16 a[52:53], v8 offset:30720
    buffer_load_dwordx4 v18, s[12:15], s40 offen offset:1024 lds
    v_mfma_f32_32x32x16_bf16 v[80:95], a[24:27], a[4:7], v[80:95]
    ds_read_b64_tr_b16 a[54:55], v8 offset:32256
    ds_read_b128 a[32:35], v5 offset:4096
    buffer_load_dwordx4 v19, s[12:15], s40 offen offset:2048 lds
    s_add_u32 m0, s35, 86016
    s_nop 0
    v_mfma_f32_32x32x16_bf16 v[144:159], a[20:23], a[4:7], v[144:159]
    ds_read_b128 a[36:39], v5 offset:8192
    ds_read_b128 a[40:43], v5 offset:12288
    buffer_load_dwordx4 v20, s[16:19], s40 offen offset:0 lds
    v_mfma_f32_32x32x16_bf16 v[208:223], a[16:19], a[4:7], v[208:223]
    buffer_load_dwordx4 v21, s[16:19], s40 offen offset:1024 lds
    v_mfma_f32_32x32x16_bf16 v[224:239], a[16:19], a[8:11], v[224:239]
    buffer_load_dwordx4 v22, s[16:19], s40 offen offset:2048 lds
    v_mfma_f32_32x32x16_bf16 v[160:175], a[20:23], a[8:11], v[160:175]
    buffer_load_dwordx4 v[36:39], v28, s[8:11], s29 offen
    v_mfma_f32_32x32x16_bf16 v[96:111], a[24:27], a[8:11], v[96:111]
    buffer_load_dwordx4 v[40:43], v28, s[8:11], s29 offen offset:512
    v_mfma_f32_32x32x16_bf16 v[112:127], a[24:27], a[12:15], v[112:127]
    buffer_load_dwordx4 v[44:47], v30, s[8:11], s29 offen offset:1024
    s_cmp_ge_u32 s27, 2
    s_cselect_b32 s38, 1, 2
    s_lshl_b32 s38, s38, 7
    v_mfma_f32_32x32x16_bf16 v[176:191], a[20:23], a[12:15], v[176:191]
    s_add_u32 m0, s36, 32768
    s_add_u32 s38, s38, s32
    v_mfma_f32_32x32x16_bf16 v[240:255], a[16:19], a[12:15], v[240:255]
    v_mfma_f32_32x32x16_bf16 a[56:71], v[24:27], a[16:19], a[56:71]
    v_mfma_f32_32x32x16_bf16 a[72:87], v[24:27], a[20:23], a[72:87]
    v_mfma_f32_32x32x16_bf16 a[88:103], v[24:27], a[24:27], a[88:103]
    s_waitcnt lgkmcnt(0)
    v_mfma_f32_32x32x16_bf16 v[192:207], a[44:47], a[28:31], v[192:207]
    s_waitcnt vmcnt(9) lgkmcnt(0)
    s_barrier
    v_mfma_f32_32x32x16_bf16 v[128:143], a[48:51], a[28:31], v[128:143]
    ds_read_b128 a[0:3], v2 offset:16384
    ds_read_b64_tr_b16 a[16:17], v9 offset:0
    buffer_load_dwordx4 v12, s[8:11], s38 offen offset:0 lds
    v_mfma_f32_32x32x16_bf16 v[64:79], a[52:55], a[28:31], v[64:79]
    ds_read_b64_tr_b16 a[18:19], v9 offset:1536
    ds_read_b64_tr_b16 a[20:21], v10 offset:0
    buffer_load_dwordx4 v13, s[8:11], s38 offen offset:1024 lds
    v_mfma_f32_32x32x16_bf16 v[80:95], a[52:55], a[32:35], v[80:95]
    ds_read_b64_tr_b16 a[22:23], v10 offset:1536
    ds_read_b64_tr_b16 a[24:25], v11 offset:0
    v_mfma_f32_32x32x16_bf16 v[144:159], a[48:51], a[32:35], v[144:159]
    ds_read_b64_tr_b16 a[26:27], v11 offset:1536
    ds_read_b128 a[4:7], v2 offset:20480
    buffer_load_dwordx4 v14, s[8:11], s38 offen offset:2048 lds
    v_mfma_f32_32x32x16_bf16 v[208:223], a[44:47], a[32:35], v[208:223]
    ds_read_b128 a[8:11], v2 offset:24576
    ds_read_b128 a[12:15], v2 offset:28672
    v_mfma_f32_32x32x16_bf16 v[224:239], a[44:47], a[36:39], v[224:239]
    buffer_load_dwordx4 v15, s[8:11], s38 offen offset:3072 lds
    s_cmp_ge_u32 s27, 2
    s_cselect_b32 s40, 1, 2
    s_mul_i32 s40, s40, 196608
    v_mfma_f32_32x32x16_bf16 v[160:175], a[48:51], a[36:39], v[160:175]
    s_add_u32 m0, s35, 0
    s_add_u32 s40, s40, s34
    v_mfma_f32_32x32x16_bf16 v[96:111], a[52:55], a[36:39], v[96:111]
    v_mfma_f32_32x32x16_bf16 v[112:127], a[52:55], a[40:43], v[112:127]
    buffer_load_dwordx4 v17, s[12:15], s40 offen offset:0 lds
    v_mfma_f32_32x32x16_bf16 v[176:191], a[48:51], a[40:43], v[176:191]
    v_mfma_f32_32x32x16_bf16 v[240:255], a[44:47], a[40:43], v[240:255]
    buffer_load_dwordx4 v18, s[12:15], s40 offen offset:1024 lds
    v_mfma_f32_32x32x16_bf16 a[56:71], v[24:27], a[44:47], a[56:71]
    v_mfma_f32_32x32x16_bf16 a[72:87], v[24:27], a[48:51], a[72:87]
    buffer_load_dwordx4 v19, s[12:15], s40 offen offset:2048 lds
    s_add_u32 m0, s35, 12288
    s_nop 0
    v_mfma_f32_32x32x16_bf16 a[88:103], v[24:27], a[52:55], a[88:103]
    s_waitcnt lgkmcnt(0)
    v_mfma_f32_32x32x16_bf16 v[192:207], a[16:19], a[0:3], v[192:207]
    ds_read_b128 a[28:31], v3 offset:16384
    ds_read_b64_tr_b16 a[44:45], v9 offset:6144
    buffer_load_dwordx4 v20, s[16:19], s40 offen offset:0 lds
    v_mfma_f32_32x32x16_bf16 v[128:143], a[20:23], a[0:3], v[128:143]
    ds_read_b64_tr_b16 a[46:47], v9 offset:7680
    ds_read_b64_tr_b16 a[48:49], v10 offset:6144
    buffer_load_dwordx4 v21, s[16:19], s40 offen offset:1024 lds
    v_mfma_f32_32x32x16_bf16 v[64:79], a[24:27], a[0:3], v[64:79]
    ds_read_b64_tr_b16 a[50:51], v10 offset:7680
    ds_read_b64_tr_b16 a[52:53], v11 offset:6144
    buffer_load_dwordx4 v22, s[16:19], s40 offen offset:2048 lds
    s_add_u32 m0, s35, 24576
    s_add_u32 s40, s40, 98304
    v_mfma_f32_32x32x16_bf16 v[80:95], a[24:27], a[4:7], v[80:95]
    ds_read_b64_tr_b16 a[54:55], v11 offset:7680
    ds_read_b128 a[32:35], v3 offset:20480
    v_mfma_f32_32x32x16_bf16 v[144:159], a[20:23], a[4:7], v[144:159]
    ds_read_b128 a[36:39], v3 offset:24576
    ds_read_b128 a[40:43], v3 offset:28672
    v_mfma_f32_32x32x16_bf16 v[208:223], a[16:19], a[4:7], v[208:223]
    v_mfma_f32_32x32x16_bf16 v[224:239], a[16:19], a[8:11], v[224:239]
    buffer_load_dwordx4 v17, s[12:15], s40 offen offset:0 lds
    v_mfma_f32_32x32x16_bf16 v[160:175], a[20:23], a[8:11], v[160:175]
    v_mfma_f32_32x32x16_bf16 v[96:111], a[24:27], a[8:11], v[96:111]
    buffer_load_dwordx4 v18, s[12:15], s40 offen offset:1024 lds
    v_mfma_f32_32x32x16_bf16 v[112:127], a[24:27], a[12:15], v[112:127]
    v_mfma_f32_32x32x16_bf16 v[176:191], a[20:23], a[12:15], v[176:191]
    buffer_load_dwordx4 v19, s[12:15], s40 offen offset:2048 lds
    s_add_u32 m0, s35, 36864
    s_nop 0
    v_mfma_f32_32x32x16_bf16 v[240:255], a[16:19], a[12:15], v[240:255]
    s_waitcnt lgkmcnt(0)
    v_mfma_f32_32x32x16_bf16 v[192:207], a[44:47], a[28:31], v[192:207]
    s_waitcnt vmcnt(16) lgkmcnt(0)
    s_barrier
    v_mfma_f32_32x32x16_bf16 v[128:143], a[48:51], a[28:31], v[128:143]
    ds_read_b128 a[0:3], v4 offset:16384
    ds_read_b64_tr_b16 a[16:17], v9 offset:24576
    buffer_load_dwordx4 v20, s[16:19], s40 offen offset:0 lds
    v_and_b32 v34, 31, v1
    v_mfma_f32_32x32x16_bf16 v[64:79], a[52:55], a[28:31], v[64:79]
    ds_read_b64_tr_b16 a[18:19], v9 offset:26112
    ds_read_b64_tr_b16 a[20:21], v10 offset:24576
    buffer_load_dwordx4 v21, s[16:19], s40 offen offset:1024 lds
    v_lshlrev_b32 v34, 2, v34
    v_mfma_f32_32x32x16_bf16 v[80:95], a[52:55], a[32:35], v[80:95]
    ds_read_b64_tr_b16 a[22:23], v10 offset:26112
    ds_read_b64_tr_b16 a[24:25], v11 offset:24576
    s_mul_i32 s29, s26, 15360
    s_mul_i32 s30, s24, 384
    v_mfma_f32_32x32x16_bf16 v[144:159], a[48:51], a[32:35], v[144:159]
    ds_read_b64_tr_b16 a[26:27], v11 offset:26112
    ds_read_b128 a[4:7], v4 offset:20480
    buffer_load_dwordx4 v22, s[16:19], s40 offen offset:2048 lds
    s_cmp_ge_u32 s27, 3
    s_cselect_b32 s38, 2, 3
    v_mfma_f32_32x32x16_bf16 v[208:223], a[44:47], a[32:35], v[208:223]
    ds_read_b128 a[8:11], v4 offset:24576
    ds_read_b128 a[12:15], v4 offset:28672
    s_lshl_b32 s38, s38, 7
    s_add_u32 m0, s36, 0
    s_add_u32 s38, s38, s32
    v_mfma_f32_32x32x16_bf16 v[224:239], a[44:47], a[36:39], v[224:239]
    buffer_load_dwordx4 v12, s[8:11], s38 offen offset:0 lds
    s_add_u32 s29, s29, s30
    s_add_u32 s54, s29, 11853824
    s_mul_i32 s29, s27, 1536
    v_mfma_f32_32x32x16_bf16 v[160:175], a[48:51], a[36:39], v[160:175]
    s_add_u32 s29, s29, s54
    buffer_store_dword a56, v34, s[20:23], s29 offen offset:0 sc1
    v_mfma_f32_32x32x16_bf16 v[96:111], a[52:55], a[36:39], v[96:111]
    buffer_store_dword a72, v34, s[20:23], s29 offen offset:128 sc1
    v_mfma_f32_32x32x16_bf16 v[112:127], a[52:55], a[40:43], v[112:127]
    buffer_load_dwordx4 v13, s[8:11], s38 offen offset:1024 lds
    v_mfma_f32_32x32x16_bf16 v[176:191], a[48:51], a[40:43], v[176:191]
    buffer_store_dword a88, v34, s[20:23], s29 offen offset:256 sc1
    s_and_b32 s30, s83, 15
    s_lshl_b32 s31, s25, 12
    s_lshl_b32 s82, s30, 2
    v_mfma_f32_32x32x16_bf16 v[240:255], a[44:47], a[40:43], v[240:255]
    s_add_u32 s31, s31, s82
    v_and_b32 v52, 15, v1
    v_lshlrev_b32 v53, 8, v52
    v_add_u32 v23, s31, v53
    s_waitcnt lgkmcnt(0)
    v_mfma_f32_32x32x16_bf16 v[192:207], a[16:19], a[0:3], v[192:207]
    ds_read_b128 a[28:31], v5 offset:16384
    ds_read_b64_tr_b16 a[44:45], v9 offset:30720
    buffer_load_dwordx4 v14, s[8:11], s38 offen offset:2048 lds
    v_add_u32 v53, 4168, v23
    v_mfma_f32_32x32x16_bf16 v[128:143], a[20:23], a[0:3], v[128:143]
    ds_read_b64_tr_b16 a[46:47], v9 offset:32256
    ds_read_b64_tr_b16 a[48:49], v10 offset:30720
    s_lshl_b32 s31, s30, 8
    s_lshl_b32 s82, s25, 2
    v_mfma_f32_32x32x16_bf16 v[64:79], a[24:27], a[0:3], v[64:79]
    ds_read_b64_tr_b16 a[50:51], v10 offset:32256
    ds_read_b64_tr_b16 a[52:53], v11 offset:30720
    buffer_load_dwordx4 v15, s[8:11], s38 offen offset:3072 lds
    s_cmp_ge_u32 s27, 3
    s_cselect_b32 s40, 2, 3
    v_mfma_f32_32x32x16_bf16 v[80:95], a[24:27], a[4:7], v[80:95]
    ds_read_b64_tr_b16 a[54:55], v11 offset:32256
    ds_read_b128 a[32:35], v5 offset:20480
    s_mul_i32 s40, s40, 196608
    s_add_u32 m0, s35, 49152
    s_add_u32 s40, s40, s34
    v_mfma_f32_32x32x16_bf16 v[144:159], a[20:23], a[4:7], v[144:159]
    ds_read_b128 a[36:39], v5 offset:24576
    ds_read_b128 a[40:43], v5 offset:28672
    buffer_load_dwordx4 v17, s[12:15], s40 offen offset:0 lds
    s_add_u32 s31, s31, s82
    v_mfma_f32_32x32x16_bf16 v[208:223], a[16:19], a[4:7], v[208:223]
    s_add_u32 s31, s31, 64
    v_lshlrev_b32 v52, 12, v52
    v_add_u32 v52, s31, v52
    v_mov_b32 v54, 2146435072
    v_mfma_f32_32x32x16_bf16 v[224:239], a[16:19], a[8:11], v[224:239]
    buffer_load_dwordx4 v18, s[12:15], s40 offen offset:1024 lds
    s_mov_b32 s82, 12500992
    s_mov_b32 vcc_lo, 0xffff0000
    s_mov_b32 vcc_hi, 0
    v_cndmask_b32 v23, v23, v52, vcc
    v_mfma_f32_32x32x16_bf16 v[160:175], a[20:23], a[8:11], v[160:175]
    s_mov_b32 vcc_lo, 0
    s_mov_b32 vcc_hi, -1
    v_cndmask_b32 v23, v23, v53, vcc
    s_cmp_ge_u32 s30, 14
    s_cselect_b32 s31, 0xff, 0
    s_cmp_lt_u32 s25, 15
    s_cselect_b32 s31, s31, 0
    v_mfma_f32_32x32x16_bf16 v[96:111], a[24:27], a[8:11], v[96:111]
    buffer_load_dwordx4 v19, s[12:15], s40 offen offset:2048 lds
    s_add_u32 m0, s35, 61440
    s_nop 0
    s_cmp_eq_u32 s24, 0
    s_cselect_b32 vcc_lo, -1, 0
    s_cselect_b32 vcc_hi, s31, 0
    v_cndmask_b32 v23, v54, v23, vcc
    v_mfma_f32_32x32x16_bf16 v[112:127], a[24:27], a[12:15], v[112:127]
    s_waitcnt vmcnt(26)
    v_lshlrev_b32 v28, 16, v36
    v_and_b32 v29, s45, v36
    v_mov_b32 v30, v28
    v_mfma_f32_32x32x16_bf16 v[176:191], a[20:23], a[12:15], v[176:191]
    buffer_load_dwordx4 v20, s[16:19], s40 offen offset:0 lds
    v_mov_b32 v31, v29
    v_mul_f32 v32, v28, v28
    v_mul_f32 v33, v29, v29
    v_mfma_f32_32x32x16_bf16 v[240:255], a[16:19], a[12:15], v[240:255]
    v_lshlrev_b32 v28, 16, v37
    v_and_b32 v29, s45, v37
    v_add_f32 v30, v30, v28
    v_add_f32 v31, v31, v29
    s_waitcnt lgkmcnt(0)
    v_mfma_f32_32x32x16_bf16 v[192:207], a[44:47], a[28:31], v[192:207]
    s_waitcnt vmcnt(17) lgkmcnt(0)
    s_barrier
    v_mfma_f32_32x32x16_bf16 v[128:143], a[48:51], a[28:31], v[128:143]
    ds_read_b128 a[0:3], v2 offset:32768
    ds_read_b64_tr_b16 a[16:17], v6 offset:0
    buffer_load_dwordx4 v21, s[16:19], s40 offen offset:1024 lds
    v_fmac_f32 v32, v28, v28
    v_mfma_f32_32x32x16_bf16 v[64:79], a[52:55], a[28:31], v[64:79]
    ds_read_b64_tr_b16 a[18:19], v6 offset:1536
    ds_read_b64_tr_b16 a[20:21], v7 offset:0
    buffer_load_dwordx4 v22, s[16:19], s40 offen offset:2048 lds
    s_add_u32 m0, s35, 73728
    s_add_u32 s40, s40, 98304
    v_mfma_f32_32x32x16_bf16 v[80:95], a[52:55], a[32:35], v[80:95]
    ds_read_b64_tr_b16 a[22:23], v7 offset:1536
    ds_read_b64_tr_b16 a[24:25], v8 offset:0
    v_fmac_f32 v33, v29, v29
    v_lshlrev_b32 v28, 16, v38
    v_mfma_f32_32x32x16_bf16 v[144:159], a[48:51], a[32:35], v[144:159]
    ds_read_b64_tr_b16 a[26:27], v8 offset:1536
    ds_read_b128 a[4:7], v2 offset:36864
    buffer_load_dwordx4 v17, s[12:15], s40 offen offset:0 lds
    v_and_b32 v29, s45, v38
    v_mfma_f32_32x32x16_bf16 v[208:223], a[44:47], a[32:35], v[208:223]
    ds_read_b128 a[8:11], v2 offset:40960
    ds_read_b128 a[12:15], v2 offset:45056
    v_add_f32 v30, v30, v28
    v_add_f32 v31, v31, v29
    v_mfma_f32_32x32x16_bf16 v[224:239], a[44:47], a[36:39], v[224:239]
    buffer_load_dwordx4 v18, s[12:15], s40 offen offset:1024 lds
    v_fmac_f32 v32, v28, v28
    v_fmac_f32 v33, v29, v29
    v_lshlrev_b32 v28, 16, v39
    v_mfma_f32_32x32x16_bf16 v[160:175], a[48:51], a[36:39], v[160:175]
    v_and_b32 v29, s45, v39
    v_add_f32 v30, v30, v28
    v_add_f32 v31, v31, v29
    v_fmac_f32 v32, v28, v28
    v_mfma_f32_32x32x16_bf16 v[96:111], a[52:55], a[36:39], v[96:111]
    v_fmac_f32 v33, v29, v29
    v_lshlrev_b32 v28, 16, v40
    v_and_b32 v29, s45, v40
    v_add_f32 v30, v30, v28
    v_mfma_f32_32x32x16_bf16 v[112:127], a[52:55], a[40:43], v[112:127]
    buffer_load_dwordx4 v19, s[12:15], s40 offen offset:2048 lds
    s_add_u32 m0, s35, 86016
    s_nop 0
    v_add_f32 v31, v31, v29
    v_mfma_f32_32x32x16_bf16 v[176:191], a[48:51], a[40:43], v[176:191]
    v_fmac_f32 v32, v28, v28
    v_fmac_f32 v33, v29, v29
    v_lshlrev_b32 v28, 16, v41
    v_and_b32 v29, s45, v41
    v_mfma_f32_32x32x16_bf16 v[240:255], a[44:47], a[40:43], v[240:255]
    buffer_load_dwordx4 v20, s[16:19], s40 offen offset:0 lds
    v_add_f32 v30, v30, v28
    v_add_f32 v31, v31, v29
    v_fmac_f32 v32, v28, v28
    s_waitcnt lgkmcnt(0)
    v_mfma_f32_32x32x16_bf16 v[192:207], a[16:19], a[0:3], v[192:207]
    ds_read_b128 a[28:31], v3 offset:32768
    ds_read_b64_tr_b16 a[44:45], v6 offset:6144
    v_fmac_f32 v33, v29, v29
    v_lshlrev_b32 v28, 16, v42
    v_mfma_f32_32x32x16_bf16 v[128:143], a[20:23], a[0:3], v[128:143]
    ds_read_b64_tr_b16 a[46:47], v6 offset:7680
    ds_read_b64_tr_b16 a[48:49], v7 offset:6144
    buffer_load_dwordx4 v21, s[16:19], s40 offen offset:1024 lds
    v_and_b32 v29, s45, v42
    v_mfma_f32_32x32x16_bf16 v[64:79], a[24:27], a[0:3], v[64:79]
    ds_read_b64_tr_b16 a[50:51], v7 offset:7680
    ds_read_b64_tr_b16 a[52:53], v8 offset:6144
    v_add_f32 v30, v30, v28
    v_add_f32 v31, v31, v29
    v_mfma_f32_32x32x16_bf16 v[80:95], a[24:27], a[4:7], v[80:95]
    ds_read_b64_tr_b16 a[54:55], v8 offset:7680
    ds_read_b128 a[32:35], v3 offset:36864
    buffer_load_dwordx4 v22, s[16:19], s40 offen offset:2048 lds
    s_cmp_ge_u32 s27, 4
    s_cselect_b32 s38, 3, 4
    v_mfma_f32_32x32x16_bf16 v[144:159], a[20:23], a[4:7], v[144:159]
    ds_read_b128 a[36:39], v3 offset:40960
    ds_read_b128 a[40:43], v3 offset:45056
    s_lshl_b32 s38, s38, 7
    s_add_u32 m0, s36, 16384
    s_add_u32 s38, s38, s32
    v_mfma_f32_32x32x16_bf16 v[208:223], a[16:19], a[4:7], v[208:223]
    buffer_load_dwordx4 v12, s[8:11], s38 offen offset:0 lds
    v_fmac_f32 v32, v28, v28
    v_fmac_f32 v33, v29, v29
    v_lshlrev_b32 v28, 16, v43
    v_mfma_f32_32x32x16_bf16 v[224:239], a[16:19], a[8:11], v[224:239]
    v_and_b32 v29, s45, v43
    v_add_f32 v30, v30, v28
    v_add_f32 v31, v31, v29
    v_fmac_f32 v32, v28, v28
    v_mfma_f32_32x32x16_bf16 v[160:175], a[20:23], a[8:11], v[160:175]
    buffer_load_dwordx4 v13, s[8:11], s38 offen offset:1024 lds
    v_fmac_f32 v33, v29, v29
    v_lshlrev_b32 v28, 16, v44
    v_and_b32 v29, s45, v44
    v_mfma_f32_32x32x16_bf16 v[96:111], a[24:27], a[8:11], v[96:111]
    v_add_f32 v30, v30, v28
    v_add_f32 v31, v31, v29
    v_fmac_f32 v32, v28, v28
    v_fmac_f32 v33, v29, v29
    v_mfma_f32_32x32x16_bf16 v[112:127], a[24:27], a[12:15], v[112:127]
    buffer_load_dwordx4 v14, s[8:11], s38 offen offset:2048 lds
    v_lshlrev_b32 v28, 16, v45
    v_and_b32 v29, s45, v45
    v_add_f32 v30, v30, v28
    v_mfma_f32_32x32x16_bf16 v[176:191], a[20:23], a[12:15], v[176:191]
    v_add_f32 v31, v31, v29
    v_fmac_f32 v32, v28, v28
    v_fmac_f32 v33, v29, v29
    v_lshlrev_b32 v28, 16, v46
    v_mfma_f32_32x32x16_bf16 v[240:255], a[16:19], a[12:15], v[240:255]
    buffer_load_dwordx4 v15, s[8:11], s38 offen offset:3072 lds
    v_and_b32 v29, s45, v46
    v_add_f32 v30, v30, v28
    v_add_f32 v31, v31, v29
    s_waitcnt lgkmcnt(0)
    v_mfma_f32_32x32x16_bf16 v[192:207], a[44:47], a[28:31], v[192:207]
    s_waitcnt vmcnt(23) lgkmcnt(0)
    s_barrier
    v_mfma_f32_32x32x16_bf16 v[128:143], a[48:51], a[28:31], v[128:143]
    ds_read_b128 a[0:3], v4 offset:32768
    ds_read_b64_tr_b16 a[16:17], v6 offset:24576
    s_cmp_ge_u32 s27, 4
    s_cselect_b32 s40, 3, 4
    v_mfma_f32_32x32x16_bf16 v[64:79], a[52:55], a[28:31], v[64:79]
    ds_read_b64_tr_b16 a[18:19], v6 offset:26112
    ds_read_b64_tr_b16 a[20:21], v7 offset:24576
    s_mul_i32 s40, s40, 196608
    s_add_u32 m0, s35, 0
    s_add_u32 s40, s40, s34
    v_mfma_f32_32x32x16_bf16 v[80:95], a[52:55], a[32:35], v[80:95]
    ds_read_b64_tr_b16 a[22:23], v7 offset:26112
    ds_read_b64_tr_b16 a[24:25], v8 offset:24576
    buffer_load_dwordx4 v17, s[12:15], s40 offen offset:0 lds
    v_fmac_f32 v32, v28, v28
    v_mfma_f32_32x32x16_bf16 v[144:159], a[48:51], a[32:35], v[144:159]
    ds_read_b64_tr_b16 a[26:27], v8 offset:26112
    ds_read_b128 a[4:7], v4 offset:36864
    buffer_load_dwordx4 v18, s[12:15], s40 offen offset:1024 lds
    v_fmac_f32 v33, v29, v29
    v_mfma_f32_32x32x16_bf16 v[208:223], a[44:47], a[32:35], v[208:223]
    ds_read_b128 a[8:11], v4 offset:40960
    ds_read_b128 a[12:15], v4 offset:45056
    v_lshlrev_b32 v28, 16, v47
    v_and_b32 v29, s45, v47
    v_mfma_f32_32x32x16_bf16 v[224:239], a[44:47], a[36:39], v[224:239]
    buffer_load_dwordx4 v19, s[12:15], s40 offen offset:2048 lds
    s_add_u32 m0, s35, 12288
    s_nop 0
    v_add_f32 v30, v30, v28
    v_mfma_f32_32x32x16_bf16 v[160:175], a[48:51], a[36:39], v[160:175]
    v_add_f32 v31, v31, v29
    v_fmac_f32 v32, v28, v28
    v_fmac_f32 v33, v29, v29
    v_add_f32 v30, v30, v31
    v_mfma_f32_32x32x16_bf16 v[96:111], a[52:55], a[36:39], v[96:111]
    buffer_load_dwordx4 v20, s[16:19], s40 offen offset:0 lds
    v_add_f32 v32, v32, v33
    s_nop 0
    v_add_f32_dpp v30, v30, v30 quad_perm:[1,0,3,2] row_mask:0xf bank_mask:0xf
    v_mfma_f32_32x32x16_bf16 v[112:127], a[52:55], a[40:43], v[112:127]
    v_add_f32_dpp v32, v32, v32 quad_perm:[1,0,3,2] row_mask:0xf bank_mask:0xf
    s_nop 0
    v_add_f32_dpp v30, v30, v30 quad_perm:[2,3,0,1] row_mask:0xf bank_mask:0xf
    v_add_f32_dpp v32, v32, v32 quad_perm:[2,3,0,1] row_mask:0xf bank_mask:0xf
    v_mfma_f32_32x32x16_bf16 v[176:191], a[48:51], a[40:43], v[176:191]
    buffer_load_dwordx4 v21, s[16:19], s40 offen offset:1024 lds
    s_nop 0
    v_add_f32_dpp v30, v30, v30 row_half_mirror row_mask:0xf bank_mask:0xf
    v_add_f32_dpp v32, v32, v32 row_half_mirror row_mask:0xf bank_mask:0xf
    v_mfma_f32_32x32x16_bf16 v[240:255], a[44:47], a[40:43], v[240:255]
    s_nop 0
    v_add_f32_dpp v30, v30, v30 row_mirror row_mask:0xf bank_mask:0xf
    v_add_f32_dpp v32, v32, v32 row_mirror row_mask:0xf bank_mask:0xf
    s_nop 0
    s_waitcnt lgkmcnt(0)
    v_mfma_f32_32x32x16_bf16 v[192:207], a[16:19], a[0:3], v[192:207]
    ds_read_b128 a[28:31], v5 offset:32768
    ds_read_b64_tr_b16 a[44:45], v6 offset:30720
    buffer_load_dwordx4 v22, s[16:19], s40 offen offset:2048 lds
    v_add_f32_dpp v30, v30, v30 row_bcast:15 row_mask:0xa bank_mask:0xf
    v_mfma_f32_32x32x16_bf16 v[128:143], a[20:23], a[0:3], v[128:143]
    ds_read_b64_tr_b16 a[46:47], v6 offset:32256
    ds_read_b64_tr_b16 a[48:49], v7 offset:30720
    v_add_f32_dpp v32, v32, v32 row_bcast:15 row_mask:0xa bank_mask:0xf
    s_nop 0
    v_mfma_f32_32x32x16_bf16 v[64:79], a[24:27], a[0:3], v[64:79]
    ds_read_b64_tr_b16 a[50:51], v7 offset:32256
    ds_read_b64_tr_b16 a[52:53], v8 offset:30720
    v_mul_f32 v30, 0x3acccccd, v30
    v_mul_f32 v32, 0x3acccccd, v32
    v_mfma_f32_32x32x16_bf16 v[80:95], a[24:27], a[4:7], v[80:95]
    ds_read_b64_tr_b16 a[54:55], v8 offset:32256
    ds_read_b128 a[32:35], v5 offset:36864
    v_fma_f32 v32, -v30, v30, v32
    v_max_f32 v32, 0, v32
    v_mfma_f32_32x32x16_bf16 v[144:159], a[20:23], a[4:7], v[144:159]
    ds_read_b128 a[36:39], v5 offset:40960
    ds_read_b128 a[40:43], v5 offset:45056
    v_cvt_pk_bf16_f32 v36, -v30, -v30
    v_cvt_pk_bf16_f32 v32, v32, v32
    v_mfma_f32_32x32x16_bf16 v[208:223], a[16:19], a[4:7], v[208:223]
    v_and_b32 v32, s45, v32
    v_add_f32 v32, 0x3727c5ac, v32
    v_cvt_pk_bf16_f32 v32, v32, v32
    v_and_b32 v32, s45, v32
    v_mfma_f32_32x32x16_bf16 v[224:239], a[16:19], a[8:11], v[224:239]
    v_sqrt_f32 v32, v32
    v_mov_b32 v37, v36
    v_cvt_pk_bf16_f32 v32, v32, v32
    v_and_b32 v32, s45, v32
    v_mfma_f32_32x32x16_bf16 v[160:175], a[20:23], a[8:11], v[160:175]
    v_rcp_f32 v38, v32
    v_and_b32 v28, 31, v1
    v_mul_f32 v39, v38, v38
    v_mov_b32 v29, 2146435072
    v_mfma_f32_32x32x16_bf16 v[96:111], a[24:27], a[8:11], v[96:111]
    s_lshl_b32 s28, s28, 5
    s_add_u32 s28, s28, 11698176
    v_cmp_eq_u32 vcc, 16, v28
    v_lshrrev_b32 v28, 5, v1
    v_lshlrev_b32 v28, 4, v28
    v_cndmask_b32 v28, v29, v28, vcc
    v_mfma_f32_32x32x16_bf16 v[112:127], a[24:27], a[12:15], v[112:127]
    buffer_store_dwordx4 v[36:39], v28, s[20:23], s28 offen sc1
    v_mfma_f32_32x32x16_bf16 v[176:191], a[20:23], a[12:15], v[176:191]
    v_mfma_f32_32x32x16_bf16 v[240:255], a[16:19], a[12:15], v[240:255]
    s_waitcnt lgkmcnt(0)
    v_mfma_f32_32x32x16_bf16 v[192:207], a[44:47], a[28:31], v[192:207]
    s_waitcnt vmcnt(17) lgkmcnt(0)
    s_barrier
    v_mfma_f32_32x32x16_bf16 v[128:143], a[48:51], a[28:31], v[128:143]
    ds_read_b128 a[0:3], v2 offset:0
    ds_read_b64_tr_b16 a[16:17], v9 offset:0
    s_add_u32 m0, s35, 24576
    s_add_u32 s40, s40, 98304
    v_mfma_f32_32x32x16_bf16 v[64:79], a[52:55], a[28:31], v[64:79]
    ds_read_b64_tr_b16 a[18:19], v9 offset:1536
    ds_read_b64_tr_b16 a[20:21], v10 offset:0
    buffer_load_dwordx4 v17, s[12:15], s40 offen offset:0 lds
    v_mfma_f32_32x32x16_bf16 v[80:95], a[52:55], a[32:35], v[80:95]
    ds_read_b64_tr_b16 a[22:23], v10 offset:1536
    ds_read_b64_tr_b16 a[24:25], v11 offset:0
    buffer_load_dwordx4 v18, s[12:15], s40 offen offset:1024 lds
    v_mfma_f32_32x32x16_bf16 v[144:159], a[48:51], a[32:35], v[144:159]
    ds_read_b64_tr_b16 a[26:27], v11 offset:1536
    ds_read_b128 a[4:7], v2 offset:4096
    v_mfma_f32_32x32x16_bf16 v[208:223], a[44:47], a[32:35], v[208:223]
    ds_read_b128 a[8:11], v2 offset:8192
    ds_read_b128 a[12:15], v2 offset:12288
    buffer_load_dwordx4 v19, s[12:15], s40 offen offset:2048 lds
    s_add_u32 m0, s35, 36864
    s_nop 0
    v_mfma_f32_32x32x16_bf16 v[224:239], a[44:47], a[36:39], v[224:239]
    v_mfma_f32_32x32x16_bf16 v[160:175], a[48:51], a[36:39], v[160:175]
    buffer_load_dwordx4 v20, s[16:19], s40 offen offset:0 lds
    v_mfma_f32_32x32x16_bf16 v[96:111], a[52:55], a[36:39], v[96:111]
    v_mfma_f32_32x32x16_bf16 v[112:127], a[52:55], a[40:43], v[112:127]
    buffer_load_dwordx4 v21, s[16:19], s40 offen offset:1024 lds
    v_mfma_f32_32x32x16_bf16 v[176:191], a[48:51], a[40:43], v[176:191]
    v_mfma_f32_32x32x16_bf16 v[240:255], a[44:47], a[40:43], v[240:255]
    buffer_load_dwordx4 v22, s[16:19], s40 offen offset:2048 lds
    s_cmp_ge_u32 s27, 5
    s_cselect_b32 s38, 4, 5
    s_lshl_b32 s38, s38, 7
    s_waitcnt lgkmcnt(0)
    v_mfma_f32_32x32x16_bf16 v[192:207], a[16:19], a[0:3], v[192:207]
    ds_read_b128 a[28:31], v3 offset:0
    ds_read_b64_tr_b16 a[44:45], v9 offset:6144
    s_add_u32 m0, s36, 32768
    s_add_u32 s38, s38, s32
    v_mfma_f32_32x32x16_bf16 v[128:143], a[20:23], a[0:3], v[128:143]
    ds_read_b64_tr_b16 a[46:47], v9 offset:7680
    ds_read_b64_tr_b16 a[48:49], v10 offset:6144
    buffer_load_dwordx4 v12, s[8:11], s38 offen offset:0 lds
    v_mfma_f32_32x32x16_bf16 v[64:79], a[24:27], a[0:3], v[64:79]
    ds_read_b64_tr_b16 a[50:51], v10 offset:7680
    ds_read_b64_tr_b16 a[52:53], v11 offset:6144
    v_mfma_f32_32x32x16_bf16 v[80:95], a[24:27], a[4:7], v[80:95]
    ds_read_b64_tr_b16 a[54:55], v11 offset:7680
    ds_read_b128 a[32:35], v3 offset:4096
    buffer_load_dwordx4 v13, s[8:11], s38 offen offset:1024 lds
    v_mfma_f32_32x32x16_bf16 v[144:159], a[20:23], a[4:7], v[144:159]
    ds_read_b128 a[36:39], v3 offset:8192
    ds_read_b128 a[40:43], v3 offset:12288
    v_mfma_f32_32x32x16_bf16 v[208:223], a[16:19], a[4:7], v[208:223]
    buffer_load_dwordx4 v14, s[8:11], s38 offen offset:2048 lds
    v_mfma_f32_32x32x16_bf16 v[224:239], a[16:19], a[8:11], v[224:239]
    v_mfma_f32_32x32x16_bf16 v[160:175], a[20:23], a[8:11], v[160:175]
    buffer_load_dwordx4 v15, s[8:11], s38 offen offset:3072 lds
    v_mfma_f32_32x32x16_bf16 v[96:111], a[24:27], a[8:11], v[96:111]
    v_mfma_f32_32x32x16_bf16 v[112:127], a[24:27], a[12:15], v[112:127]
    v_mfma_f32_32x32x16_bf16 v[176:191], a[20:23], a[12:15], v[176:191]
    v_mfma_f32_32x32x16_bf16 v[240:255], a[16:19], a[12:15], v[240:255]
    s_waitcnt lgkmcnt(0)
    v_mfma_f32_32x32x16_bf16 v[192:207], a[44:47], a[28:31], v[192:207]
    s_waitcnt vmcnt(21) lgkmcnt(0)
    s_barrier
    v_mfma_f32_32x32x16_bf16 v[128:143], a[48:51], a[28:31], v[128:143]
    ds_read_b128 a[0:3], v4 offset:0
    ds_read_b64_tr_b16 a[16:17], v9 offset:24576
    s_cmp_ge_u32 s27, 5
    s_cselect_b32 s40, 4, 5
    v_mfma_f32_32x32x16_bf16 v[64:79], a[52:55], a[28:31], v[64:79]
    ds_read_b64_tr_b16 a[18:19], v9 offset:26112
    ds_read_b64_tr_b16 a[20:21], v10 offset:24576
    s_mul_i32 s40, s40, 196608
    s_add_u32 m0, s35, 49152
    s_add_u32 s40, s40, s34
    v_mfma_f32_32x32x16_bf16 v[80:95], a[52:55], a[32:35], v[80:95]
    ds_read_b64_tr_b16 a[22:23], v10 offset:26112
    ds_read_b64_tr_b16 a[24:25], v11 offset:24576
    buffer_load_dwordx4 v17, s[12:15], s40 offen offset:0 lds
    v_mfma_f32_32x32x16_bf16 v[144:159], a[48:51], a[32:35], v[144:159]
    ds_read_b64_tr_b16 a[26:27], v11 offset:26112
    ds_read_b128 a[4:7], v4 offset:4096
    buffer_load_dwordx4 v18, s[12:15], s40 offen offset:1024 lds
    v_mfma_f32_32x32x16_bf16 v[208:223], a[44:47], a[32:35], v[208:223]
    ds_read_b128 a[8:11], v4 offset:8192
    ds_read_b128 a[12:15], v4 offset:12288
    v_mfma_f32_32x32x16_bf16 v[224:239], a[44:47], a[36:39], v[224:239]
    buffer_load_dwordx4 v19, s[12:15], s40 offen offset:2048 lds
    s_add_u32 m0, s35, 61440
    s_nop 0
    v_mfma_f32_32x32x16_bf16 v[160:175], a[48:51], a[36:39], v[160:175]
    v_mfma_f32_32x32x16_bf16 v[96:111], a[52:55], a[36:39], v[96:111]
    buffer_load_dwordx4 v20, s[16:19], s40 offen offset:0 lds
    v_mfma_f32_32x32x16_bf16 v[112:127], a[52:55], a[40:43], v[112:127]
    v_mfma_f32_32x32x16_bf16 v[176:191], a[48:51], a[40:43], v[176:191]
    buffer_load_dwordx4 v21, s[16:19], s40 offen offset:1024 lds
    v_mfma_f32_32x32x16_bf16 v[240:255], a[44:47], a[40:43], v[240:255]
    s_waitcnt lgkmcnt(0)
    v_mfma_f32_32x32x16_bf16 v[192:207], a[16:19], a[0:3], v[192:207]
    ds_read_b128 a[28:31], v5 offset:0
    ds_read_b64_tr_b16 a[44:45], v9 offset:30720
    buffer_load_dwordx4 v22, s[16:19], s40 offen offset:2048 lds
    v_mfma_f32_32x32x16_bf16 v[128:143], a[20:23], a[0:3], v[128:143]
    ds_read_b64_tr_b16 a[46:47], v9 offset:32256
    ds_read_b64_tr_b16 a[48:49], v10 offset:30720
    v_mfma_f32_32x32x16_bf16 v[64:79], a[24:27], a[0:3], v[64:79]
    ds_read_b64_tr_b16 a[50:51], v10 offset:32256
    ds_read_b64_tr_b16 a[52:53], v11 offset:30720
    v_mfma_f32_32x32x16_bf16 v[80:95], a[24:27], a[4:7], v[80:95]
    ds_read_b64_tr_b16 a[54:55], v11 offset:32256
    ds_read_b128 a[32:35], v5 offset:4096
    v_mfma_f32_32x32x16_bf16 v[144:159], a[20:23], a[4:7], v[144:159]
    ds_read_b128 a[36:39], v5 offset:8192
    ds_read_b128 a[40:43], v5 offset:12288
    v_mfma_f32_32x32x16_bf16 v[208:223], a[16:19], a[4:7], v[208:223]
    v_mfma_f32_32x32x16_bf16 v[224:239], a[16:19], a[8:11], v[224:239]
    v_mfma_f32_32x32x16_bf16 v[160:175], a[20:23], a[8:11], v[160:175]
    v_mfma_f32_32x32x16_bf16 v[96:111], a[24:27], a[8:11], v[96:111]
    v_mfma_f32_32x32x16_bf16 v[112:127], a[24:27], a[12:15], v[112:127]
    v_mfma_f32_32x32x16_bf16 v[176:191], a[20:23], a[12:15], v[176:191]
    v_mfma_f32_32x32x16_bf16 v[240:255], a[16:19], a[12:15], v[240:255]
    s_waitcnt lgkmcnt(0)
    v_mfma_f32_32x32x16_bf16 v[192:207], a[44:47], a[28:31], v[192:207]
    s_waitcnt vmcnt(16) lgkmcnt(0)
    s_barrier
    v_mfma_f32_32x32x16_bf16 v[128:143], a[48:51], a[28:31], v[128:143]
    ds_read_b128 a[0:3], v2 offset:16384
    ds_read_b64_tr_b16 a[16:17], v6 offset:0
    s_add_u32 m0, s35, 73728
    s_add_u32 s40, s40, 98304
    v_mfma_f32_32x32x16_bf16 v[64:79], a[52:55], a[28:31], v[64:79]
    ds_read_b64_tr_b16 a[18:19], v6 offset:1536
    ds_read_b64_tr_b16 a[20:21], v7 offset:0
    buffer_load_dwordx4 v17, s[12:15], s40 offen offset:0 lds
    v_mfma_f32_32x32x16_bf16 v[80:95], a[52:55], a[32:35], v[80:95]
    ds_read_b64_tr_b16 a[22:23], v7 offset:1536
    ds_read_b64_tr_b16 a[24:25], v8 offset:0
    buffer_load_dwordx4 v18, s[12:15], s40 offen offset:1024 lds
    v_mfma_f32_32x32x16_bf16 v[144:159], a[48:51], a[32:35], v[144:159]
    ds_read_b64_tr_b16 a[26:27], v8 offset:1536
    ds_read_b128 a[4:7], v2 offset:20480
    v_mfma_f32_32x32x16_bf16 v[208:223], a[44:47], a[32:35], v[208:223]
    ds_read_b128 a[8:11], v2 offset:24576
    ds_read_b128 a[12:15], v2 offset:28672
    buffer_store_dword v35, v23, s[20:23], s82 offen sc0 sc1
    v_mfma_f32_32x32x16_bf16 v[224:239], a[44:47], a[36:39], v[224:239]
    buffer_load_dwordx4 v19, s[12:15], s40 offen offset:2048 lds
    s_add_u32 m0, s35, 86016
    s_nop 0
    v_mfma_f32_32x32x16_bf16 v[160:175], a[48:51], a[36:39], v[160:175]
    buffer_load_dwordx4 v20, s[16:19], s40 offen offset:0 lds
    v_mfma_f32_32x32x16_bf16 v[96:111], a[52:55], a[36:39], v[96:111]
    v_mfma_f32_32x32x16_bf16 v[112:127], a[52:55], a[40:43], v[112:127]
    buffer_load_dwordx4 v21, s[16:19], s40 offen offset:1024 lds
    v_mfma_f32_32x32x16_bf16 v[176:191], a[48:51], a[40:43], v[176:191]
    v_mfma_f32_32x32x16_bf16 v[240:255], a[44:47], a[40:43], v[240:255]
    buffer_load_dwordx4 v22, s[16:19], s40 offen offset:2048 lds
    s_cmp_ge_u32 s27, 6
    s_cselect_b32 s38, 5, 6
    s_lshl_b32 s38, s38, 7
    s_waitcnt lgkmcnt(0)
    v_mfma_f32_32x32x16_bf16 v[192:207], a[16:19], a[0:3], v[192:207]
    ds_read_b128 a[28:31], v3 offset:16384
    ds_read_b64_tr_b16 a[44:45], v6 offset:6144
    s_add_u32 m0, s36, 0
    s_add_u32 s38, s38, s32
    v_mfma_f32_32x32x16_bf16 v[128:143], a[20:23], a[0:3], v[128:143]
    ds_read_b64_tr_b16 a[46:47], v6 offset:7680
    ds_read_b64_tr_b16 a[48:49], v7 offset:6144
    buffer_load_dwordx4 v12, s[8:11], s38 offen offset:0 lds
    v_mfma_f32_32x32x16_bf16 v[64:79], a[24:27], a[0:3], v[64:79]
    ds_read_b64_tr_b16 a[50:51], v7 offset:7680
    ds_read_b64_tr_b16 a[52:53], v8 offset:6144
    v_mfma_f32_32x32x16_bf16 v[80:95], a[24:27], a[4:7], v[80:95]
    ds_read_b64_tr_b16 a[54:55], v8 offset:7680
    ds_read_b128 a[32:35], v3 offset:20480
    buffer_load_dwordx4 v13, s[8:11], s38 offen offset:1024 lds
    v_mfma_f32_32x32x16_bf16 v[144:159], a[20:23], a[4:7], v[144:159]
    ds_read_b128 a[36:39], v3 offset:24576
    ds_read_b128 a[40:43], v3 offset:28672
    v_mfma_f32_32x32x16_bf16 v[208:223], a[16:19], a[4:7], v[208:223]
    buffer_load_dwordx4 v14, s[8:11], s38 offen offset:2048 lds
    v_mfma_f32_32x32x16_bf16 v[224:239], a[16:19], a[8:11], v[224:239]
    v_mfma_f32_32x32x16_bf16 v[160:175], a[20:23], a[8:11], v[160:175]
    v_mfma_f32_32x32x16_bf16 v[96:111], a[24:27], a[8:11], v[96:111]
    buffer_load_dwordx4 v15, s[8:11], s38 offen offset:3072 lds
    v_mfma_f32_32x32x16_bf16 v[112:127], a[24:27], a[12:15], v[112:127]
    v_mfma_f32_32x32x16_bf16 v[176:191], a[20:23], a[12:15], v[176:191]
    v_mfma_f32_32x32x16_bf16 v[240:255], a[16:19], a[12:15], v[240:255]
    s_waitcnt lgkmcnt(0)
    v_mfma_f32_32x32x16_bf16 v[192:207], a[44:47], a[28:31], v[192:207]
    s_waitcnt vmcnt(21) lgkmcnt(0)
    s_barrier
    v_mfma_f32_32x32x16_bf16 v[128:143], a[48:51], a[28:31], v[128:143]
    ds_read_b128 a[0:3], v4 offset:16384
    ds_read_b64_tr_b16 a[16:17], v6 offset:24576
    s_cmp_ge_u32 s27, 6
    s_cselect_b32 s40, 5, 6
    v_mfma_f32_32x32x16_bf16 v[64:79], a[52:55], a[28:31], v[64:79]
    ds_read_b64_tr_b16 a[18:19], v6 offset:26112
    ds_read_b64_tr_b16 a[20:21], v7 offset:24576
    s_mul_i32 s40, s40, 196608
    s_add_u32 m0, s35, 0
    s_add_u32 s40, s40, s34
    v_mfma_f32_32x32x16_bf16 v[80:95], a[52:55], a[32:35], v[80:95]
    ds_read_b64_tr_b16 a[22:23], v7 offset:26112
    ds_read_b64_tr_b16 a[24:25], v8 offset:24576
    buffer_load_dwordx4 v17, s[12:15], s40 offen offset:0 lds
    v_mfma_f32_32x32x16_bf16 v[144:159], a[48:51], a[32:35], v[144:159]
    ds_read_b64_tr_b16 a[26:27], v8 offset:26112
    ds_read_b128 a[4:7], v4 offset:20480
    buffer_load_dwordx4 v18, s[12:15], s40 offen offset:1024 lds
    v_mfma_f32_32x32x16_bf16 v[208:223], a[44:47], a[32:35], v[208:223]
    ds_read_b128 a[8:11], v4 offset:24576
    ds_read_b128 a[12:15], v4 offset:28672
    v_mfma_f32_32x32x16_bf16 v[224:239], a[44:47], a[36:39], v[224:239]
    buffer_load_dwordx4 v19, s[12:15], s40 offen offset:2048 lds
    s_add_u32 m0, s35, 12288
    s_nop 0
    v_mfma_f32_32x32x16_bf16 v[160:175], a[48:51], a[36:39], v[160:175]
    v_mfma_f32_32x32x16_bf16 v[96:111], a[52:55], a[36:39], v[96:111]
    buffer_load_dwordx4 v20, s[16:19], s40 offen offset:0 lds
    v_mfma_f32_32x32x16_bf16 v[112:127], a[52:55], a[40:43], v[112:127]
    v_mfma_f32_32x32x16_bf16 v[176:191], a[48:51], a[40:43], v[176:191]
    buffer_load_dwordx4 v21, s[16:19], s40 offen offset:1024 lds
    v_mfma_f32_32x32x16_bf16 v[240:255], a[44:47], a[40:43], v[240:255]
    s_waitcnt lgkmcnt(0)
    v_mfma_f32_32x32x16_bf16 v[192:207], a[16:19], a[0:3], v[192:207]
    ds_read_b128 a[28:31], v5 offset:16384
    ds_read_b64_tr_b16 a[44:45], v6 offset:30720
    buffer_load_dwordx4 v22, s[16:19], s40 offen offset:2048 lds
    v_mfma_f32_32x32x16_bf16 v[128:143], a[20:23], a[0:3], v[128:143]
    ds_read_b64_tr_b16 a[46:47], v6 offset:32256
    ds_read_b64_tr_b16 a[48:49], v7 offset:30720
    v_mfma_f32_32x32x16_bf16 v[64:79], a[24:27], a[0:3], v[64:79]
    ds_read_b64_tr_b16 a[50:51], v7 offset:32256
    ds_read_b64_tr_b16 a[52:53], v8 offset:30720
    v_mfma_f32_32x32x16_bf16 v[80:95], a[24:27], a[4:7], v[80:95]
    ds_read_b64_tr_b16 a[54:55], v8 offset:32256
    ds_read_b128 a[32:35], v5 offset:20480
    v_mfma_f32_32x32x16_bf16 v[144:159], a[20:23], a[4:7], v[144:159]
    ds_read_b128 a[36:39], v5 offset:24576
    ds_read_b128 a[40:43], v5 offset:28672
    v_mfma_f32_32x32x16_bf16 v[208:223], a[16:19], a[4:7], v[208:223]
    v_mfma_f32_32x32x16_bf16 v[224:239], a[16:19], a[8:11], v[224:239]
    v_mfma_f32_32x32x16_bf16 v[160:175], a[20:23], a[8:11], v[160:175]
    v_mfma_f32_32x32x16_bf16 v[96:111], a[24:27], a[8:11], v[96:111]
    v_mfma_f32_32x32x16_bf16 v[112:127], a[24:27], a[12:15], v[112:127]
    v_mfma_f32_32x32x16_bf16 v[176:191], a[20:23], a[12:15], v[176:191]
    v_mfma_f32_32x32x16_bf16 v[240:255], a[16:19], a[12:15], v[240:255]
    s_waitcnt lgkmcnt(0)
    v_mfma_f32_32x32x16_bf16 v[192:207], a[44:47], a[28:31], v[192:207]
    s_waitcnt vmcnt(17) lgkmcnt(0)
    s_barrier
    v_mfma_f32_32x32x16_bf16 v[128:143], a[48:51], a[28:31], v[128:143]
    ds_read_b128 a[0:3], v2 offset:32768
    ds_read_b64_tr_b16 a[16:17], v9 offset:0
    s_add_u32 m0, s35, 24576
    s_add_u32 s40, s40, 98304
    v_mfma_f32_32x32x16_bf16 v[64:79], a[52:55], a[28:31], v[64:79]
    ds_read_b64_tr_b16 a[18:19], v9 offset:1536
    ds_read_b64_tr_b16 a[20:21], v10 offset:0
    buffer_load_dwordx4 v17, s[12:15], s40 offen offset:0 lds
    v_mfma_f32_32x32x16_bf16 v[80:95], a[52:55], a[32:35], v[80:95]
    ds_read_b64_tr_b16 a[22:23], v10 offset:1536
    ds_read_b64_tr_b16 a[24:25], v11 offset:0
    buffer_load_dwordx4 v18, s[12:15], s40 offen offset:1024 lds
    v_mfma_f32_32x32x16_bf16 v[144:159], a[48:51], a[32:35], v[144:159]
    ds_read_b64_tr_b16 a[26:27], v11 offset:1536
    ds_read_b128 a[4:7], v2 offset:36864
    v_mfma_f32_32x32x16_bf16 v[208:223], a[44:47], a[32:35], v[208:223]
    ds_read_b128 a[8:11], v2 offset:40960
    ds_read_b128 a[12:15], v2 offset:45056
    buffer_load_dwordx4 v19, s[12:15], s40 offen offset:2048 lds
    s_add_u32 m0, s35, 36864
    s_nop 0
    v_mfma_f32_32x32x16_bf16 v[224:239], a[44:47], a[36:39], v[224:239]
    v_mfma_f32_32x32x16_bf16 v[160:175], a[48:51], a[36:39], v[160:175]
    buffer_load_dwordx4 v20, s[16:19], s40 offen offset:0 lds
    v_mfma_f32_32x32x16_bf16 v[96:111], a[52:55], a[36:39], v[96:111]
    v_mfma_f32_32x32x16_bf16 v[112:127], a[52:55], a[40:43], v[112:127]
    buffer_load_dwordx4 v21, s[16:19], s40 offen offset:1024 lds
    v_mfma_f32_32x32x16_bf16 v[176:191], a[48:51], a[40:43], v[176:191]
    v_mfma_f32_32x32x16_bf16 v[240:255], a[44:47], a[40:43], v[240:255]
    buffer_load_dwordx4 v22, s[16:19], s40 offen offset:2048 lds
    s_cmp_ge_u32 s27, 7
    s_cselect_b32 s38, 6, 7
    s_lshl_b32 s38, s38, 7
    s_waitcnt lgkmcnt(0)
    v_mfma_f32_32x32x16_bf16 v[192:207], a[16:19], a[0:3], v[192:207]
    ds_read_b128 a[28:31], v3 offset:32768
    ds_read_b64_tr_b16 a[44:45], v9 offset:6144
    s_add_u32 m0, s36, 16384
    s_add_u32 s38, s38, s32
    v_mfma_f32_32x32x16_bf16 v[128:143], a[20:23], a[0:3], v[128:143]
    ds_read_b64_tr_b16 a[46:47], v9 offset:7680
    ds_read_b64_tr_b16 a[48:49], v10 offset:6144
    buffer_load_dwordx4 v12, s[8:11], s38 offen offset:0 lds
    v_mfma_f32_32x32x16_bf16 v[64:79], a[24:27], a[0:3], v[64:79]
    ds_read_b64_tr_b16 a[50:51], v10 offset:7680
    ds_read_b64_tr_b16 a[52:53], v11 offset:6144
    v_mfma_f32_32x32x16_bf16 v[80:95], a[24:27], a[4:7], v[80:95]
    ds_read_b64_tr_b16 a[54:55], v11 offset:7680
    ds_read_b128 a[32:35], v3 offset:36864
    buffer_load_dwordx4 v13, s[8:11], s38 offen offset:1024 lds
    v_mfma_f32_32x32x16_bf16 v[144:159], a[20:23], a[4:7], v[144:159]
    ds_read_b128 a[36:39], v3 offset:40960
    ds_read_b128 a[40:43], v3 offset:45056
    v_mfma_f32_32x32x16_bf16 v[208:223], a[16:19], a[4:7], v[208:223]
    buffer_load_dwordx4 v14, s[8:11], s38 offen offset:2048 lds
    v_mfma_f32_32x32x16_bf16 v[224:239], a[16:19], a[8:11], v[224:239]
    v_mfma_f32_32x32x16_bf16 v[160:175], a[20:23], a[8:11], v[160:175]
    buffer_load_dwordx4 v15, s[8:11], s38 offen offset:3072 lds
    v_mfma_f32_32x32x16_bf16 v[96:111], a[24:27], a[8:11], v[96:111]
    v_mfma_f32_32x32x16_bf16 v[112:127], a[24:27], a[12:15], v[112:127]
    v_mfma_f32_32x32x16_bf16 v[176:191], a[20:23], a[12:15], v[176:191]
    v_mfma_f32_32x32x16_bf16 v[240:255], a[16:19], a[12:15], v[240:255]
    s_waitcnt lgkmcnt(0)
    v_mfma_f32_32x32x16_bf16 v[192:207], a[44:47], a[28:31], v[192:207]
    s_waitcnt vmcnt(20) lgkmcnt(0)
    s_barrier
    v_mfma_f32_32x32x16_bf16 v[128:143], a[48:51], a[28:31], v[128:143]
    ds_read_b128 a[0:3], v4 offset:32768
    ds_read_b64_tr_b16 a[16:17], v9 offset:24576
    s_cmp_ge_u32 s27, 7
    s_cselect_b32 s40, 6, 7
    v_mfma_f32_32x32x16_bf16 v[64:79], a[52:55], a[28:31], v[64:79]
    ds_read_b64_tr_b16 a[18:19], v9 offset:26112
    ds_read_b64_tr_b16 a[20:21], v10 offset:24576
    s_mul_i32 s40, s40, 196608
    s_add_u32 m0, s35, 49152
    s_add_u32 s40, s40, s34
    v_mfma_f32_32x32x16_bf16 v[80:95], a[52:55], a[32:35], v[80:95]
    ds_read_b64_tr_b16 a[22:23], v10 offset:26112
    ds_read_b64_tr_b16 a[24:25], v11 offset:24576
    buffer_load_dwordx4 v17, s[12:15], s40 offen offset:0 lds
    s_lshl_b32 s30, s25, 15
    v_mfma_f32_32x32x16_bf16 v[144:159], a[48:51], a[32:35], v[144:159]
    ds_read_b64_tr_b16 a[26:27], v11 offset:26112
    ds_read_b128 a[4:7], v4 offset:36864
    buffer_load_dwordx4 v18, s[12:15], s40 offen offset:1024 lds
    s_lshl_b32 s31, s26, 7
    v_mfma_f32_32x32x16_bf16 v[208:223], a[44:47], a[32:35], v[208:223]
    ds_read_b128 a[8:11], v4 offset:40960
    ds_read_b128 a[12:15], v4 offset:45056
    v_cmp_gt_u32 vcc, 32, v0
    v_lshrrev_b32 v60, 5, v0
    v_mul_u32_u24 v60, 32640, v60
    v_lshl_add_u32 v23, v0, 2, v60
    v_mov_b32 v60, 2146435072
    v_cndmask_b32 v23, v60, v23, vcc
    v_mfma_f32_32x32x16_bf16 v[224:239], a[44:47], a[36:39], v[224:239]
    s_lshl_b32 s3, s43, 3
    s_add_u32 s3, s3, s44
    s_lshl_b32 s3, s3, 7
    s_add_u32 s3, s3, 12566528
    v_mfma_f32_32x32x16_bf16 v[160:175], a[48:51], a[36:39], v[160:175]
    buffer_load_dword v60, v23, s[20:23], s3 offen sc1 nt
    s_add_u32 s30, s30, s31
    s_add_u32 s53, s30, 11977728
    v_mfma_f32_32x32x16_bf16 v[96:111], a[52:55], a[36:39], v[96:111]
    buffer_load_dwordx4 v19, s[12:15], s40 offen offset:2048 lds
    s_add_u32 m0, s35, 61440
    s_nop 0
    v_mfma_f32_32x32x16_bf16 v[112:127], a[52:55], a[40:43], v[112:127]
    buffer_load_dwordx4 v20, s[16:19], s40 offen offset:0 lds
    v_mfma_f32_32x32x16_bf16 v[176:191], a[48:51], a[40:43], v[176:191]
    v_mfma_f32_32x32x16_bf16 v[240:255], a[44:47], a[40:43], v[240:255]
    buffer_load_dwordx4 v21, s[16:19], s40 offen offset:1024 lds
    s_waitcnt lgkmcnt(0)
    v_mfma_f32_32x32x16_bf16 v[192:207], a[16:19], a[0:3], v[192:207]
    ds_read_b128 a[28:31], v5 offset:32768
    ds_read_b64_tr_b16 a[44:45], v9 offset:30720
    v_mfma_f32_32x32x16_bf16 v[128:143], a[20:23], a[0:3], v[128:143]
    ds_read_b64_tr_b16 a[46:47], v9 offset:32256
    ds_read_b64_tr_b16 a[48:49], v10 offset:30720
    buffer_load_dwordx4 v22, s[16:19], s40 offen offset:2048 lds
    v_mfma_f32_32x32x16_bf16 v[64:79], a[24:27], a[0:3], v[64:79]
    ds_read_b64_tr_b16 a[50:51], v10 offset:32256
    ds_read_b64_tr_b16 a[52:53], v11 offset:30720
    v_mfma_f32_32x32x16_bf16 v[80:95], a[24:27], a[4:7], v[80:95]
    ds_read_b64_tr_b16 a[54:55], v11 offset:32256
    ds_read_b128 a[32:35], v5 offset:36864
    v_mfma_f32_32x32x16_bf16 v[144:159], a[20:23], a[4:7], v[144:159]
    ds_read_b128 a[36:39], v5 offset:40960
    ds_read_b128 a[40:43], v5 offset:45056
    v_mfma_f32_32x32x16_bf16 v[208:223], a[16:19], a[4:7], v[208:223]
    v_mfma_f32_32x32x16_bf16 v[224:239], a[16:19], a[8:11], v[224:239]
    v_mfma_f32_32x32x16_bf16 v[160:175], a[20:23], a[8:11], v[160:175]
    v_mfma_f32_32x32x16_bf16 v[96:111], a[24:27], a[8:11], v[96:111]
    v_mfma_f32_32x32x16_bf16 v[112:127], a[24:27], a[12:15], v[112:127]
    v_mfma_f32_32x32x16_bf16 v[176:191], a[20:23], a[12:15], v[176:191]
    v_mfma_f32_32x32x16_bf16 v[240:255], a[16:19], a[12:15], v[240:255]
    s_waitcnt lgkmcnt(0)
    v_mfma_f32_32x32x16_bf16 v[192:207], a[44:47], a[28:31], v[192:207]
    s_waitcnt vmcnt(4) lgkmcnt(0)
    s_cmp_lg_u32 s24, 0
    s_cbranch_scc1 LF_okw
    v_cmp_ne_u32 vcc, s52, v60
    s_and_b32 vcc_lo, vcc_lo, 0x0fff0fff
    s_cbranch_scc1 LF_sloww
LF_okw:
    s_barrier
    v_mfma_f32_32x32x16_bf16 v[128:143], a[48:51], a[28:31], v[128:143]
    ds_read_b128 a[0:3], v2 offset:0
    ds_read_b64_tr_b16 a[16:17], v6 offset:0
    s_add_u32 m0, s35, 73728
    s_add_u32 s40, s40, 98304
    v_mfma_f32_32x32x16_bf16 v[64:79], a[52:55], a[28:31], v[64:79]
    ds_read_b64_tr_b16 a[18:19], v6 offset:1536
    ds_read_b64_tr_b16 a[20:21], v7 offset:0
    buffer_load_dwordx4 v17, s[12:15], s40 offen offset:0 lds
    v_mfma_f32_32x32x16_bf16 v[80:95], a[52:55], a[32:35], v[80:95]
    ds_read_b64_tr_b16 a[22:23], v7 offset:1536
    ds_read_b64_tr_b16 a[24:25], v8 offset:0
    buffer_load_dwordx4 v18, s[12:15], s40 offen offset:1024 lds
    v_mfma_f32_32x32x16_bf16 v[144:159], a[48:51], a[32:35], v[144:159]
    ds_read_b64_tr_b16 a[26:27], v8 offset:1536
    ds_read_b128 a[4:7], v2 offset:4096
    v_mfma_f32_32x32x16_bf16 v[208:223], a[44:47], a[32:35], v[208:223]
    ds_read_b128 a[8:11], v2 offset:8192
    ds_read_b128 a[12:15], v2 offset:12288
    s_cmp_eq_u32 s24, 0
    s_cselect_b32 s82, 0, 2146435072
    v_lshlrev_b32 v52, 2, v1
    v_add_u32 v52, s82, v52
    v_mfma_f32_32x32x16_bf16 v[224:239], a[44:47], a[36:39], v[224:239]
    s_mov_b32 s4, -1
    s_cmp_lg_u32 s25, 0
    s_cselect_b32 s5, 0, 0
    s_lshl_b32 s82, s83, 8
    s_add_u32 s82, s82, 12500992
    v_mfma_f32_32x32x16_bf16 v[160:175], a[48:51], a[36:39], v[160:175]
    buffer_load_dword v48, v52, s[20:23], s82 offen sc1 nt
    v_mfma_f32_32x32x16_bf16 v[96:111], a[52:55], a[36:39], v[96:111]
    buffer_load_dwordx4 v19, s[12:15], s40 offen offset:2048 lds
    s_add_u32 m0, s35, 86016
    s_nop 0
    v_mfma_f32_32x32x16_bf16 v[112:127], a[52:55], a[40:43], v[112:127]
    buffer_load_dwordx4 v20, s[16:19], s40 offen offset:0 lds
    v_mfma_f32_32x32x16_bf16 v[176:191], a[48:51], a[40:43], v[176:191]
    v_mfma_f32_32x32x16_bf16 v[240:255], a[44:47], a[40:43], v[240:255]
    buffer_load_dwordx4 v21, s[16:19], s40 offen offset:1024 lds
    s_waitcnt lgkmcnt(0)
    v_mfma_f32_32x32x16_bf16 v[192:207], a[16:19], a[0:3], v[192:207]
    ds_read_b128 a[28:31], v3 offset:0
    ds_read_b64_tr_b16 a[44:45], v6 offset:6144
    v_mfma_f32_32x32x16_bf16 v[128:143], a[20:23], a[0:3], v[128:143]
    ds_read_b64_tr_b16 a[46:47], v6 offset:7680
    ds_read_b64_tr_b16 a[48:49], v7 offset:6144
    buffer_load_dwordx4 v22, s[16:19], s40 offen offset:2048 lds
    s_cmp_ge_u32 s27, 8
    s_cselect_b32 s38, 7, 8
    v_mfma_f32_32x32x16_bf16 v[64:79], a[24:27], a[0:3], v[64:79]
    ds_read_b64_tr_b16 a[50:51], v7 offset:7680
    ds_read_b64_tr_b16 a[52:53], v8 offset:6144
    s_lshl_b32 s38, s38, 7
    s_add_u32 m0, s36, 32768
    s_add_u32 s38, s38, s32
    v_mfma_f32_32x32x16_bf16 v[80:95], a[24:27], a[4:7], v[80:95]
    ds_read_b64_tr_b16 a[54:55], v8 offset:7680
    ds_read_b128 a[32:35], v3 offset:4096
    buffer_load_dwordx4 v12, s[8:11], s38 offen offset:0 lds
    v_mfma_f32_32x32x16_bf16 v[144:159], a[20:23], a[4:7], v[144:159]
    ds_read_b128 a[36:39], v3 offset:8192
    ds_read_b128 a[40:43], v3 offset:12288
    v_mfma_f32_32x32x16_bf16 v[208:223], a[16:19], a[4:7], v[208:223]
    buffer_load_dwordx4 v13, s[8:11], s38 offen offset:1024 lds
    v_mfma_f32_32x32x16_bf16 v[224:239], a[16:19], a[8:11], v[224:239]
    v_mfma_f32_32x32x16_bf16 v[160:175], a[20:23], a[8:11], v[160:175]
    buffer_load_dwordx4 v14, s[8:11], s38 offen offset:2048 lds
    v_mfma_f32_32x32x16_bf16 v[96:111], a[24:27], a[8:11], v[96:111]
    v_mfma_f32_32x32x16_bf16 v[112:127], a[24:27], a[12:15], v[112:127]
    buffer_load_dwordx4 v15, s[8:11], s38 offen offset:3072 lds
    s_cmp_ge_u32 s6, 12
    s_cselect_b32 s51, 12, 0
    s_sub_i32 s51, 0, s51
    s_mul_i32 s51, s51, 40960
    s_add_u32 s51, s51, s46
    v_mfma_f32_32x32x16_bf16 v[176:191], a[20:23], a[12:15], v[176:191]
    v_mfma_f32_32x32x16_bf16 v[240:255], a[16:19], a[12:15], v[240:255]
    buffer_load_dwordx4 a[56:59], v62, s[20:23], s51 offen sc1
    s_waitcnt lgkmcnt(0)
    v_mfma_f32_32x32x16_bf16 v[192:207], a[44:47], a[28:31], v[192:207]
    s_waitcnt vmcnt(9) lgkmcnt(0)
    s_cmp_lg_u32 s24, 0
    s_cbranch_scc1 LF_ok
    v_cmp_ne_u32 vcc, s52, v48
    s_and_b64 vcc, vcc, s[4:5]
    s_cbranch_scc1 LF_slow
LF_ok:
    s_barrier
    v_mfma_f32_32x32x16_bf16 v[128:143], a[48:51], a[28:31], v[128:143]
    ds_read_b128 a[0:3], v4 offset:0
    ds_read_b64_tr_b16 a[16:17], v6 offset:24576
    s_cmp_ge_u32 s27, 8
    s_cselect_b32 s40, 7, 8
    v_mfma_f32_32x32x16_bf16 v[64:79], a[52:55], a[28:31], v[64:79]
    ds_read_b64_tr_b16 a[18:19], v6 offset:26112
    ds_read_b64_tr_b16 a[20:21], v7 offset:24576
    s_mul_i32 s40, s40, 196608
    s_add_u32 m0, s35, 0
    s_add_u32 s40, s40, s34
    v_mfma_f32_32x32x16_bf16 v[80:95], a[52:55], a[32:35], v[80:95]
    ds_read_b64_tr_b16 a[22:23], v7 offset:26112
    ds_read_b64_tr_b16 a[24:25], v8 offset:24576
    buffer_load_dwordx4 v17, s[12:15], s40 offen offset:0 lds
    v_and_b32 v59, 31, v1
    v_mfma_f32_32x32x16_bf16 v[144:159], a[48:51], a[32:35], v[144:159]
    ds_read_b64_tr_b16 a[26:27], v8 offset:26112
    ds_read_b128 a[4:7], v4 offset:4096
    buffer_load_dwordx4 v18, s[12:15], s40 offen offset:1024 lds
    s_lshl_b32 s28, s25, 7
    v_mfma_f32_32x32x16_bf16 v[208:223], a[44:47], a[32:35], v[208:223]
    ds_read_b128 a[8:11], v4 offset:8192
    ds_read_b128 a[12:15], v4 offset:12288
    v_add_u32 v59, s28, v59
    v_lshlrev_b32 v59, 4, v59
    v_mfma_f32_32x32x16_bf16 v[224:239], a[44:47], a[36:39], v[224:239]
    buffer_load_dwordx4 v19, s[12:15], s40 offen offset:2048 lds
    s_add_u32 m0, s35, 12288
    s_nop 0
    s_mov_b32 s28, 11698176
    v_mfma_f32_32x32x16_bf16 v[160:175], a[48:51], a[36:39], v[160:175]
    buffer_load_dwordx4 v[28:31], v59, s[20:23], s28 offen offset:0 sc1
    v_mfma_f32_32x32x16_bf16 v[96:111], a[52:55], a[36:39], v[96:111]
    buffer_load_dwordx4 v20, s[16:19], s40 offen offset:0 lds
    v_mfma_f32_32x32x16_bf16 v[112:127], a[52:55], a[40:43], v[112:127]
    buffer_load_dwordx4 v[32:35], v59, s[20:23], s28 offen offset:512 sc1
    v_mfma_f32_32x32x16_bf16 v[176:191], a[48:51], a[40:43], v[176:191]
    buffer_load_dwordx4 v[36:39], v59, s[20:23], s28 offen offset:1024 sc1
    v_mfma_f32_32x32x16_bf16 v[240:255], a[44:47], a[40:43], v[240:255]
    buffer_load_dwordx4 v21, s[16:19], s40 offen offset:1024 lds
    s_waitcnt lgkmcnt(0)
    v_mfma_f32_32x32x16_bf16 v[192:207], a[16:19], a[0:3], v[192:207]
    ds_read_b128 a[28:31], v5 offset:0
    ds_read_b64_tr_b16 a[44:45], v6 offset:30720
    buffer_load_dwordx4 v[40:43], v59, s[20:23], s28 offen offset:1536 sc1
    v_and_b32 v59, 31, v1
    v_mfma_f32_32x32x16_bf16 v[128:143], a[20:23], a[0:3], v[128:143]
    ds_read_b64_tr_b16 a[46:47], v6 offset:32256
    ds_read_b64_tr_b16 a[48:49], v7 offset:30720
    v_lshrrev_b32 v61, 5, v1
    v_mul_u32_u24 v61, 7680, v61
    v_mfma_f32_32x32x16_bf16 v[64:79], a[24:27], a[0:3], v[64:79]
    ds_read_b64_tr_b16 a[50:51], v7 offset:32256
    ds_read_b64_tr_b16 a[52:53], v8 offset:30720
    buffer_load_dwordx4 v22, s[16:19], s40 offen offset:2048 lds
    v_lshl_add_u32 v59, v59, 2, v61
    v_mfma_f32_32x32x16_bf16 v[80:95], a[24:27], a[4:7], v[80:95]
    ds_read_b64_tr_b16 a[54:55], v8 offset:32256
    ds_read_b128 a[32:35], v5 offset:4096
    buffer_load_dword v44, v59, s[20:23], s54 offen offset:0 sc1
    v_mfma_f32_32x32x16_bf16 v[144:159], a[20:23], a[4:7], v[144:159]
    ds_read_b128 a[36:39], v5 offset:8192
    ds_read_b128 a[40:43], v5 offset:12288
    buffer_load_dword v49, v59, s[20:23], s54 offen offset:128 sc1
    v_mfma_f32_32x32x16_bf16 v[208:223], a[16:19], a[4:7], v[208:223]
    buffer_load_dword v54, v59, s[20:23], s54 offen offset:256 sc1
    v_mfma_f32_32x32x16_bf16 v[224:239], a[16:19], a[8:11], v[224:239]
    buffer_load_dword v45, v59, s[20:23], s54 offen offset:1536 sc1
    v_mfma_f32_32x32x16_bf16 v[160:175], a[20:23], a[8:11], v[160:175]
    buffer_load_dword v50, v59, s[20:23], s54 offen offset:1664 sc1
    v_mfma_f32_32x32x16_bf16 v[96:111], a[24:27], a[8:11], v[96:111]
    buffer_load_dword v55, v59, s[20:23], s54 offen offset:1792 sc1
    s_add_u32 s54, s54, 3072
    v_mfma_f32_32x32x16_bf16 v[112:127], a[24:27], a[12:15], v[112:127]
    buffer_load_dword v46, v59, s[20:23], s54 offen offset:0 sc1
    v_mfma_f32_32x32x16_bf16 v[176:191], a[20:23], a[12:15], v[176:191]
    buffer_load_dword v51, v59, s[20:23], s54 offen offset:128 sc1
    v_mfma_f32_32x32x16_bf16 v[240:255], a[16:19], a[12:15], v[240:255]
    buffer_load_dword v56, v59, s[20:23], s54 offen offset:256 sc1
    s_waitcnt lgkmcnt(0)
    v_mfma_f32_32x32x16_bf16 v[192:207], a[44:47], a[28:31], v[192:207]
    s_waitcnt lgkmcnt(0)
    s_barrier
    v_mfma_f32_32x32x16_bf16 v[128:143], a[48:51], a[28:31], v[128:143]
    ds_read_b128 a[0:3], v2 offset:16384
    ds_read_b64_tr_b16 a[16:17], v9 offset:0
    s_add_u32 m0, s35, 24576
    s_add_u32 s40, s40, 98304
    v_mfma_f32_32x32x16_bf16 v[64:79], a[52:55], a[28:31], v[64:79]
    ds_read_b64_tr_b16 a[18:19], v9 offset:1536
    ds_read_b64_tr_b16 a[20:21], v10 offset:0
    buffer_load_dwordx4 v17, s[12:15], s40 offen offset:0 lds
    v_mfma_f32_32x32x16_bf16 v[80:95], a[52:55], a[32:35], v[80:95]
    ds_read_b64_tr_b16 a[22:23], v10 offset:1536
    ds_read_b64_tr_b16 a[24:25], v11 offset:0
    buffer_load_dwordx4 v18, s[12:15], s40 offen offset:1024 lds
    v_mfma_f32_32x32x16_bf16 v[144:159], a[48:51], a[32:35], v[144:159]
    ds_read_b64_tr_b16 a[26:27], v11 offset:1536
    ds_read_b128 a[4:7], v2 offset:20480
    buffer_load_dword v47, v59, s[20:23], s54 offen offset:1536 sc1
    v_mfma_f32_32x32x16_bf16 v[208:223], a[44:47], a[32:35], v[208:223]
    ds_read_b128 a[8:11], v2 offset:24576
    ds_read_b128 a[12:15], v2 offset:28672
    buffer_load_dwordx4 v19, s[12:15], s40 offen offset:2048 lds
    s_add_u32 m0, s35, 36864
    s_nop 0
    v_mfma_f32_32x32x16_bf16 v[224:239], a[44:47], a[36:39], v[224:239]
    buffer_load_dword v52, v59, s[20:23], s54 offen offset:1664 sc1
    v_mfma_f32_32x32x16_bf16 v[160:175], a[48:51], a[36:39], v[160:175]
    buffer_load_dword v57, v59, s[20:23], s54 offen offset:1792 sc1
    s_add_u32 s54, s54, 3072
    v_mfma_f32_32x32x16_bf16 v[96:111], a[52:55], a[36:39], v[96:111]
    buffer_load_dwordx4 v20, s[16:19], s40 offen offset:0 lds
    v_mfma_f32_32x32x16_bf16 v[112:127], a[52:55], a[40:43], v[112:127]
    buffer_load_dword v48, v59, s[20:23], s54 offen offset:0 sc1
    v_mfma_f32_32x32x16_bf16 v[176:191], a[48:51], a[40:43], v[176:191]
    buffer_load_dword v53, v59, s[20:23], s54 offen offset:128 sc1
    v_mfma_f32_32x32x16_bf16 v[240:255], a[44:47], a[40:43], v[240:255]
    buffer_load_dwordx4 v21, s[16:19], s40 offen offset:1024 lds
    s_waitcnt lgkmcnt(0)
    v_mfma_f32_32x32x16_bf16 v[192:207], a[16:19], a[0:3], v[192:207]
    ds_read_b128 a[28:31], v3 offset:16384
    ds_read_b64_tr_b16 a[44:45], v9 offset:6144
    buffer_load_dword v58, v59, s[20:23], s54 offen offset:256 sc1
    v_mfma_f32_32x32x16_bf16 v[128:143], a[20:23], a[0:3], v[128:143]
    ds_read_b64_tr_b16 a[46:47], v9 offset:7680
    ds_read_b64_tr_b16 a[48:49], v10 offset:6144
    v_mfma_f32_32x32x16_bf16 v[64:79], a[24:27], a[0:3], v[64:79]
    ds_read_b64_tr_b16 a[50:51], v10 offset:7680
    ds_read_b64_tr_b16 a[52:53], v11 offset:6144
    buffer_load_dwordx4 v22, s[16:19], s40 offen offset:2048 lds
    s_cmp_ge_u32 s27, 9
    s_cselect_b32 s38, 8, 9
    v_mfma_f32_32x32x16_bf16 v[80:95], a[24:27], a[4:7], v[80:95]
    ds_read_b64_tr_b16 a[54:55], v11 offset:7680
    ds_read_b128 a[32:35], v3 offset:20480
    s_lshl_b32 s38, s38, 7
    s_add_u32 m0, s36, 0
    s_add_u32 s38, s38, s32
    v_mfma_f32_32x32x16_bf16 v[144:159], a[20:23], a[4:7], v[144:159]
    ds_read_b128 a[36:39], v3 offset:24576
    ds_read_b128 a[40:43], v3 offset:28672
    buffer_load_dwordx4 v12, s[8:11], s38 offen offset:0 lds
    v_mfma_f32_32x32x16_bf16 v[208:223], a[16:19], a[4:7], v[208:223]
    v_mfma_f32_32x32x16_bf16 v[224:239], a[16:19], a[8:11], v[224:239]
    buffer_load_dwordx4 v13, s[8:11], s38 offen offset:1024 lds
    v_mfma_f32_32x32x16_bf16 v[160:175], a[20:23], a[8:11], v[160:175]
    v_mfma_f32_32x32x16_bf16 v[96:111], a[24:27], a[8:11], v[96:111]
    buffer_load_dwordx4 v14, s[8:11], s38 offen offset:2048 lds
    v_mfma_f32_32x32x16_bf16 v[112:127], a[24:27], a[12:15], v[112:127]
    v_mfma_f32_32x32x16_bf16 v[176:191], a[20:23], a[12:15], v[176:191]
    buffer_load_dwordx4 v15, s[8:11], s38 offen offset:3072 lds
    v_mfma_f32_32x32x16_bf16 v[240:255], a[16:19], a[12:15], v[240:255]
    s_waitcnt lgkmcnt(0)
    v_mfma_f32_32x32x16_bf16 v[192:207], a[44:47], a[28:31], v[192:207]
    s_waitcnt vmcnt(40) lgkmcnt(0)
    s_barrier
    v_mfma_f32_32x32x16_bf16 v[128:143], a[48:51], a[28:31], v[128:143]
    ds_read_b128 a[0:3], v4 offset:16384
    ds_read_b64_tr_b16 a[16:17], v9 offset:24576
    s_cmp_ge_u32 s27, 9
    s_cselect_b32 s40, 8, 9
    v_mfma_f32_32x32x16_bf16 v[64:79], a[52:55], a[28:31], v[64:79]
    ds_read_b64_tr_b16 a[18:19], v9 offset:26112
    ds_read_b64_tr_b16 a[20:21], v10 offset:24576
    s_mul_i32 s40, s40, 196608
    s_add_u32 m0, s35, 49152
    s_add_u32 s40, s40, s34
    v_mfma_f32_32x32x16_bf16 v[80:95], a[52:55], a[32:35], v[80:95]
    ds_read_b64_tr_b16 a[22:23], v10 offset:26112
    ds_read_b64_tr_b16 a[24:25], v11 offset:24576
    buffer_load_dwordx4 v17, s[12:15], s40 offen offset:0 lds
    v_mfma_f32_32x32x16_bf16 v[144:159], a[48:51], a[32:35], v[144:159]
    ds_read_b64_tr_b16 a[26:27], v11 offset:26112
    ds_read_b128 a[4:7], v4 offset:20480
    buffer_load_dwordx4 v18, s[12:15], s40 offen offset:1024 lds
    v_mfma_f32_32x32x16_bf16 v[208:223], a[44:47], a[32:35], v[208:223]
    ds_read_b128 a[8:11], v4 offset:24576
    ds_read_b128 a[12:15], v4 offset:28672
    v_mfma_f32_32x32x16_bf16 v[224:239], a[44:47], a[36:39], v[224:239]
    buffer_load_dwordx4 v19, s[12:15], s40 offen offset:2048 lds
    s_add_u32 m0, s35, 61440
    s_nop 0
    v_mfma_f32_32x32x16_bf16 v[160:175], a[48:51], a[36:39], v[160:175]
    v_mfma_f32_32x32x16_bf16 v[96:111], a[52:55], a[36:39], v[96:111]
    buffer_load_dwordx4 v20, s[16:19], s40 offen offset:0 lds
    v_mfma_f32_32x32x16_bf16 v[112:127], a[52:55], a[40:43], v[112:127]
    v_mfma_f32_32x32x16_bf16 v[176:191], a[48:51], a[40:43], v[176:191]
    buffer_load_dwordx4 v21, s[16:19], s40 offen offset:1024 lds
    v_mfma_f32_32x32x16_bf16 v[240:255], a[44:47], a[40:43], v[240:255]
    s_waitcnt lgkmcnt(0)
    v_mfma_f32_32x32x16_bf16 v[192:207], a[16:19], a[0:3], v[192:207]
    ds_read_b128 a[28:31], v5 offset:16384
    ds_read_b64_tr_b16 a[44:45], v9 offset:30720
    buffer_load_dwordx4 v22, s[16:19], s40 offen offset:2048 lds
    s_waitcnt vmcnt(11)
    v_mfma_f32_32x32x16_bf16 v[128:143], a[20:23], a[0:3], v[128:143]
    ds_read_b64_tr_b16 a[46:47], v9 offset:32256
    ds_read_b64_tr_b16 a[48:49], v10 offset:30720
    v_add_f32 v44, v44, v45
    v_add_f32 v46, v46, v47
    v_mfma_f32_32x32x16_bf16 v[64:79], a[24:27], a[0:3], v[64:79]
    ds_read_b64_tr_b16 a[50:51], v10 offset:32256
    ds_read_b64_tr_b16 a[52:53], v11 offset:30720
    v_add_f32 v44, v44, v48
    v_add_f32 v44, v44, v46
    v_mfma_f32_32x32x16_bf16 v[80:95], a[24:27], a[4:7], v[80:95]
    ds_read_b64_tr_b16 a[54:55], v11 offset:32256
    ds_read_b128 a[32:35], v5 offset:20480
    v_and_b32 v45, s45, v44
    v_sub_f32 v44, v44, v45
    v_mfma_f32_32x32x16_bf16 v[144:159], a[20:23], a[4:7], v[144:159]
    ds_read_b128 a[36:39], v5 offset:24576
    ds_read_b128 a[40:43], v5 offset:28672
    v_and_b32 v46, s45, v44
    v_sub_f32 v44, v44, v46
    v_mfma_f32_32x32x16_bf16 v[208:223], a[16:19], a[4:7], v[208:223]
    v_cvt_pk_bf16_f32 v24, v45, v46
    v_cvt_pk_bf16_f32 v25, v44, 0
    v_add_f32 v49, v49, v50
    v_add_f32 v51, v51, v52
    v_mfma_f32_32x32x16_bf16 v[224:239], a[16:19], a[8:11], v[224:239]
    v_add_f32 v49, v49, v53
    v_add_f32 v49, v49, v51
    v_and_b32 v50, s45, v49
    v_sub_f32 v49, v49, v50
    v_mfma_f32_32x32x16_bf16 v[160:175], a[20:23], a[8:11], v[160:175]
    v_and_b32 v51, s45, v49
    v_sub_f32 v49, v49, v51
    v_cvt_pk_bf16_f32 v26, v50, v51
    v_cvt_pk_bf16_f32 v27, v49, 0
    v_mfma_f32_32x32x16_bf16 v[96:111], a[24:27], a[8:11], v[96:111]
    v_add_f32 v54, v54, v55
    v_add_f32 v56, v56, v57
    v_add_f32 v54, v54, v58
    v_add_f32 v54, v54, v56
    v_mfma_f32_32x32x16_bf16 v[112:127], a[24:27], a[12:15], v[112:127]
    v_and_b32 v55, s45, v54
    v_sub_f32 v54, v54, v55
    v_and_b32 v56, s45, v54
    v_sub_f32 v54, v54, v56
    v_mfma_f32_32x32x16_bf16 v[176:191], a[20:23], a[12:15], v[176:191]
    v_cvt_pk_bf16_f32 v60, v55, v56
    v_cvt_pk_bf16_f32 v61, v54, 0
    buffer_load_dwordx4 a[60:63], v63, s[20:23], s51 offen offset:0 sc1
    v_mfma_f32_32x32x16_bf16 v[240:255], a[16:19], a[12:15], v[240:255]
    buffer_load_dwordx4 a[64:67], v63, s[20:23], s51 offen offset:1024 sc1
    s_waitcnt lgkmcnt(0)
    v_mfma_f32_32x32x16_bf16 v[192:207], a[44:47], a[28:31], v[192:207]
    s_waitcnt lgkmcnt(0)
    s_barrier
    v_mfma_f32_32x32x16_bf16 v[128:143], a[48:51], a[28:31], v[128:143]
    ds_read_b128 a[0:3], v2 offset:32768
    ds_read_b64_tr_b16 a[16:17], v6 offset:0
    s_add_u32 m0, s35, 73728
    s_add_u32 s40, s40, 98304
    v_mfma_f32_32x32x16_bf16 v[64:79], a[52:55], a[28:31], v[64:79]
    ds_read_b64_tr_b16 a[18:19], v6 offset:1536
    ds_read_b64_tr_b16 a[20:21], v7 offset:0
    buffer_load_dwordx4 v17, s[12:15], s40 offen offset:0 lds
    v_mfma_f32_32x32x16_bf16 v[80:95], a[52:55], a[32:35], v[80:95]
    ds_read_b64_tr_b16 a[22:23], v7 offset:1536
    ds_read_b64_tr_b16 a[24:25], v8 offset:0
    buffer_load_dwordx4 v18, s[12:15], s40 offen offset:1024 lds
    v_mfma_f32_32x32x16_bf16 v[144:159], a[48:51], a[32:35], v[144:159]
    ds_read_b64_tr_b16 a[26:27], v8 offset:1536
    ds_read_b128 a[4:7], v2 offset:36864
    v_mfma_f32_32x32x16_bf16 v[208:223], a[44:47], a[32:35], v[208:223]
    ds_read_b128 a[8:11], v2 offset:40960
    ds_read_b128 a[12:15], v2 offset:45056
    buffer_load_dwordx4 v19, s[12:15], s40 offen offset:2048 lds
    s_add_u32 m0, s35, 86016
    s_nop 0
    v_mfma_f32_32x32x16_bf16 v[224:239], a[44:47], a[36:39], v[224:239]
    v_mfma_f32_32x32x16_bf16 v[160:175], a[48:51], a[36:39], v[160:175]
    buffer_load_dwordx4 v20, s[16:19], s40 offen offset:0 lds
    v_mfma_f32_32x32x16_bf16 v[96:111], a[52:55], a[36:39], v[96:111]
    v_mfma_f32_32x32x16_bf16 v[112:127], a[52:55], a[40:43], v[112:127]
    buffer_load_dwordx4 v21, s[16:19], s40 offen offset:1024 lds
    v_mfma_f32_32x32x16_bf16 v[176:191], a[48:51], a[40:43], v[176:191]
    v_mfma_f32_32x32x16_bf16 v[240:255], a[44:47], a[40:43], v[240:255]
    buffer_load_dwordx4 v22, s[16:19], s40 offen offset:2048 lds
    s_waitcnt lgkmcnt(0)
    v_mfma_f32_32x32x16_bf16 v[192:207], a[16:19], a[0:3], v[192:207]
    ds_read_b128 a[28:31], v3 offset:32768
    ds_read_b64_tr_b16 a[44:45], v6 offset:6144
    s_add_u32 s3, s24, 0
    s_and_b32 s3, s3, 3
    v_mfma_f32_32x32x16_bf16 v[128:143], a[20:23], a[0:3], v[128:143]
    ds_read_b64_tr_b16 a[46:47], v6 offset:7680
    ds_read_b64_tr_b16 a[48:49], v7 offset:6144
    buffer_load_dwordx4 a[68:71], v63, s[20:23], s51 offen offset:2048 sc1
    s_lshl_b32 s60, s3, 10
    v_mfma_f32_32x32x16_bf16 v[64:79], a[24:27], a[0:3], v[64:79]
    ds_read_b64_tr_b16 a[50:51], v7 offset:7680
    ds_read_b64_tr_b16 a[52:53], v8 offset:6144
    s_mul_i32 s4, s3, 30720
    s_add_u32 s3, s24, 1
    v_mfma_f32_32x32x16_bf16 v[80:95], a[24:27], a[4:7], v[80:95]
    ds_read_b64_tr_b16 a[54:55], v8 offset:7680
    ds_read_b128 a[32:35], v3 offset:36864
    buffer_load_dwordx4 a[72:75], v63, s[20:23], s51 offen offset:3072 sc1
    s_cmp_ge_u32 s6, 11
    s_cselect_b32 s51, 12, 0
    s_sub_i32 s51, 1, s51
    s_mul_i32 s51, s51, 40960
    s_add_u32 s51, s51, s46
    v_mfma_f32_32x32x16_bf16 v[144:159], a[20:23], a[4:7], v[144:159]
    ds_read_b128 a[36:39], v3 offset:40960
    ds_read_b128 a[40:43], v3 offset:45056
    s_and_b32 s3, s3, 3
    s_lshl_b32 s61, s3, 10
    v_mfma_f32_32x32x16_bf16 v[208:223], a[16:19], a[4:7], v[208:223]
    buffer_load_dwordx4 a[76:79], v62, s[20:23], s51 offen sc1
    s_mul_i32 s5, s3, 30720
    s_add_u32 s3, s24, 2
    s_and_b32 s3, s3, 3
    v_mfma_f32_32x32x16_bf16 v[224:239], a[16:19], a[8:11], v[224:239]
    s_lshl_b32 s62, s3, 10
    s_mul_i32 s54, s3, 30720
    s_add_u32 s54, s54, 10240
    s_add_u32 s3, s24, 3
    v_mfma_f32_32x32x16_bf16 v[160:175], a[20:23], a[8:11], v[160:175]
    buffer_load_dwordx4 a[80:83], v63, s[20:23], s51 offen offset:0 sc1
    s_and_b32 s3, s3, 3
    s_lshl_b32 s63, s3, 10
    s_mul_i32 s82, s3, 30720
    v_mfma_f32_32x32x16_bf16 v[96:111], a[24:27], a[8:11], v[96:111]
    s_add_u32 s82, s82, 20480
    s_cmp_ge_u32 s6, 12
    s_cselect_b32 s3, 49152, 0
    s_sub_u32 s12, s47, s3
    v_mfma_f32_32x32x16_bf16 v[112:127], a[24:27], a[12:15], v[112:127]
    buffer_load_dwordx4 a[84:87], v63, s[20:23], s51 offen offset:1024 sc1
    s_add_u32 s12, s12, 0
    s_add_u32 s13, s12, 4096
    s_add_u32 s14, s13, 4096
    v_mfma_f32_32x32x16_bf16 v[176:191], a[20:23], a[12:15], v[176:191]
    s_cmp_ge_u32 s6, 9
    s_cselect_b32 s3, 49152, 0
    s_sub_u32 s15, s47, s3
    s_add_u32 s15, s15, 12288
    v_mfma_f32_32x32x16_bf16 v[240:255], a[16:19], a[12:15], v[240:255]
    buffer_load_dwordx4 a[88:91], v63, s[20:23], s51 offen offset:2048 sc1
    s_add_u32 s16, s15, 4096
    s_add_u32 s17, s16, 4096
    s_cmp_ge_u32 s6, 6
    s_cselect_b32 s3, 49152, 0
    v_mfma_f32_32x32x8_bf16 v[192:207], v[24:25], v[28:29], v[192:207]
    s_sub_u32 s18, s47, s3
    s_add_u32 s18, s18, 24576
    s_add_u32 s19, s18, 4096
    s_add_u32 s32, s19, 4096
    v_mfma_f32_32x32x8_bf16 v[128:143], v[26:27], v[28:29], v[128:143]
    buffer_load_dwordx4 a[92:95], v63, s[20:23], s51 offen offset:3072 sc1
    s_cmp_ge_u32 s6, 10
    s_cselect_b32 s51, 12, 0
    s_sub_i32 s51, 2, s51
    s_mul_i32 s51, s51, 40960
    s_add_u32 s51, s51, s46
    v_mfma_f32_32x32x8_bf16 v[64:79], v[60:61], v[28:29], v[64:79]
    s_cmp_ge_u32 s6, 3
    s_cselect_b32 s3, 49152, 0
    s_sub_u32 s33, s47, s3
    s_add_u32 s33, s33, 36864
    v_mfma_f32_32x32x8_bf16 v[208:223], v[24:25], v[32:33], v[208:223]
    buffer_load_dwordx4 a[96:99], v62, s[20:23], s51 offen sc1
    s_add_u32 s34, s33, 4096
    s_add_u32 s35, s34, 4096
    s_cmp_ge_u32 s7, 5
    s_cselect_b32 s3, 20480, 0
    v_mfma_f32_32x32x8_bf16 v[144:159], v[26:27], v[32:33], v[144:159]
    s_sub_u32 s36, s55, s3
    s_add_u32 s36, s36, 0
    s_cmp_ge_u32 s7, 4
    s_cselect_b32 s3, 20480, 0
    v_mfma_f32_32x32x8_bf16 v[80:95], v[60:61], v[32:33], v[80:95]
    buffer_load_dwordx4 a[100:103], v63, s[20:23], s51 offen offset:0 sc1
    s_sub_u32 s37, s55, s3
    s_add_u32 s37, s37, 4096
    s_cmp_ge_u32 s7, 3
    s_cselect_b32 s3, 20480, 0
    v_mfma_f32_32x32x8_bf16 v[224:239], v[24:25], v[36:37], v[224:239]
    s_sub_u32 s38, s55, s3
    s_add_u32 s38, s38, 8192
    s_cmp_ge_u32 s7, 2
    s_cselect_b32 s3, 20480, 0
    v_mfma_f32_32x32x8_bf16 v[160:175], v[26:27], v[36:37], v[160:175]
    s_sub_u32 s39, s55, s3
    s_add_u32 s39, s39, 12288
    s_cmp_ge_u32 s7, 1
    s_cselect_b32 s3, 20480, 0
    v_mfma_f32_32x32x8_bf16 v[96:111], v[60:61], v[36:37], v[96:111]
    buffer_load_dwordx4 a[104:107], v63, s[20:23], s51 offen offset:1024 sc1
    s_sub_u32 s40, s55, s3
    s_add_u32 s40, s40, 16384
    s_lshl_b32 s41, s43, 3
    v_mfma_f32_32x32x8_bf16 v[240:255], v[24:25], v[40:41], v[240:255]
    s_add_u32 s41, s41, s44
    s_lshl_b32 s41, s41, 11
    s_lshl_b32 s3, s24, 8
    s_add_u32 s41, s41, s3
    v_mfma_f32_32x32x8_bf16 v[176:191], v[26:27], v[40:41], v[176:191]
    buffer_load_dwordx4 a[108:111], v63, s[20:23], s51 offen offset:2048 sc1
    s_add_u32 s41, s41, 11976704
    s_mov_b32 s49, 200000
    v_mfma_f32_32x32x8_bf16 v[112:127], v[60:61], v[40:41], v[112:127]
    s_waitcnt lgkmcnt(0)
    v_mfma_f32_32x32x16_bf16 v[192:207], a[44:47], a[28:31], v[192:207]
    s_waitcnt vmcnt(19) lgkmcnt(0)
    s_barrier
    v_mfma_f32_32x32x16_bf16 v[128:143], a[48:51], a[28:31], v[128:143]
    ds_read_b64_tr_b16 a[16:17], v6 offset:24576
    ds_read_b64_tr_b16 a[18:19], v6 offset:26112
    buffer_load_dwordx4 a[112:115], v63, s[20:23], s51 offen offset:3072 sc1
    s_cmp_ge_u32 s6, 9
    s_cselect_b32 s51, 12, 0
    s_sub_i32 s51, 3, s51
    s_mul_i32 s51, s51, 40960
    s_add_u32 s51, s51, s46
    v_mfma_f32_32x32x16_bf16 v[64:79], a[52:55], a[28:31], v[64:79]
    ds_read_b128 a[0:3], v4 offset:32768
    ds_read_b128 a[4:7], v4 offset:36864
    buffer_load_dwordx4 a[116:119], v62, s[20:23], s51 offen sc1
    v_mfma_f32_32x32x16_bf16 v[80:95], a[52:55], a[32:35], v[80:95]
    ds_read_b128 a[8:11], v4 offset:40960
    ds_read_b128 a[12:15], v4 offset:45056
    v_mfma_f32_32x32x16_bf16 v[144:159], a[48:51], a[32:35], v[144:159]
    buffer_load_dwordx4 a[120:123], v63, s[20:23], s51 offen offset:0 sc1
    v_mfma_f32_32x32x16_bf16 v[208:223], a[44:47], a[32:35], v[208:223]
    v_mfma_f32_32x32x16_bf16 v[224:239], a[44:47], a[36:39], v[224:239]
    buffer_load_dwordx4 a[124:127], v63, s[20:23], s51 offen offset:1024 sc1
    v_mfma_f32_32x32x16_bf16 v[160:175], a[48:51], a[36:39], v[160:175]
    v_mfma_f32_32x32x16_bf16 v[96:111], a[52:55], a[36:39], v[96:111]
    buffer_load_dwordx4 a[128:131], v63, s[20:23], s51 offen offset:2048 sc1
    v_mfma_f32_32x32x16_bf16 v[112:127], a[52:55], a[40:43], v[112:127]
    v_mfma_f32_32x32x16_bf16 v[176:191], a[48:51], a[40:43], v[176:191]
    buffer_load_dwordx4 a[132:135], v63, s[20:23], s51 offen offset:3072 sc1
    s_cmp_ge_u32 s6, 8
    s_cselect_b32 s51, 12, 0
    s_sub_i32 s51, 4, s51
    s_mul_i32 s51, s51, 40960
    s_add_u32 s51, s51, s46
    v_mfma_f32_32x32x16_bf16 v[240:255], a[44:47], a[40:43], v[240:255]
    s_waitcnt lgkmcnt(0)
    v_mfma_f32_32x32x16_bf16 v[192:207], a[16:19], a[0:3], v[192:207]
    ds_read_b64_tr_b16 a[44:45], v6 offset:30720
    ds_read_b64_tr_b16 a[46:47], v6 offset:32256
    buffer_load_dwordx4 a[136:139], v62, s[20:23], s51 offen sc1
    v_bfe_u32 v60, v1, 4, 1
    v_lshlrev_b32 v60, 10, v60
    v_mfma_f32_32x32x16_bf16 v[208:223], a[16:19], a[4:7], v[208:223]
    ds_read_b128 a[28:31], v5 offset:32768
    ds_read_b128 a[32:35], v5 offset:36864
    v_lshrrev_b32 v61, 5, v1
    v_lshl_add_u32 v60, v61, 8, v60
    v_and_b32 v61, 1, v1
    v_mfma_f32_32x32x16_bf16 v[224:239], a[16:19], a[8:11], v[224:239]
    ds_read_b128 a[36:39], v5 offset:40960
    ds_read_b128 a[40:43], v5 offset:45056
    v_lshl_add_u32 v60, v61, 4, v60
    v_bfe_u32 v61, v1, 2, 2
    v_lshl_add_u32 v60, v61, 5, v60
    v_mfma_f32_32x32x16_bf16 v[240:255], a[16:19], a[12:15], v[240:255]
    ds_read_b64_tr_b16 v[28:29], v9 offset:0
    ds_read_b64_tr_b16 v[30:31], v9 offset:1536
    v_bfe_u32 v61, v1, 1, 1
    v_lshl_add_u32 v59, v61, 7, v60
    v_add_u32 v60, 278528, v59
    s_waitcnt lgkmcnt(2)
    v_mfma_f32_32x32x16_bf16 v[192:207], a[44:47], a[28:31], v[192:207]
    ds_read_b128 a[20:23], v2 offset:0
    ds_read_b128 a[24:27], v2 offset:4096
    buffer_load_dwordx4 a[140:143], v63, s[20:23], s51 offen offset:0 sc1
    s_mul_i32 s28, s26, 12
    s_mul_i32 s29, s24, 3
    v_mfma_f32_32x32x16_bf16 v[208:223], a[44:47], a[32:35], v[208:223]
    ds_read_b128 a[48:51], v2 offset:8192
    ds_read_b128 a[52:55], v2 offset:12288
    s_add_u32 s28, s28, s29
    s_mul_i32 s30, s25, 557056
    s_add_u32 s30, s30, 81920
    v_mfma_f32_32x32x16_bf16 v[224:239], a[44:47], a[36:39], v[224:239]
    ds_read_b64_tr_b16 a[16:17], v9 offset:6144
    ds_read_b64_tr_b16 a[18:19], v9 offset:7680
    s_add_u32 s29, s28, 0
    s_lshr_b32 s84, s29, 1
    s_lshl_b32 s84, s84, 12
    v_mfma_f32_32x32x16_bf16 v[240:255], a[44:47], a[40:43], v[240:255]
    ds_read_b128 a[0:3], v3 offset:0
    ds_read_b128 a[4:7], v3 offset:4096
    s_and_b32 s29, s29, 1
    s_lshl_b32 s29, s29, 9
    s_add_u32 s84, s84, s29
    s_waitcnt lgkmcnt(4)
    v_mfma_f32_32x32x16_bf16 v[192:207], v[28:31], a[20:23], v[192:207]
    ds_read_b128 a[8:11], v3 offset:8192
    ds_read_b128 a[12:15], v3 offset:12288
    s_waitcnt vmcnt(19)
    s_barrier
    buffer_load_dwordx4 a[144:147], v63, s[20:23], s51 offen offset:1024 sc1
    v_mfma_f32_32x32x16_bf16 v[208:223], v[28:31], a[24:27], v[208:223]
    ds_read_b64_tr_b16 a[44:45], v9 offset:24576
    ds_read_b64_tr_b16 a[46:47], v9 offset:26112
    s_add_u32 s84, s84, s30
    s_add_u32 s29, s28, 1
    s_lshr_b32 s85, s29, 1
    v_mfma_f32_32x32x16_bf16 v[224:239], v[28:31], a[48:51], v[224:239]
    ds_read_b128 a[28:31], v4 offset:0
    ds_read_b128 a[32:35], v4 offset:4096
    s_lshl_b32 s85, s85, 12
    s_and_b32 s29, s29, 1
    s_lshl_b32 s29, s29, 9
    v_mfma_f32_32x32x16_bf16 v[240:255], v[28:31], a[52:55], v[240:255]
    ds_read_b128 a[36:39], v4 offset:8192
    ds_read_b128 a[40:43], v4 offset:12288
    s_add_u32 s85, s85, s29
    s_add_u32 s85, s85, s30
    s_add_u32 s29, s28, 2
    s_waitcnt lgkmcnt(6)
    v_mfma_f32_32x32x16_bf16 v[192:207], a[16:19], a[0:3], v[192:207]
    ds_read_b64_tr_b16 v[28:29], v9 offset:30720
    ds_read_b64_tr_b16 v[30:31], v9 offset:32256
    buffer_load_dwordx4 a[148:151], v63, s[20:23], s51 offen offset:2048 sc1
    s_lshr_b32 s86, s29, 1
    s_lshl_b32 s86, s86, 12
    v_mfma_f32_32x32x16_bf16 v[208:223], a[16:19], a[4:7], v[208:223]
    ds_read_b128 a[20:23], v5 offset:0
    ds_read_b128 a[24:27], v5 offset:4096
    s_and_b32 s29, s29, 1
    s_lshl_b32 s29, s29, 9
    s_add_u32 s86, s86, s29
    v_mfma_f32_32x32x16_bf16 v[224:239], a[16:19], a[8:11], v[224:239]
    ds_read_b128 a[48:51], v5 offset:8192
    ds_read_b128 a[52:55], v5 offset:12288
    s_add_u32 s86, s86, s30
    v_mfma_f32_32x32x16_bf16 v[240:255], a[16:19], a[12:15], v[240:255]
    s_waitcnt lgkmcnt(6)
    v_mfma_f32_32x32x16_bf16 v[192:207], a[44:47], a[28:31], v[192:207]
    ds_read_b64_tr_b16 a[16:17], v7 offset:24576
    ds_read_b64_tr_b16 a[18:19], v7 offset:26112
    buffer_load_dwordx4 a[152:155], v63, s[20:23], s51 offen offset:3072 sc1
    v_mfma_f32_32x32x16_bf16 v[208:223], a[44:47], a[32:35], v[208:223]
    ds_read_b128 a[0:3], v4 offset:32768
    ds_read_b128 a[4:7], v4 offset:36864
    v_mfma_f32_32x32x16_bf16 v[224:239], a[44:47], a[36:39], v[224:239]
    ds_read_b128 a[8:11], v4 offset:40960
    ds_read_b128 a[12:15], v4 offset:45056
    v_mfma_f32_32x32x16_bf16 v[240:255], a[44:47], a[40:43], v[240:255]
    s_waitcnt lgkmcnt(6)
    v_mfma_f32_32x32x16_bf16 v[192:207], v[28:31], a[20:23], v[192:207]
    ds_read_b64_tr_b16 a[44:45], v7 offset:30720
    ds_read_b64_tr_b16 a[46:47], v7 offset:32256
    s_cmp_ge_u32 s6, 7
    s_cselect_b32 s51, 12, 0
    s_sub_i32 s51, 5, s51
    s_mul_i32 s51, s51, 40960
    s_add_u32 s51, s51, s46
    buffer_load_dwordx4 a[156:159], v62, s[20:23], s51 offen sc1
    s_nop 0
    v_mfma_f32_32x32x16_bf16 v[208:223], v[28:31], a[24:27], v[208:223]
    ds_read_b128 a[28:31], v5 offset:32768
    ds_read_b128 a[32:35], v5 offset:36864
    s_nop 1
    v_mfma_f32_32x32x16_bf16 v[224:239], v[28:31], a[48:51], v[224:239]
    ds_read_b128 a[36:39], v5 offset:40960
    ds_read_b128 a[40:43], v5 offset:45056
    s_nop 1
    v_mfma_f32_32x32x16_bf16 v[240:255], v[28:31], a[52:55], v[240:255]
    v_max_f32 v192, 0, v192
    v_max_f32 v193, 0, v193
    v_max_f32 v194, 0, v194
    v_max_f32 v195, 0, v195
    v_max_f32 v196, 0, v196
    s_waitcnt lgkmcnt(6)
    v_mfma_f32_32x32x16_bf16 v[128:143], a[16:19], a[0:3], v[128:143]
    ds_read_b64_tr_b16 v[28:29], v10 offset:0
    ds_read_b64_tr_b16 v[30:31], v10 offset:1536
    buffer_load_dwordx4 a[160:163], v63, s[20:23], s51 offen offset:0 sc1
    v_max_f32 v197, 0, v197
    v_max_f32 v198, 0, v198
    v_mfma_f32_32x32x16_bf16 v[144:159], a[16:19], a[4:7], v[144:159]
    ds_read_b128 a[20:23], v2 offset:0
    ds_read_b128 a[24:27], v2 offset:4096
    v_max_f32 v199, 0, v199
    v_mul_f32 v192, v192, v200
    v_mul_f32 v193, v193, v201
    v_mfma_f32_32x32x16_bf16 v[160:175], a[16:19], a[8:11], v[160:175]
    ds_read_b128 a[48:51], v2 offset:8192
    ds_read_b128 a[52:55], v2 offset:12288
    v_mul_f32 v194, v194, v202
    v_mul_f32 v195, v195, v203
    v_mul_f32 v196, v196, v204
    v_mfma_f32_32x32x16_bf16 v[176:191], a[16:19], a[12:15], v[176:191]
    v_mul_f32 v197, v197, v205
    v_mul_f32 v198, v198, v206
    v_mul_f32 v199, v199, v207
    v_cvt_pk_bf16_f32 v44, v192, v193
    v_cvt_pk_bf16_f32 v45, v194, v195
    s_waitcnt lgkmcnt(6)
    v_mfma_f32_32x32x16_bf16 v[128:143], a[44:47], a[28:31], v[128:143]
    ds_read_b64_tr_b16 a[16:17], v10 offset:6144
    ds_read_b64_tr_b16 a[18:19], v10 offset:7680
    buffer_load_dwordx4 a[164:167], v63, s[20:23], s51 offen offset:1024 sc1
    v_cvt_pk_bf16_f32 v46, v196, v197
    v_cvt_pk_bf16_f32 v47, v198, v199
    v_mfma_f32_32x32x16_bf16 v[144:159], a[44:47], a[32:35], v[144:159]
    ds_read_b128 a[0:3], v3 offset:0
    ds_read_b128 a[4:7], v3 offset:4096
    buffer_store_dwordx4 v[44:47], v59, s[20:23], s84 offen offset:0 sc1
    v_max_f32 v208, 0, v208
    v_max_f32 v209, 0, v209
    v_mfma_f32_32x32x16_bf16 v[160:175], a[44:47], a[36:39], v[160:175]
    ds_read_b128 a[8:11], v3 offset:8192
    ds_read_b128 a[12:15], v3 offset:12288
    v_max_f32 v210, 0, v210
    v_max_f32 v211, 0, v211
    v_max_f32 v212, 0, v212
    v_mfma_f32_32x32x16_bf16 v[176:191], a[44:47], a[40:43], v[176:191]
    v_max_f32 v213, 0, v213
    v_max_f32 v214, 0, v214
    v_max_f32 v215, 0, v215
    v_mul_f32 v208, v208, v216
    v_mul_f32 v209, v209, v217
    s_waitcnt lgkmcnt(6)
    v_mfma_f32_32x32x16_bf16 v[128:143], v[28:31], a[20:23], v[128:143]
    ds_read_b64_tr_b16 a[44:45], v10 offset:24576
    ds_read_b64_tr_b16 a[46:47], v10 offset:26112
    buffer_load_dwordx4 a[168:171], v63, s[20:23], s51 offen offset:2048 sc1
    v_mul_f32 v210, v210, v218
    v_mul_f32 v211, v211, v219
    v_mfma_f32_32x32x16_bf16 v[144:159], v[28:31], a[24:27], v[144:159]
    ds_read_b128 a[28:31], v4 offset:0
    ds_read_b128 a[32:35], v4 offset:4096
    v_mul_f32 v212, v212, v220
    v_mul_f32 v213, v213, v221
    v_mul_f32 v214, v214, v222
    v_mfma_f32_32x32x16_bf16 v[160:175], v[28:31], a[48:51], v[160:175]
    ds_read_b128 a[36:39], v4 offset:8192
    ds_read_b128 a[40:43], v4 offset:12288
    v_mul_f32 v215, v215, v223
    v_cvt_pk_bf16_f32 v48, v208, v209
    v_cvt_pk_bf16_f32 v49, v210, v211
    v_mfma_f32_32x32x16_bf16 v[176:191], v[28:31], a[52:55], v[176:191]
    v_cvt_pk_bf16_f32 v50, v212, v213
    v_cvt_pk_bf16_f32 v51, v214, v215
    buffer_store_dwordx4 v[48:51], v59, s[20:23], s84 offen offset:2048 sc1
    v_max_f32 v224, 0, v224
    v_max_f32 v225, 0, v225
    s_waitcnt lgkmcnt(6)
    v_mfma_f32_32x32x16_bf16 v[128:143], a[16:19], a[0:3], v[128:143]
    ds_read_b64_tr_b16 v[28:29], v10 offset:30720
    ds_read_b64_tr_b16 v[30:31], v10 offset:32256
    buffer_load_dwordx4 a[172:175], v63, s[20:23], s51 offen offset:3072 sc1
    v_max_f32 v226, 0, v226
    v_max_f32 v227, 0, v227
    v_mfma_f32_32x32x16_bf16 v[144:159], a[16:19], a[4:7], v[144:159]
    ds_read_b128 a[20:23], v5 offset:0
    ds_read_b128 a[24:27], v5 offset:4096
    v_max_f32 v228, 0, v228
    v_max_f32 v229, 0, v229
    v_max_f32 v230, 0, v230
    v_mfma_f32_32x32x16_bf16 v[160:175], a[16:19], a[8:11], v[160:175]
    ds_read_b128 a[48:51], v5 offset:8192
    ds_read_b128 a[52:55], v5 offset:12288
    v_max_f32 v231, 0, v231
    v_mul_f32 v224, v224, v232
    v_mul_f32 v225, v225, v233
    v_mfma_f32_32x32x16_bf16 v[176:191], a[16:19], a[12:15], v[176:191]
    v_mul_f32 v226, v226, v234
    v_mul_f32 v227, v227, v235
    v_mul_f32 v228, v228, v236
    v_mul_f32 v229, v229, v237
    v_mul_f32 v230, v230, v238
    s_waitcnt lgkmcnt(6)
    v_mfma_f32_32x32x16_bf16 v[128:143], a[44:47], a[28:31], v[128:143]
    ds_read_b64_tr_b16 a[16:17], v8 offset:24576
    ds_read_b64_tr_b16 a[18:19], v8 offset:26112
    s_cmp_ge_u32 s6, 6
    s_cselect_b32 s51, 12, 0
    s_sub_i32 s51, 6, s51
    s_mul_i32 s51, s51, 40960
    s_add_u32 s51, s51, s46
    buffer_load_dwordx4 a[176:179], v62, s[20:23], s51 offen sc1
    v_mul_f32 v231, v231, v239
    v_cvt_pk_bf16_f32 v52, v224, v225
    v_mfma_f32_32x32x16_bf16 v[144:159], a[44:47], a[32:35], v[144:159]
    ds_read_b128 a[0:3], v4 offset:32768
    ds_read_b128 a[4:7], v4 offset:36864
    v_cvt_pk_bf16_f32 v53, v226, v227
    v_cvt_pk_bf16_f32 v54, v228, v229
    v_cvt_pk_bf16_f32 v55, v230, v231
    v_mfma_f32_32x32x16_bf16 v[160:175], a[44:47], a[36:39], v[160:175]
    ds_read_b128 a[8:11], v4 offset:40960
    ds_read_b128 a[12:15], v4 offset:45056
    buffer_store_dwordx4 v[52:55], v60, s[20:23], s84 offen offset:0 sc1
    v_max_f32 v240, 0, v240
    v_max_f32 v241, 0, v241
    v_mfma_f32_32x32x16_bf16 v[176:191], a[44:47], a[40:43], v[176:191]
    v_max_f32 v242, 0, v242
    v_max_f32 v243, 0, v243
    v_max_f32 v244, 0, v244
    v_max_f32 v245, 0, v245
    v_max_f32 v246, 0, v246
    s_waitcnt lgkmcnt(6)
    v_mfma_f32_32x32x16_bf16 v[128:143], v[28:31], a[20:23], v[128:143]
    ds_read_b64_tr_b16 a[44:45], v8 offset:30720
    ds_read_b64_tr_b16 a[46:47], v8 offset:32256
    buffer_load_dwordx4 a[180:183], v63, s[20:23], s51 offen offset:0 sc1
    v_max_f32 v247, 0, v247
    v_mul_f32 v240, v240, v248
    v_mfma_f32_32x32x16_bf16 v[144:159], v[28:31], a[24:27], v[144:159]
    ds_read_b128 a[28:31], v5 offset:32768
    ds_read_b128 a[32:35], v5 offset:36864
    v_mul_f32 v241, v241, v249
    v_mul_f32 v242, v242, v250
    v_mul_f32 v243, v243, v251
    v_mfma_f32_32x32x16_bf16 v[160:175], v[28:31], a[48:51], v[160:175]
    ds_read_b128 a[36:39], v5 offset:40960
    ds_read_b128 a[40:43], v5 offset:45056
    v_mul_f32 v244, v244, v252
    v_mul_f32 v245, v245, v253
    v_mul_f32 v246, v246, v254
    v_mfma_f32_32x32x16_bf16 v[176:191], v[28:31], a[52:55], v[176:191]
    v_mul_f32 v247, v247, v255
    v_cvt_pk_bf16_f32 v44, v240, v241
    v_cvt_pk_bf16_f32 v45, v242, v243
    v_cvt_pk_bf16_f32 v46, v244, v245
    v_cvt_pk_bf16_f32 v47, v246, v247
    s_waitcnt lgkmcnt(6)
    v_mfma_f32_32x32x16_bf16 v[64:79], a[16:19], a[0:3], v[64:79]
    ds_read_b64_tr_b16 v[28:29], v11 offset:0
    ds_read_b64_tr_b16 v[30:31], v11 offset:1536
    buffer_load_dwordx4 a[184:187], v63, s[20:23], s51 offen offset:1024 sc1
    buffer_store_dwordx4 v[44:47], v60, s[20:23], s84 offen offset:2048 sc1
    v_max_f32 v128, 0, v128
    v_mfma_f32_32x32x16_bf16 v[80:95], a[16:19], a[4:7], v[80:95]
    ds_read_b128 a[20:23], v2 offset:0
    ds_read_b128 a[24:27], v2 offset:4096
    v_max_f32 v129, 0, v129
    v_max_f32 v130, 0, v130
    v_max_f32 v131, 0, v131
    v_mfma_f32_32x32x16_bf16 v[96:111], a[16:19], a[8:11], v[96:111]
    ds_read_b128 a[48:51], v2 offset:8192
    ds_read_b128 a[52:55], v2 offset:12288
    v_max_f32 v132, 0, v132
    v_max_f32 v133, 0, v133
    v_max_f32 v134, 0, v134
    v_mfma_f32_32x32x16_bf16 v[112:127], a[16:19], a[12:15], v[112:127]
    v_max_f32 v135, 0, v135
    v_mul_f32 v128, v128, v136
    v_mul_f32 v129, v129, v137
    v_mul_f32 v130, v130, v138
    v_mul_f32 v131, v131, v139
    s_waitcnt lgkmcnt(6)
    v_mfma_f32_32x32x16_bf16 v[64:79], a[44:47], a[28:31], v[64:79]
    ds_read_b64_tr_b16 a[16:17], v11 offset:6144
    ds_read_b64_tr_b16 a[18:19], v11 offset:7680
    buffer_load_dwordx4 a[188:191], v63, s[20:23], s51 offen offset:2048 sc1
    v_mul_f32 v132, v132, v140
    v_mul_f32 v133, v133, v141
    v_mfma_f32_32x32x16_bf16 v[80:95], a[44:47], a[32:35], v[80:95]
    ds_read_b128 a[0:3], v3 offset:0
    ds_read_b128 a[4:7], v3 offset:4096
    v_mul_f32 v134, v134, v142
    v_mul_f32 v135, v135, v143
    v_cvt_pk_bf16_f32 v48, v128, v129
    v_mfma_f32_32x32x16_bf16 v[96:111], a[44:47], a[36:39], v[96:111]
    ds_read_b128 a[8:11], v3 offset:8192
    ds_read_b128 a[12:15], v3 offset:12288
    v_cvt_pk_bf16_f32 v49, v130, v131
    v_cvt_pk_bf16_f32 v50, v132, v133
    v_cvt_pk_bf16_f32 v51, v134, v135
    v_mfma_f32_32x32x16_bf16 v[112:127], a[44:47], a[40:43], v[112:127]
    buffer_store_dwordx4 v[48:51], v59, s[20:23], s85 offen offset:0 sc1
    v_max_f32 v144, 0, v144
    v_max_f32 v145, 0, v145
    v_max_f32 v146, 0, v146
    v_max_f32 v147, 0, v147
    s_waitcnt lgkmcnt(6)
    v_mfma_f32_32x32x16_bf16 v[64:79], v[28:31], a[20:23], v[64:79]
    ds_read_b64_tr_b16 a[44:45], v11 offset:24576
    ds_read_b64_tr_b16 a[46:47], v11 offset:26112
    buffer_load_dwordx4 a[192:195], v63, s[20:23], s51 offen offset:3072 sc1
    v_max_f32 v148, 0, v148
    v_max_f32 v149, 0, v149
    v_mfma_f32_32x32x16_bf16 v[80:95], v[28:31], a[24:27], v[80:95]
    ds_read_b128 a[28:31], v4 offset:0
    ds_read_b128 a[32:35], v4 offset:4096
    v_max_f32 v150, 0, v150
    v_max_f32 v151, 0, v151
    v_mul_f32 v144, v144, v152
    v_mfma_f32_32x32x16_bf16 v[96:111], v[28:31], a[48:51], v[96:111]
    ds_read_b128 a[36:39], v4 offset:8192
    ds_read_b128 a[40:43], v4 offset:12288
    v_mul_f32 v145, v145, v153
    v_mul_f32 v146, v146, v154
    v_mul_f32 v147, v147, v155
    v_mfma_f32_32x32x16_bf16 v[112:127], v[28:31], a[52:55], v[112:127]
    v_mul_f32 v148, v148, v156
    v_mul_f32 v149, v149, v157
    v_mul_f32 v150, v150, v158
    v_mul_f32 v151, v151, v159
    v_cvt_pk_bf16_f32 v52, v144, v145
    s_waitcnt lgkmcnt(6)
    v_mfma_f32_32x32x16_bf16 v[64:79], a[16:19], a[0:3], v[64:79]
    ds_read_b64_tr_b16 v[28:29], v11 offset:30720
    ds_read_b64_tr_b16 v[30:31], v11 offset:32256
    s_cmp_ge_u32 s6, 5
    s_cselect_b32 s51, 12, 0
    s_sub_i32 s51, 7, s51
    s_mul_i32 s51, s51, 40960
    s_add_u32 s51, s51, s46
    buffer_load_dwordx4 a[196:199], v62, s[20:23], s51 offen sc1
    v_cvt_pk_bf16_f32 v53, v146, v147
    v_cvt_pk_bf16_f32 v54, v148, v149
    v_mfma_f32_32x32x16_bf16 v[80:95], a[16:19], a[4:7], v[80:95]
    ds_read_b128 a[20:23], v5 offset:0
    ds_read_b128 a[24:27], v5 offset:4096
    v_cvt_pk_bf16_f32 v55, v150, v151
    buffer_store_dwordx4 v[52:55], v59, s[20:23], s85 offen offset:2048 sc1
    v_max_f32 v160, 0, v160
    v_mfma_f32_32x32x16_bf16 v[96:111], a[16:19], a[8:11], v[96:111]
    ds_read_b128 a[48:51], v5 offset:8192
    ds_read_b128 a[52:55], v5 offset:12288
    v_max_f32 v161, 0, v161
    v_max_f32 v162, 0, v162
    v_max_f32 v163, 0, v163
    v_mfma_f32_32x32x16_bf16 v[112:127], a[16:19], a[12:15], v[112:127]
    v_max_f32 v164, 0, v164
    v_max_f32 v165, 0, v165
    v_max_f32 v166, 0, v166
    v_max_f32 v167, 0, v167
    v_mul_f32 v160, v160, v168
    s_waitcnt lgkmcnt(6)
    v_mfma_f32_32x32x16_bf16 v[64:79], a[44:47], a[28:31], v[64:79]
    buffer_load_dwordx4 a[200:203], v63, s[20:23], s51 offen offset:0 sc1
    v_mul_f32 v161, v161, v169
    v_mul_f32 v162, v162, v170
    v_mul_f32 v163, v163, v171
    v_mul_f32 v164, v164, v172
    s_waitcnt lgkmcnt(0)
    v_mfma_f32_32x32x16_bf16 v[64:79], v[28:31], a[20:23], v[64:79]
    v_mul_f32 v165, v165, v173
    v_mul_f32 v166, v166, v174
    v_mul_f32 v167, v167, v175
    v_cvt_pk_bf16_f32 v44, v160, v161
    v_cvt_pk_bf16_f32 v45, v162, v163
    v_mfma_f32_32x32x16_bf16 v[80:95], a[44:47], a[32:35], v[80:95]
    v_cvt_pk_bf16_f32 v46, v164, v165
    v_cvt_pk_bf16_f32 v47, v166, v167
    buffer_store_dwordx4 v[44:47], v60, s[20:23], s85 offen offset:0 sc1
    v_max_f32 v176, 0, v176
    v_max_f32 v177, 0, v177
    v_mfma_f32_32x32x16_bf16 v[80:95], v[28:31], a[24:27], v[80:95]
    v_max_f32 v178, 0, v178
    v_max_f32 v179, 0, v179
    v_max_f32 v180, 0, v180
    v_max_f32 v181, 0, v181
    v_max_f32 v182, 0, v182
    v_mfma_f32_32x32x16_bf16 v[96:111], a[44:47], a[36:39], v[96:111]
    buffer_load_dwordx4 a[204:207], v63, s[20:23], s51 offen offset:1024 sc1
    v_max_f32 v183, 0, v183
    v_mul_f32 v176, v176, v184
    v_mul_f32 v177, v177, v185
    v_mul_f32 v178, v178, v186
    v_mfma_f32_32x32x16_bf16 v[96:111], v[28:31], a[48:51], v[96:111]
    v_mul_f32 v179, v179, v187
    v_mul_f32 v180, v180, v188
    v_mul_f32 v181, v181, v189
    v_mul_f32 v182, v182, v190
    v_mul_f32 v183, v183, v191
    v_mfma_f32_32x32x16_bf16 v[112:127], a[44:47], a[40:43], v[112:127]
    v_cvt_pk_bf16_f32 v48, v176, v177
    v_cvt_pk_bf16_f32 v49, v178, v179
    v_cvt_pk_bf16_f32 v50, v180, v181
    v_cvt_pk_bf16_f32 v51, v182, v183
    buffer_store_dwordx4 v[48:51], v60, s[20:23], s85 offen offset:2048 sc1
    v_mfma_f32_32x32x16_bf16 v[112:127], v[28:31], a[52:55], v[112:127]
    v_max_f32 v64, 0, v64
    v_max_f32 v65, 0, v65
    v_max_f32 v66, 0, v66
    v_max_f32 v67, 0, v67
    v_max_f32 v68, 0, v68
    v_max_f32 v69, 0, v69
    v_max_f32 v70, 0, v70
    v_max_f32 v71, 0, v71
    v_mul_f32 v64, v64, v72
    v_mul_f32 v65, v65, v73
    v_mul_f32 v66, v66, v74
    v_mul_f32 v67, v67, v75
    v_pk_mul_f32 v[68:69], v[68:69], v[76:77]
    v_pk_mul_f32 v[70:71], v[70:71], v[78:79]
    v_cvt_pk_bf16_f32 v52, v64, v65
    v_cvt_pk_bf16_f32 v53, v66, v67
    v_cvt_pk_bf16_f32 v54, v68, v69
    v_cvt_pk_bf16_f32 v55, v70, v71
    buffer_store_dwordx4 v[52:55], v59, s[20:23], s86 offen offset:0 sc1
    v_max_f32 v80, 0, v80
    v_max_f32 v81, 0, v81
    v_max_f32 v82, 0, v82
    v_max_f32 v83, 0, v83
    v_max_f32 v84, 0, v84
    v_max_f32 v85, 0, v85
    v_max_f32 v86, 0, v86
    v_max_f32 v87, 0, v87
    v_pk_mul_f32 v[80:81], v[80:81], v[88:89]
    v_pk_mul_f32 v[82:83], v[82:83], v[90:91]
    v_pk_mul_f32 v[84:85], v[84:85], v[92:93]
    v_pk_mul_f32 v[86:87], v[86:87], v[94:95]
    v_cvt_pk_bf16_f32 v44, v80, v81
    v_cvt_pk_bf16_f32 v45, v82, v83
    v_cvt_pk_bf16_f32 v46, v84, v85
    v_cvt_pk_bf16_f32 v47, v86, v87
    buffer_store_dwordx4 v[44:47], v59, s[20:23], s86 offen offset:2048 sc1
    v_max_f32 v96, 0, v96
    v_max_f32 v97, 0, v97
    v_max_f32 v98, 0, v98
    v_max_f32 v99, 0, v99
    v_max_f32 v100, 0, v100
    v_max_f32 v101, 0, v101
    v_max_f32 v102, 0, v102
    v_max_f32 v103, 0, v103
    v_pk_mul_f32 v[96:97], v[96:97], v[104:105]
    v_pk_mul_f32 v[98:99], v[98:99], v[106:107]
    v_pk_mul_f32 v[100:101], v[100:101], v[108:109]
    v_pk_mul_f32 v[102:103], v[102:103], v[110:111]
    v_cvt_pk_bf16_f32 v48, v96, v97
    v_cvt_pk_bf16_f32 v49, v98, v99
    v_cvt_pk_bf16_f32 v50, v100, v101
    v_cvt_pk_bf16_f32 v51, v102, v103
    buffer_store_dwordx4 v[48:51], v60, s[20:23], s86 offen offset:0 sc1
    v_max_f32 v112, 0, v112
    v_max_f32 v113, 0, v113
    v_max_f32 v114, 0, v114
    v_max_f32 v115, 0, v115
    v_max_f32 v116, 0, v116
    v_max_f32 v117, 0, v117
    v_max_f32 v118, 0, v118
    v_max_f32 v119, 0, v119
    v_pk_mul_f32 v[112:113], v[112:113], v[120:121]
    v_pk_mul_f32 v[114:115], v[114:115], v[122:123]
    v_pk_mul_f32 v[116:117], v[116:117], v[124:125]
    v_pk_mul_f32 v[118:119], v[118:119], v[126:127]
    v_cvt_pk_bf16_f32 v52, v112, v113
    v_cvt_pk_bf16_f32 v53, v114, v115
    v_cvt_pk_bf16_f32 v54, v116, v117
    v_cvt_pk_bf16_f32 v55, v118, v119
    buffer_store_dwordx4 v[52:55], v60, s[20:23], s86 offen offset:2048 sc1
    buffer_load_dwordx4 a[208:211], v63, s[20:23], s51 offen offset:2048 sc1
    buffer_load_dwordx4 a[212:215], v63, s[20:23], s51 offen offset:3072 sc1
    s_cmp_ge_u32 s7, 5
    s_cselect_b32 s51, 5, 0
    s_sub_i32 s51, 0, s51
    s_mul_i32 s51, s51, 40960
    s_add_u32 s51, s51, s50
    buffer_load_dwordx4 a[216:219], v62, s[20:23], s51 offen sc1
    buffer_load_dwordx4 a[220:223], v63, s[20:23], s51 offen offset:0 sc1
    buffer_load_dwordx4 a[224:227], v63, s[20:23], s51 offen offset:1024 sc1
    buffer_load_dwordx4 a[228:231], v63, s[20:23], s51 offen offset:2048 sc1
    buffer_load_dwordx4 a[232:235], v63, s[20:23], s51 offen offset:3072 sc1
    v_cmp_gt_u32 vcc, 64, v0
    v_mov_b32 v12, 2146435072
    v_lshrrev_b32 v13, 2, v0
    v_lshlrev_b32 v13, 11, v13
    v_and_b32 v6, 3, v0
    v_lshl_add_u32 v13, v6, 4, v13
    v_cndmask_b32 v12, v12, v13, vcc
    v_mov_b32 v244, s52
    v_mov_b32 v245, s52
    v_mov_b32 v246, s52
    v_mov_b32 v247, s52
    v_and_b32 v9, 1, v1
    v_bfe_u32 v6, v1, 3, 1
    v_lshl_add_u32 v9, v6, 1, v9
    v_bfe_u32 v6, v1, 1, 2
    v_lshl_add_u32 v9, v6, 2, v9
    v_mul_u32_u24 v5, 1280, v9
    v_lshrrev_b32 v6, 4, v1
    v_lshl_add_u32 v5, v6, 3, v5
    v_lshlrev_b32 v9, 4, v9
    v_cmp_gt_u32 vcc, 2, v1
    v_lshlrev_b32 v4, 7, v1
    v_mov_b32 v7, 2146435072
    v_cndmask_b32 v4, v7, v4, vcc
    v_mov_b32 v13, s52
    v_add_u32 v8, s4, v62
    v_add_u32 v2, s5, v62
    v_add_u32 v3, s54, v62
    v_add_u32 v6, s82, v62
    s_mov_b32 s30, 0xbfb8aa3b
    v_add_u32 v10, s60, v62
    v_add_u32 v11, s61, v62
    v_add_u32 v14, s62, v62
    v_add_u32 v15, s63, v62
    s_waitcnt vmcnt(7)
    s_barrier
    buffer_store_dwordx4 v[244:247], v12, s[20:23], s53 offen sc0 sc1
    v_mov_b32 v12, 2146435072
    s_cmp_ge_u32 s7, 4
    s_cselect_b32 s51, 5, 0
    s_sub_i32 s51, 1, s51
    s_mul_i32 s51, s51, 40960
    s_add_u32 s51, s51, s50
    buffer_load_dwordx4 a[236:239], v62, s[20:23], s51 offen sc1
    buffer_load_dwordx4 a[240:243], v63, s[20:23], s51 offen offset:0 sc1
    buffer_load_dwordx4 a[244:247], v63, s[20:23], s51 offen offset:1024 sc1
    buffer_load_dwordx4 a[248:251], v63, s[20:23], s51 offen offset:2048 sc1
    buffer_load_dwordx4 a[252:255], v63, s[20:23], s51 offen offset:3072 sc1
    s_cmp_ge_u32 s6, 2
    s_cselect_b32 s51, 12, 0
    s_sub_i32 s51, 10, s51
    s_mul_i32 s51, s51, 40960
    s_add_u32 s51, s51, s46
    buffer_load_dwordx4 v[200:203], v62, s[20:23], s51 offen sc1
    buffer_load_dwordx4 v[204:207], v63, s[20:23], s51 offen offset:0 sc1
    buffer_load_dwordx4 v[208:211], v63, s[20:23], s51 offen offset:1024 sc1
    buffer_load_dwordx4 v[212:215], v63, s[20:23], s51 offen offset:2048 sc1
    buffer_load_dwordx4 v[216:219], v63, s[20:23], s51 offen offset:3072 sc1
    s_cmp_ge_u32 s6, 1
    s_cselect_b32 s51, 12, 0
    s_sub_i32 s51, 11, s51
    s_mul_i32 s51, s51, 40960
    s_add_u32 s51, s51, s46
    buffer_load_dwordx4 v[220:223], v62, s[20:23], s51 offen sc1
    buffer_load_dwordx4 v[224:227], v63, s[20:23], s51 offen offset:0 sc1
    buffer_load_dwordx4 v[228:231], v63, s[20:23], s51 offen offset:1024 sc1
    buffer_load_dwordx4 v[232:235], v63, s[20:23], s51 offen offset:2048 sc1
    buffer_load_dwordx4 v[236:239], v63, s[20:23], s51 offen offset:3072 sc1
    s_cmp_ge_u32 s6, 4
    s_cselect_b32 s51, 12, 0
    s_sub_i32 s51, 8, s51
    s_mul_i32 s51, s51, 40960
    s_add_u32 s51, s51, s46
    buffer_load_dwordx4 v[160:163], v62, s[20:23], s51 offen sc1
    buffer_load_dwordx4 v[164:167], v63, s[20:23], s51 offen offset:0 sc1
    buffer_load_dwordx4 v[168:171], v63, s[20:23], s51 offen offset:1024 sc1
    buffer_load_dwordx4 v[172:175], v63, s[20:23], s51 offen offset:2048 sc1
    buffer_load_dwordx4 v[176:179], v63, s[20:23], s51 offen offset:3072 sc1
    s_cmp_ge_u32 s6, 3
    s_cselect_b32 s51, 12, 0
    s_sub_i32 s51, 9, s51
    s_mul_i32 s51, s51, 40960
    s_add_u32 s51, s51, s46
    buffer_load_dwordx4 v[180:183], v62, s[20:23], s51 offen sc1
    buffer_load_dwordx4 v[184:187], v63, s[20:23], s51 offen offset:0 sc1
    buffer_load_dwordx4 v[188:191], v63, s[20:23], s51 offen offset:1024 sc1
    buffer_load_dwordx4 v[192:195], v63, s[20:23], s51 offen offset:2048 sc1
    buffer_load_dwordx4 v[196:199], v63, s[20:23], s51 offen offset:3072 sc1
    buffer_load_dword v7, v4, s[20:23], s41 offen offset:1024 sc1 nt
    s_waitcnt vmcnt(0)
    v_cmp_ne_u32 vcc, s52, v7
    s_and_b32 vcc_lo, vcc_lo, 3
    s_cbranch_scc1 L_pollh
    s_branch L_pollh_go
LF_slow:
    s_mov_b32 s49, 100000
LF_spin:
    s_sleep 4
    buffer_load_dword v48, v52, s[20:23], s82 offen sc1 nt
    s_waitcnt vmcnt(0)
    v_cmp_ne_u32 vcc, s52, v48
    s_and_b64 vcc, vcc, s[4:5]
    s_cbranch_scc0 LF_ok
    s_sub_u32 s49, s49, 1
    s_cmp_gt_i32 s49, 0
    s_cbranch_scc1 LF_spin
    s_branch LF_ok
LF_sloww:
    s_mov_b32 s49, 100000
LF_spinw:
    s_sleep 4
    buffer_load_dword v60, v23, s[20:23], s3 offen sc1 nt
    s_waitcnt vmcnt(0)
    v_cmp_ne_u32 vcc, s52, v60
    s_and_b32 vcc_lo, vcc_lo, 0x0fff0fff
    s_cbranch_scc0 LF_okw
    s_sub_u32 s49, s49, 1
    s_cmp_gt_i32 s49, 0
    s_cbranch_scc1 LF_spinw
    s_branch LF_okw

L_A:
    s_getpc_b64 s[4:5]
L_pcA:
    s_sub_u32 s4, s4, (L_pcA-L_start)
    s_subb_u32 s5, s5, 0
    s_lshr_b32 s29, s2, 3
    s_and_b32 s28, s29, 3
    s_lshl_b32 s28, s28, 14
    v_lshlrev_b32 v2, 6, v0
    v_add_u32 v2, s28, v2
    v_min_u32 v2, (L_end-L_start-4), v2

    global_load_dword v61, v2, s[4:5]
    v_lshrrev_b32 v2, 6, v0
    v_and_b32 v1, 63, v0
    s_and_b32 s28, s2, 7
    v_readfirstlane_b32 s24, v2
    s_and_b32 s31, s28, 1
    s_lshl_b32 s25, s31, 3
    s_and_b32 s30, s29, 7
    s_add_u32 s25, s25, s30
    s_bfe_u32 s27, s2, 0x10006
    s_and_b32 s26, s28, 6
    s_add_u32 s26, s26, s27
    s_mul_i32 s27, s31, 5
    s_add_u32 s27, s27, s30
    s_cmp_lt_u32 s30, 5
    s_cselect_b32 s27, s27, 0

    v_lshrrev_b32 v28, 3, v1
    s_lshl_b32 s28, s24, 5
    v_add_u32 v29, s28, v28
    v_mul_u32_u24 v29, 1280, v29
    v_lshrrev_b32 v30, 4, v1
    v_and_b32 v31, 7, v1
    v_xor_b32 v31, v31, v30
    v_lshl_add_u32 v12, v31, 4, v29
    v_xor_b32 v32, 4, v31
    v_lshl_add_u32 v13, v32, 4, v29
    v_add_u32 v13, 9216, v13
    v_add_u32 v14, 18432, v12
    v_add_u32 v15, 18432, v13
    s_mul_i32 s32, s25, 163840
    s_lshl_b32 s36, s24, 12
    s_lshl_b32 s28, s24, 3

    s_add_u32 s36, s36, 4096
    s_lshl_b32 s37, s24, 10
    s_sub_u32 s33, s32, 40960
    s_max_i32 s33, s33, 0
    v_add_u32 v29, s28, v28
    v_mul_u32_u24 v29, 1280, v29
    s_bitcmp1_b32 s24, 0
    s_cselect_b32 s29, 4, 0
    v_xor_b32 v32, s29, v31
    v_lshl_add_u32 v29, v32, 4, v29
    s_mov_b32 s29, 2146435072
    s_cmp_lt_u32 s24, 2
    s_cselect_b32 s30, s29, 0
    s_cmp_eq_u32 s25, 0
    s_cselect_b32 s30, s29, s30
    v_add_u32 v16, s30, v29
    v_lshrrev_b32 v28, 5, v1
    v_mov_b32 v34, 2146435072

    v_and_b32 v31, 31, v1
    s_mov_b32 s29, 43620
    s_mul_i32 s30, s28, 3840
    s_sub_u32 s30, s30, 320
    v_add_u32 v29, 0, v28
    v_lshlrev_b32 v30, 2, v29
    v_xor_b32 v30, v30, v31
    v_mul_u32_u24 v32, 26, v30
    v_cmp_le_u32 vcc, 30, v30
    v_lshrrev_b32 v32, 5, v32
    v_and_b32 v32, 24, v32
    v_bfe_u32 v32, s29, v32, 8
    v_add_lshl_u32 v32, v32, v30, 4
    v_mul_u32_u24 v29, 3840, v29
    v_add3_u32 v32, v32, v29, s30

    v_cndmask_b32 v17, v32, v34, vcc
    v_add_u32 v19, 13312, v17

    v_add_u32 v29, 2, v28
    v_lshlrev_b32 v30, 2, v29
    v_xor_b32 v30, v30, v31
    v_mul_u32_u24 v32, 26, v30
    v_cmp_le_u32 vcc, 30, v30
    v_lshrrev_b32 v32, 5, v32
    v_and_b32 v32, 24, v32
    v_bfe_u32 v32, s29, v32, 8
    v_add_lshl_u32 v32, v32, v30, 4
    v_mul_u32_u24 v29, 3840, v29
    v_add3_u32 v32, v32, v29, s30
    v_subrev_u32 v32, 1024, v32
    v_cndmask_b32 v18, v32, v34, vcc
    v_add_u32 v20, 13312, v18

    s_lshl_b32 s35, s24, 12
    s_add_u32 s35, s35, 61440
    s_mul_i32 s34, s26, 160
    s_waitcnt lgkmcnt(0)
    s_mov_b32 s8, s64
    s_and_b32 s9, s65, 0xffff
    s_mov_b32 s10, 2621440
    s_mov_b32 s11, 0x00020000
    s_mov_b32 s38, s27
    s_lshl_b32 s38, s38, 7
    s_add_u32 s39, s38, s33
    s_add_u32 m0, s36, 0
    s_add_u32 s38, s38, s32
    buffer_load_dwordx4 v12, s[8:11], s38 offen offset:0 lds
    buffer_load_dwordx4 v13, s[8:11], s38 offen offset:1024 lds
    buffer_load_dwordx4 v14, s[8:11], s38 offen offset:2048 lds
    buffer_load_dwordx4 v15, s[8:11], s38 offen offset:3072 lds
    s_add_u32 m0, s37, 0
    s_nop 0
    buffer_load_dwordx4 v16, s[8:11], s39 offen lds
    s_mov_b32 s12, s66
    s_and_b32 s13, s67, 0xffff
    s_mov_b32 s14, 2457600
    s_mov_b32 s15, 0x00020000
    s_mov_b32 s40, s27
    s_mul_i32 s40, s40, 245760
    s_add_u32 m0, s35, 0
    s_add_u32 s40, s40, s34
    buffer_load_dwordx4 v17, s[12:15], s40 offen offset:0 lds
    buffer_load_dwordx4 v18, s[12:15], s40 offen offset:1024 lds
    buffer_load_dwordx4 v19, s[12:15], s40 offen offset:2048 lds
    buffer_load_dwordx4 v20, s[12:15], s40 offen offset:3072 lds
    v_and_b32 v28, 31, v1
    v_lshrrev_b32 v29, 5, v1
    v_bfe_u32 v30, v1, 1, 3
    v_xor_b32 v30, v30, v29
    v_lshlrev_b32 v28, 7, v28

    v_xor_b32 v31, 0, v30
    v_lshl_add_u32 v2, v31, 4, v28
    v_xor_b32 v31, 2, v30
    v_lshl_add_u32 v3, v31, 4, v28
    v_xor_b32 v31, 4, v30
    v_lshl_add_u32 v4, v31, 4, v28
    v_xor_b32 v31, 6, v30
    v_lshl_add_u32 v5, v31, 4, v28
    v_bfe_u32 v30, v1, 2, 2
    v_lshl_add_u32 v29, v29, 3, v30
    v_lshlrev_b32 v29, 9, v29
    v_add_u32 v29, 61440, v29
    v_lshlrev_b32 v30, 6, v30
    s_mul_i32 s28, s24, 5
    v_and_b32 v31, 3, v1
    v_lshlrev_b32 v31, 3, v31
    s_mov_b32 vcc_lo, 0xffff0000
    s_mov_b32 vcc_hi, 0xffff0000

    s_mov_b32 s29, 370480132
    s_bitcmp1_b32 s24, 0
    s_cselect_b32 s29, 387323140, s29
    v_mov_b32 v28, 50462976
    v_mov_b32 v32, s29
    v_cndmask_b32 v28, v28, v32, vcc
    v_bfe_u32 v28, v28, v31, 8
    v_add_lshl_u32 v28, v28, s28, 3
    v_xor_b32 v28, v28, v30
    v_add_u32 v6, v28, v29
    v_add_u32 v8, 32768, v6

    s_mov_b32 s29, 690493463
    s_bitcmp1_b32 s24, 0
    s_cselect_b32 s29, 690492440, s29
    v_mov_b32 v28, 741092138
    v_mov_b32 v32, s29
    v_cndmask_b32 v28, v32, v28, vcc
    v_bfe_u32 v28, v28, v31, 8
    v_add_lshl_u32 v28, v28, s28, 3
    v_xor_b32 v28, v28, v30
    v_add_u32 v7, v28, v29
    v_add_u32 v9, 32768, v7

    v_mov_b32 v24, 0x3f803f80
    v_mov_b32 v25, 0x3f803f80
    v_mov_b32 v26, 0x3f803f80
    v_mov_b32 v27, 0x3f803f80
    s_add_u32 m0, s35, 16384
    s_add_u32 s40, s40, 122880
    buffer_load_dwordx4 v17, s[12:15], s40 offen offset:0 lds
    buffer_load_dwordx4 v18, s[12:15], s40 offen offset:1024 lds
    buffer_load_dwordx4 v19, s[12:15], s40 offen offset:2048 lds
    buffer_load_dwordx4 v20, s[12:15], s40 offen offset:3072 lds
    s_mov_b32 s20, s82
    s_and_b32 s21, s83, 0xffff
    s_mov_b32 s22, 12632192
    s_mov_b32 s23, 0x00020000
    s_mov_b32 s56, s78
    s_and_b32 s57, s79, 0xffff
    s_mov_b32 s58, 2621440
    s_mov_b32 s59, 0x00020000
    s_mov_b32 s45, 0xffff0000
    v_lshlrev_b32 v62, 4, v1
    v_add_u32 v63, 1024, v62
    v_lshrrev_b32 v28, 5, v1
    v_mul_u32_u24 v28, 1280, v28
    v_and_b32 v29, 31, v1
    v_lshl_add_u32 v28, v29, 4, v28
    v_cmp_gt_u32 vcc, 16, v29
    v_mov_b32 v31, 2146435072
    v_mov_b32 v32, 0
    v_cndmask_b32 v30, v31, v28, vcc
    s_lshl_b32 s83, s25, 4
    s_add_u32 s83, s83, s26
    s_add_u32 s83, s83, 0
    s_lshl_b32 s28, s83, 2
    s_add_u32 s28, s28, s24
    s_mul_i32 s29, s28, 2560
    s_mov_b32 s30, 12632064
    buffer_load_dword v35, v32, s[20:23], s30 offen sc1
    s_sub_u32 s49, s2, 0
    s_mul_i32 s17, s49, 205
    s_lshr_b32 s17, s17, 11
    s_mul_i32 s16, s17, 10
    s_sub_u32 s16, s49, s16
    s_mul_i32 s87, s24, 12
    s_add_u32 s87, s87, s17
    s_lshl_b32 s49, s16, 7
    s_add_u32 s88, s87, 28
    s_mul_i32 s88, s88, 40960
    s_add_u32 s88, s88, s49
    s_cmp_lt_u32 s87, 20
    s_cselect_b32 s89, 0, 20
    s_cselect_b64 vcc, -1, 0
    s_sub_u32 s89, s87, s89
    s_mul_i32 s89, s89, 40960
    s_add_u32 s89, s89, s49
    s_mul_i32 s84, s87, 40960
    s_lshl_b32 s49, s16, 12
    s_add_u32 s84, s84, s49
    s_add_u32 s84, s84, 8912896
    s_add_u32 s86, s84, 1966080
    v_lshrrev_b32 v48, 3, v1
    v_mul_u32_u24 v48, 1280, v48
    v_and_b32 v49, 7, v1
    v_lshl_add_u32 v64, v49, 4, v48
    v_lshrrev_b32 v48, 4, v1
    v_bfe_u32 v49, v1, 2, 2
    v_lshl_add_u32 v50, v48, 3, v49
    v_lshrrev_b32 v51, 1, v48
    v_lshl_add_u32 v51, v51, 4, v49
    v_and_b32 v48, 1, v48
    v_lshl_add_u32 v51, v48, 2, v51
    v_cndmask_b32 v50, v51, v50, vcc
    v_and_b32 v48, 3, v1
    v_lshl_add_u32 v48, v48, 3, s36
    v_lshl_add_u32 v67, v51, 7, v48
    v_add_u32 v67, 139264, v67
    v_lshl_add_u32 v65, v50, 7, v48
    v_add_u32 v65, 122880, v65
    v_mov_b32 v48, 1024
    v_mov_b32 v49, 512
    v_cndmask_b32 v48, v48, v49, vcc
    v_add_u32 v66, v65, v48
    s_cmp_lt_u32 s17, 12
    s_cselect_b32 s49, 0, 2146435072
    s_cselect_b32 s85, s87, 64
    v_add_u32 v68, s49, v62
    s_mov_b32 s60, s76
    s_and_b32 s61, s77, 0xffff
    s_cmp_lt_u32 s85, 20
    s_cselect_b32 s62, 1966080, 0
    s_cselect_b32 s49, 0, 2146435072
    s_cselect_b32 s88, s88, 0
    s_cselect_b32 s86, s86, 0
    s_mov_b32 s63, 0x00020000
    s_waitcnt vmcnt(5) lgkmcnt(0)
    s_barrier
    ds_read_b128 a[0:3], v2 offset:0
    ds_read_b64_tr_b16 a[20:21], v6 offset:0
    ds_read_b64_tr_b16 a[22:23], v6 offset:2048
    ds_read_b64_tr_b16 a[24:25], v7 offset:0
    ds_read_b64_tr_b16 a[26:27], v7 offset:2048
    ds_read_b128 a[4:7], v2 offset:4096
    ds_read_b128 a[8:11], v2 offset:8192
    ds_read_b128 a[12:15], v2 offset:12288
    ds_read_b128 a[16:19], v2 offset:16384
    s_waitcnt lgkmcnt(0)
    v_mfma_f32_32x32x16_bf16 v[176:191], a[20:23], a[0:3], 0
    ds_read_b128 a[28:31], v3 offset:0
    ds_read_b64_tr_b16 a[48:49], v6 offset:8192
    s_cmp_ge_u32 s27, 1
    s_cselect_b32 s38, 0, 1
    v_mfma_f32_32x32x16_bf16 v[96:111], a[24:27], a[0:3], 0
    ds_read_b64_tr_b16 a[50:51], v6 offset:10240
    ds_read_b64_tr_b16 a[52:53], v7 offset:8192
    s_lshl_b32 s38, s38, 7
    s_add_u32 s39, s38, s33
    v_mfma_f32_32x32x16_bf16 v[112:127], a[24:27], a[4:7], 0
    ds_read_b64_tr_b16 a[54:55], v7 offset:10240
    ds_read_b128 a[32:35], v3 offset:4096
    s_add_u32 m0, s36, 20480
    s_add_u32 s38, s38, s32
    buffer_load_dwordx4 v12, s[8:11], s38 offen offset:0 lds
    v_mfma_f32_32x32x16_bf16 v[192:207], a[20:23], a[4:7], 0
    ds_read_b128 a[36:39], v3 offset:8192
    ds_read_b128 a[40:43], v3 offset:12288
    buffer_load_dwordx4 v13, s[8:11], s38 offen offset:1024 lds
    v_add_u32 v69, s49, v62
    v_mfma_f32_32x32x16_bf16 v[208:223], a[20:23], a[8:11], 0
    ds_read_b128 a[44:47], v3 offset:16384
    buffer_load_dwordx4 v14, s[8:11], s38 offen offset:2048 lds
    v_mfma_f32_32x32x16_bf16 v[128:143], a[24:27], a[8:11], 0
    buffer_load_dwordx4 v15, s[8:11], s38 offen offset:3072 lds
    s_add_u32 m0, s37, 20480
    s_nop 0
    v_mfma_f32_32x32x16_bf16 v[144:159], a[24:27], a[12:15], 0
    buffer_load_dwordx4 v16, s[8:11], s39 offen lds
    s_cmp_ge_u32 s27, 1
    s_cselect_b32 s40, 0, 1
    s_mul_i32 s40, s40, 245760
    v_mfma_f32_32x32x16_bf16 v[224:239], a[20:23], a[12:15], 0
    s_add_u32 m0, s35, 32768
    s_add_u32 s40, s40, s34
    v_mfma_f32_32x32x16_bf16 v[240:255], a[20:23], a[16:19], 0
    v_mfma_f32_32x32x16_bf16 v[160:175], a[24:27], a[16:19], 0
    v_mfma_f32_32x32x16_bf16 a[56:71], v[24:27], a[20:23], 0
    buffer_load_dwordx4 v17, s[12:15], s40 offen offset:0 lds
    v_mfma_f32_32x32x16_bf16 a[72:87], v[24:27], a[24:27], 0
    s_waitcnt lgkmcnt(0)
    v_mfma_f32_32x32x16_bf16 v[176:191], a[48:51], a[28:31], v[176:191]
    s_waitcnt vmcnt(7) lgkmcnt(0)
    s_barrier
    v_mfma_f32_32x32x16_bf16 v[96:111], a[52:55], a[28:31], v[96:111]
    ds_read_b128 a[0:3], v4 offset:0
    ds_read_b64_tr_b16 a[20:21], v6 offset:16384
    s_waitcnt vmcnt(6)
    v_add_u32 v35, 1, v35
    buffer_load_dwordx4 v18, s[12:15], s40 offen offset:1024 lds
    v_mfma_f32_32x32x16_bf16 v[112:127], a[52:55], a[32:35], v[112:127]
    ds_read_b64_tr_b16 a[22:23], v6 offset:18432
    ds_read_b64_tr_b16 a[24:25], v7 offset:16384
    s_nop 0
    v_readfirstlane_b32 s52, v35
    buffer_load_dwordx4 v19, s[12:15], s40 offen offset:2048 lds
    v_mfma_f32_32x32x16_bf16 v[192:207], a[48:51], a[32:35], v[192:207]
    ds_read_b64_tr_b16 a[26:27], v7 offset:18432
    ds_read_b128 a[4:7], v4 offset:4096
    s_and_b32 s4, s2, 7
    s_lshr_b32 s5, s2, 3
    buffer_load_dwordx4 v20, s[12:15], s40 offen offset:3072 lds
    v_mfma_f32_32x32x16_bf16 v[208:223], a[48:51], a[36:39], v[208:223]
    ds_read_b128 a[8:11], v4 offset:8192
    ds_read_b128 a[12:15], v4 offset:12288
    s_lshl_b32 s43, s4, 2
    s_and_b32 s44, s5, 1
    v_mfma_f32_32x32x16_bf16 v[128:143], a[52:55], a[36:39], v[128:143]
    ds_read_b128 a[16:19], v4 offset:16384
    s_lshl_b32 s44, s44, 1
    s_add_u32 s43, s43, s44
    s_lshr_b32 s44, s5, 4
    v_mfma_f32_32x32x16_bf16 v[144:159], a[52:55], a[40:43], v[144:159]
    s_xor_b32 s44, s44, 1
    s_add_u32 s43, s43, s44
    s_bfe_u32 s44, s5, 0x30001
    s_mul_i32 s4, s43, 278528
    v_mfma_f32_32x32x16_bf16 v[224:239], a[48:51], a[40:43], v[224:239]
    s_mul_i32 s5, s24, 49152
    s_add_u32 s47, s4, s5
    s_add_u32 s47, s47, 81920
    s_mul_i32 s5, s24, 20480
    v_mfma_f32_32x32x16_bf16 v[240:255], a[48:51], a[44:47], v[240:255]
    s_add_u32 s55, s4, s5
    s_mul_i32 s4, s44, 5120
    s_add_u32 s4, s4, 8912896
    s_mul_i32 s5, s24, 491520
    v_mfma_f32_32x32x16_bf16 v[160:175], a[52:55], a[44:47], v[160:175]
    s_add_u32 s46, s4, s5
    s_add_u32 s46, s46, 819200
    s_mul_i32 s5, s24, 204800
    s_add_u32 s50, s4, s5
    v_mfma_f32_32x32x16_bf16 a[56:71], v[24:27], a[48:51], a[56:71]
    s_lshl_b32 s4, s44, 1
    s_add_u32 s4, s4, s43
    s_and_b32 s4, s4, 2
    s_and_b32 s7, s4, 3
    v_mfma_f32_32x32x16_bf16 a[72:87], v[24:27], a[52:55], a[72:87]
    s_mul_i32 s6, s7, 3
    s_mul_i32 s3, s6, 40960
    s_add_u32 s46, s46, s3
    s_mul_i32 s3, s7, 40960
    s_waitcnt lgkmcnt(0)
    v_mfma_f32_32x32x16_bf16 v[176:191], a[20:23], a[0:3], v[176:191]
    ds_read_b128 a[28:31], v5 offset:0
    ds_read_b64_tr_b16 a[48:49], v6 offset:24576
    s_add_u32 s50, s50, s3
    s_lshl_b32 s3, s6, 12
    v_mfma_f32_32x32x16_bf16 v[96:111], a[24:27], a[0:3], v[96:111]
    ds_read_b64_tr_b16 a[50:51], v6 offset:26624
    ds_read_b64_tr_b16 a[52:53], v7 offset:24576
    s_add_u32 s47, s47, s3
    s_lshl_b32 s3, s7, 12
    v_mfma_f32_32x32x16_bf16 v[112:127], a[24:27], a[4:7], v[112:127]
    ds_read_b64_tr_b16 a[54:55], v7 offset:26624
    ds_read_b128 a[32:35], v5 offset:4096
    s_add_u32 s55, s55, s3
    s_lshl_b32 s48, s43, 6
    v_mfma_f32_32x32x16_bf16 v[192:207], a[20:23], a[4:7], v[192:207]
    ds_read_b128 a[36:39], v5 offset:8192
    ds_read_b128 a[40:43], v5 offset:12288
    s_lshl_b32 s5, s24, 4
    s_add_u32 s48, s48, s5
    v_mfma_f32_32x32x16_bf16 v[208:223], a[20:23], a[8:11], v[208:223]
    ds_read_b128 a[44:47], v5 offset:16384
    s_lshl_b32 s42, s48, 4
    s_add_u32 s42, s42, 11698176
    s_mul_i32 s48, s48, 1280
    v_mfma_f32_32x32x16_bf16 v[128:143], a[24:27], a[8:11], v[128:143]
    s_mul_i32 s5, s44, 160
    s_add_u32 s48, s48, s5
    s_add_u32 m0, s36, 139264
    s_nop 0
    buffer_load_dwordx4 v64, s[60:63], s88 offen lds
    v_mfma_f32_32x32x16_bf16 v[144:159], a[24:27], a[12:15], v[144:159]
    s_add_u32 s88, s88, 10240
    s_add_u32 m0, s36, 140288
    s_nop 0
    buffer_load_dwordx4 v64, s[60:63], s88 offen lds
    v_mfma_f32_32x32x16_bf16 v[224:239], a[20:23], a[12:15], v[224:239]
    s_add_u32 s88, s88, 10240
    s_add_u32 m0, s36, 141312
    s_nop 0
    buffer_load_dwordx4 v64, s[60:63], s88 offen lds
    v_mfma_f32_32x32x16_bf16 v[240:255], a[20:23], a[16:19], v[240:255]
    s_add_u32 s88, s88, 10240
    s_add_u32 m0, s36, 142336
    s_nop 0
    buffer_load_dwordx4 v64, s[60:63], s88 offen lds
    v_mfma_f32_32x32x16_bf16 v[160:175], a[24:27], a[16:19], v[160:175]
    s_add_u32 s88, s88, 10240
    s_mov_b32 s62, 1966080
    s_cmp_lt_u32 s87, 20
    s_cselect_b32 s60, s68, s76
    s_cselect_b32 s61, s69, s77
    s_cselect_b32 s62, 819200, s62
    v_mfma_f32_32x32x16_bf16 a[56:71], v[24:27], a[20:23], a[56:71]
    s_and_b32 s61, s61, 0xffff
    s_add_u32 m0, s36, 122880
    s_nop 0
    buffer_load_dwordx4 v64, s[60:63], s89 offen lds
    v_mfma_f32_32x32x16_bf16 a[72:87], v[24:27], a[24:27], a[72:87]
    s_add_u32 s89, s89, 10240
    s_add_u32 m0, s36, 123904
    s_nop 0
    buffer_load_dwordx4 v64, s[60:63], s89 offen lds
    s_waitcnt lgkmcnt(0)
    v_mfma_f32_32x32x16_bf16 v[176:191], a[48:51], a[28:31], v[176:191]
    s_waitcnt vmcnt(6) lgkmcnt(0)
    s_barrier
    v_mfma_f32_32x32x16_bf16 v[96:111], a[52:55], a[28:31], v[96:111]
    ds_read_b128 a[0:3], v2 offset:20480
    ds_read_b64_tr_b16 a[20:21], v8 offset:0
    s_add_u32 s89, s89, 10240
    s_add_u32 m0, s36, 124928
    s_nop 0
    buffer_load_dwordx4 v64, s[60:63], s89 offen lds
    v_mfma_f32_32x32x16_bf16 v[112:127], a[52:55], a[32:35], v[112:127]
    ds_read_b64_tr_b16 a[22:23], v8 offset:2048
    ds_read_b64_tr_b16 a[24:25], v9 offset:0
    s_add_u32 s89, s89, 10240
    s_add_u32 m0, s36, 125952
    s_nop 0
    buffer_load_dwordx4 v64, s[60:63], s89 offen lds
    v_mfma_f32_32x32x16_bf16 v[192:207], a[48:51], a[32:35], v[192:207]
    ds_read_b64_tr_b16 a[26:27], v9 offset:2048
    ds_read_b128 a[4:7], v2 offset:24576
    s_add_u32 s89, s89, 10240
    buffer_load_dwordx4 v[36:39], v28, s[8:11], s29 offen
    v_mfma_f32_32x32x16_bf16 v[208:223], a[48:51], a[36:39], v[208:223]
    ds_read_b128 a[8:11], v2 offset:28672
    ds_read_b128 a[12:15], v2 offset:32768
    buffer_load_dwordx4 v[40:43], v28, s[8:11], s29 offen offset:512
    v_mfma_f32_32x32x16_bf16 v[128:143], a[52:55], a[36:39], v[128:143]
    ds_read_b128 a[16:19], v2 offset:36864
    buffer_load_dwordx4 v[44:47], v30, s[8:11], s29 offen offset:1024
    s_add_u32 m0, s35, 49152
    s_add_u32 s40, s40, 122880
    v_mfma_f32_32x32x16_bf16 v[144:159], a[52:55], a[40:43], v[144:159]
    buffer_load_dwordx4 v17, s[12:15], s40 offen offset:0 lds
    v_mfma_f32_32x32x16_bf16 v[224:239], a[48:51], a[40:43], v[224:239]
    buffer_load_dwordx4 v18, s[12:15], s40 offen offset:1024 lds
    v_mfma_f32_32x32x16_bf16 v[240:255], a[48:51], a[44:47], v[240:255]
    buffer_load_dwordx4 v19, s[12:15], s40 offen offset:2048 lds
    v_mfma_f32_32x32x16_bf16 v[160:175], a[52:55], a[44:47], v[160:175]
    buffer_load_dwordx4 v20, s[12:15], s40 offen offset:3072 lds
    s_cmp_ge_u32 s27, 2
    s_cselect_b32 s38, 1, 2
    s_lshl_b32 s38, s38, 7
    v_mfma_f32_32x32x16_bf16 a[56:71], v[24:27], a[48:51], a[56:71]
    s_add_u32 s39, s38, s33
    s_add_u32 m0, s36, 40960
    s_add_u32 s38, s38, s32
    v_mfma_f32_32x32x16_bf16 a[72:87], v[24:27], a[52:55], a[72:87]
    s_waitcnt lgkmcnt(0)
    v_mfma_f32_32x32x16_bf16 v[176:191], a[20:23], a[0:3], v[176:191]
    ds_read_b128 a[28:31], v3 offset:20480
    ds_read_b64_tr_b16 a[48:49], v8 offset:8192
    s_waitcnt vmcnt(11)
    buffer_load_dwordx4 v12, s[8:11], s38 offen offset:0 lds
    v_mfma_f32_32x32x16_bf16 v[96:111], a[24:27], a[0:3], v[96:111]
    ds_read_b64_tr_b16 a[50:51], v8 offset:10240
    ds_read_b64_tr_b16 a[52:53], v9 offset:8192
    buffer_load_dwordx4 v13, s[8:11], s38 offen offset:1024 lds
    v_mfma_f32_32x32x16_bf16 v[112:127], a[24:27], a[4:7], v[112:127]
    ds_read_b64_tr_b16 a[54:55], v9 offset:10240
    ds_read_b128 a[32:35], v3 offset:24576
    buffer_load_dwordx4 v14, s[8:11], s38 offen offset:2048 lds
    v_mfma_f32_32x32x16_bf16 v[192:207], a[20:23], a[4:7], v[192:207]
    ds_read_b128 a[36:39], v3 offset:28672
    ds_read_b128 a[40:43], v3 offset:32768
    buffer_load_dwordx4 v15, s[8:11], s38 offen offset:3072 lds
    s_add_u32 m0, s37, 40960
    s_nop 0
    v_mfma_f32_32x32x16_bf16 v[208:223], a[20:23], a[8:11], v[208:223]
    ds_read_b128 a[44:47], v3 offset:36864
    ds_read_b64_tr_b16 a[104:105], v67 offset:0
    buffer_load_dwordx4 v16, s[8:11], s39 offen lds
    s_cmp_ge_u32 s27, 2
    s_cselect_b32 s40, 1, 2
    v_mfma_f32_32x32x16_bf16 v[128:143], a[24:27], a[8:11], v[128:143]
    ds_read_b64_tr_b16 a[106:107], v67 offset:1024
    ds_read_b64_tr_b16 a[108:109], v67 offset:32
    s_mul_i32 s40, s40, 245760
    s_add_u32 m0, s35, 0
    s_add_u32 s40, s40, s34
    buffer_load_dwordx4 v17, s[12:15], s40 offen offset:0 lds
    v_mfma_f32_32x32x16_bf16 v[144:159], a[24:27], a[12:15], v[144:159]
    ds_read_b64_tr_b16 a[110:111], v67 offset:1056
    ds_read_b64_tr_b16 a[112:113], v67 offset:64
    buffer_load_dwordx4 v18, s[12:15], s40 offen offset:1024 lds
    v_mfma_f32_32x32x16_bf16 v[224:239], a[20:23], a[12:15], v[224:239]
    ds_read_b64_tr_b16 a[114:115], v67 offset:1088
    ds_read_b64_tr_b16 a[116:117], v67 offset:96
    buffer_load_dwordx4 v19, s[12:15], s40 offen offset:2048 lds
    v_mfma_f32_32x32x16_bf16 v[240:255], a[20:23], a[16:19], v[240:255]
    ds_read_b64_tr_b16 a[118:119], v67 offset:1120
    buffer_load_dwordx4 v20, s[12:15], s40 offen offset:3072 lds
    s_add_u32 m0, s35, 16384
    s_add_u32 s40, s40, 122880
    v_mfma_f32_32x32x16_bf16 v[160:175], a[24:27], a[16:19], v[160:175]
    s_waitcnt lgkmcnt(8)
    v_mfma_f32_32x32x16_bf16 v[176:191], a[48:51], a[28:31], v[176:191]
    s_waitcnt vmcnt(9) lgkmcnt(0)
    s_barrier
    v_mfma_f32_32x32x16_bf16 v[96:111], a[52:55], a[28:31], v[96:111]
    ds_read_b128 a[0:3], v4 offset:20480
    ds_read_b64_tr_b16 a[20:21], v8 offset:16384
    v_and_b32 v34, 31, v1
    v_lshlrev_b32 v34, 2, v34
    v_mfma_f32_32x32x16_bf16 v[112:127], a[52:55], a[32:35], v[112:127]
    ds_read_b64_tr_b16 a[22:23], v8 offset:18432
    ds_read_b64_tr_b16 a[24:25], v9 offset:16384
    s_mul_i32 s29, s26, 15360
    s_mul_i32 s30, s24, 384
    v_mfma_f32_32x32x16_bf16 v[192:207], a[48:51], a[32:35], v[192:207]
    ds_read_b64_tr_b16 a[26:27], v9 offset:18432
    ds_read_b128 a[4:7], v4 offset:24576
    s_add_u32 s29, s29, s30
    s_add_u32 s54, s29, 11730944
    v_mfma_f32_32x32x16_bf16 v[208:223], a[48:51], a[36:39], v[208:223]
    ds_read_b128 a[8:11], v4 offset:28672
    ds_read_b128 a[12:15], v4 offset:32768
    buffer_load_dwordx4 v17, s[12:15], s40 offen offset:0 lds
    s_mul_i32 s29, s27, 1536
    v_mfma_f32_32x32x16_bf16 v[128:143], a[52:55], a[36:39], v[128:143]
    ds_read_b128 a[16:19], v4 offset:36864
    ds_read_b64_tr_b16 a[120:121], v65 offset:0
    v_mfma_f32_32x32x16_bf16 v[144:159], a[52:55], a[40:43], v[144:159]
    ds_read_b64_tr_b16 a[122:123], v66 offset:0
    ds_read_b64_tr_b16 a[124:125], v65 offset:32
    s_add_u32 s29, s29, s54
    buffer_store_dword a56, v34, s[20:23], s29 offen offset:0 sc1
    v_mfma_f32_32x32x16_bf16 v[224:239], a[48:51], a[40:43], v[224:239]
    ds_read_b64_tr_b16 a[126:127], v66 offset:32
    ds_read_b64_tr_b16 a[128:129], v65 offset:64
    buffer_store_dword a72, v34, s[20:23], s29 offen offset:128 sc1
    s_and_b32 s30, s83, 15
    v_mfma_f32_32x32x16_bf16 v[240:255], a[48:51], a[44:47], v[240:255]
    ds_read_b64_tr_b16 a[130:131], v66 offset:64
    ds_read_b64_tr_b16 a[132:133], v65 offset:96
    s_lshl_b32 s31, s25, 12
    s_lshl_b32 s82, s30, 2
    v_mfma_f32_32x32x16_bf16 v[160:175], a[52:55], a[44:47], v[160:175]
    ds_read_b64_tr_b16 a[134:135], v66 offset:96
    buffer_load_dwordx4 v18, s[12:15], s40 offen offset:1024 lds
    s_add_u32 s31, s31, s82
    v_and_b32 v52, 15, v1
    s_waitcnt lgkmcnt(8)
    v_mfma_f32_32x32x16_bf16 v[176:191], a[20:23], a[0:3], v[176:191]
    ds_read_b128 a[28:31], v5 offset:20480
    ds_read_b64_tr_b16 a[48:49], v8 offset:24576
    buffer_load_dwordx4 v19, s[12:15], s40 offen offset:2048 lds
    v_lshlrev_b32 v53, 8, v52
    v_mfma_f32_32x32x16_bf16 v[96:111], a[24:27], a[0:3], v[96:111]
    ds_read_b64_tr_b16 a[50:51], v8 offset:26624
    ds_read_b64_tr_b16 a[52:53], v9 offset:24576
    buffer_load_dwordx4 v20, s[12:15], s40 offen offset:3072 lds
    s_cmp_ge_u32 s27, 3
    s_cselect_b32 s38, 2, 3
    v_mfma_f32_32x32x16_bf16 v[112:127], a[24:27], a[4:7], v[112:127]
    ds_read_b64_tr_b16 a[54:55], v9 offset:26624
    ds_read_b128 a[32:35], v5 offset:24576
    s_lshl_b32 s38, s38, 7
    s_add_u32 s39, s38, s33
    v_mfma_f32_32x32x16_bf16 v[192:207], a[20:23], a[4:7], v[192:207]
    ds_read_b128 a[36:39], v5 offset:28672
    ds_read_b128 a[40:43], v5 offset:32768
    s_add_u32 m0, s36, 0
    s_add_u32 s38, s38, s32
    v_mfma_f32_32x32x16_bf16 v[208:223], a[20:23], a[8:11], v[208:223]
    ds_read_b128 a[44:47], v5 offset:36864
    s_waitcnt lgkmcnt(9)
    buffer_store_dwordx4 a[104:107], v69, s[20:23], s86 offen offset:0 sc1
    v_add_u32 v23, s31, v53
    v_mfma_f32_32x32x16_bf16 v[128:143], a[24:27], a[8:11], v[128:143]
    buffer_store_dwordx4 a[108:111], v69, s[20:23], s86 offen offset:1024 sc1
    v_add_u32 v53, 4168, v23
    s_lshl_b32 s31, s30, 8
    s_lshl_b32 s82, s25, 2
    v_mfma_f32_32x32x16_bf16 v[144:159], a[24:27], a[12:15], v[144:159]
    buffer_store_dwordx4 a[112:115], v69, s[20:23], s86 offen offset:2048 sc1
    s_add_u32 s31, s31, s82
    s_add_u32 s31, s31, 64
    v_lshlrev_b32 v52, 12, v52
    v_mfma_f32_32x32x16_bf16 v[224:239], a[20:23], a[12:15], v[224:239]
    buffer_store_dwordx4 a[116:119], v69, s[20:23], s86 offen offset:3072 sc1
    v_add_u32 v52, s31, v52
    v_mov_b32 v54, 2146435072
    s_mov_b32 s82, 12500992
    v_mfma_f32_32x32x16_bf16 v[240:255], a[20:23], a[16:19], v[240:255]
    buffer_store_dwordx4 a[120:123], v68, s[20:23], s84 offen offset:0 sc1
    s_mov_b32 vcc_lo, 0xffff0000
    s_mov_b32 vcc_hi, 0
    v_cndmask_b32 v23, v23, v52, vcc
    v_mfma_f32_32x32x16_bf16 v[160:175], a[24:27], a[16:19], v[160:175]
    buffer_store_dwordx4 a[124:127], v68, s[20:23], s84 offen offset:1024 sc1
    s_mov_b32 vcc_lo, 0
    s_mov_b32 vcc_hi, -1
    v_cndmask_b32 v23, v23, v53, vcc
    s_waitcnt lgkmcnt(0)
    v_mfma_f32_32x32x16_bf16 v[176:191], a[48:51], a[28:31], v[176:191]
    s_waitcnt vmcnt(12) lgkmcnt(0)
    s_barrier
    v_mfma_f32_32x32x16_bf16 v[96:111], a[52:55], a[28:31], v[96:111]
    ds_read_b128 a[0:3], v2 offset:40960
    ds_read_b64_tr_b16 a[20:21], v6 offset:0
    buffer_store_dwordx4 a[128:131], v68, s[20:23], s84 offen offset:2048 sc1
    s_cmp_ge_u32 s30, 14
    s_cselect_b32 s31, 0xff, 0
    s_cmp_lt_u32 s25, 15
    s_cselect_b32 s31, s31, 0
    v_mfma_f32_32x32x16_bf16 v[112:127], a[52:55], a[32:35], v[112:127]
    ds_read_b64_tr_b16 a[22:23], v6 offset:2048
    ds_read_b64_tr_b16 a[24:25], v7 offset:0
    buffer_store_dwordx4 a[132:135], v68, s[20:23], s84 offen offset:3072 sc1
    s_cmp_eq_u32 s24, 0
    s_cselect_b32 vcc_lo, -1, 0
    s_cselect_b32 vcc_hi, s31, 0
    v_cndmask_b32 v23, v54, v23, vcc
    v_mfma_f32_32x32x16_bf16 v[192:207], a[48:51], a[32:35], v[192:207]
    ds_read_b64_tr_b16 a[26:27], v7 offset:2048
    ds_read_b128 a[4:7], v2 offset:45056
    buffer_load_dwordx4 v12, s[8:11], s38 offen offset:0 lds
    v_mfma_f32_32x32x16_bf16 v[208:223], a[48:51], a[36:39], v[208:223]
    ds_read_b128 a[8:11], v2 offset:49152
    ds_read_b128 a[12:15], v2 offset:53248
    buffer_load_dwordx4 v13, s[8:11], s38 offen offset:1024 lds
    v_lshlrev_b32 v28, 16, v36
    v_mfma_f32_32x32x16_bf16 v[128:143], a[52:55], a[36:39], v[128:143]
    ds_read_b128 a[16:19], v2 offset:57344
    buffer_load_dwordx4 v14, s[8:11], s38 offen offset:2048 lds
    v_and_b32 v29, s45, v36
    v_mov_b32 v30, v28
    v_mfma_f32_32x32x16_bf16 v[144:159], a[52:55], a[40:43], v[144:159]
    buffer_load_dwordx4 v15, s[8:11], s38 offen offset:3072 lds
    s_add_u32 m0, s37, 0
    s_nop 0
    v_mov_b32 v31, v29
    v_mfma_f32_32x32x16_bf16 v[224:239], a[48:51], a[40:43], v[224:239]
    buffer_load_dwordx4 v16, s[8:11], s39 offen lds
    s_cmp_ge_u32 s27, 3
    s_cselect_b32 s40, 2, 3
    s_mul_i32 s40, s40, 245760
    v_mfma_f32_32x32x16_bf16 v[240:255], a[48:51], a[44:47], v[240:255]
    s_add_u32 m0, s35, 32768
    s_add_u32 s40, s40, s34
    v_mul_f32 v32, v28, v28
    v_mul_f32 v33, v29, v29
    v_mfma_f32_32x32x16_bf16 v[160:175], a[52:55], a[44:47], v[160:175]
    v_lshlrev_b32 v28, 16, v37
    v_and_b32 v29, s45, v37
    v_add_f32 v30, v30, v28
    v_add_f32 v31, v31, v29
    s_waitcnt lgkmcnt(0)
    v_mfma_f32_32x32x16_bf16 v[176:191], a[20:23], a[0:3], v[176:191]
    ds_read_b128 a[28:31], v3 offset:40960
    ds_read_b64_tr_b16 a[48:49], v6 offset:8192
    buffer_load_dwordx4 v17, s[12:15], s40 offen offset:0 lds
    v_fmac_f32 v32, v28, v28
    v_mfma_f32_32x32x16_bf16 v[96:111], a[24:27], a[0:3], v[96:111]
    ds_read_b64_tr_b16 a[50:51], v6 offset:10240
    ds_read_b64_tr_b16 a[52:53], v7 offset:8192
    buffer_load_dwordx4 v18, s[12:15], s40 offen offset:1024 lds
    v_fmac_f32 v33, v29, v29
    v_mfma_f32_32x32x16_bf16 v[112:127], a[24:27], a[4:7], v[112:127]
    ds_read_b64_tr_b16 a[54:55], v7 offset:10240
    ds_read_b128 a[32:35], v3 offset:45056
    buffer_load_dwordx4 v19, s[12:15], s40 offen offset:2048 lds
    v_lshlrev_b32 v28, 16, v38
    v_mfma_f32_32x32x16_bf16 v[192:207], a[20:23], a[4:7], v[192:207]
    ds_read_b128 a[36:39], v3 offset:49152
    ds_read_b128 a[40:43], v3 offset:53248
    buffer_load_dwordx4 v20, s[12:15], s40 offen offset:3072 lds
    s_add_u32 m0, s35, 49152
    s_add_u32 s40, s40, 122880
    v_mfma_f32_32x32x16_bf16 v[208:223], a[20:23], a[8:11], v[208:223]
    ds_read_b128 a[44:47], v3 offset:57344
    v_and_b32 v29, s45, v38
    v_add_f32 v30, v30, v28
    v_add_f32 v31, v31, v29
    v_mfma_f32_32x32x16_bf16 v[128:143], a[24:27], a[8:11], v[128:143]
    v_fmac_f32 v32, v28, v28
    v_fmac_f32 v33, v29, v29
    v_lshlrev_b32 v28, 16, v39
    v_and_b32 v29, s45, v39
    v_mfma_f32_32x32x16_bf16 v[144:159], a[24:27], a[12:15], v[144:159]
    v_add_f32 v30, v30, v28
    v_add_f32 v31, v31, v29
    v_fmac_f32 v32, v28, v28
    v_fmac_f32 v33, v29, v29
    v_mfma_f32_32x32x16_bf16 v[224:239], a[20:23], a[12:15], v[224:239]
    v_lshlrev_b32 v28, 16, v40
    v_and_b32 v29, s45, v40
    v_add_f32 v30, v30, v28
    v_add_f32 v31, v31, v29
    v_mfma_f32_32x32x16_bf16 v[240:255], a[20:23], a[16:19], v[240:255]
    v_fmac_f32 v32, v28, v28
    v_fmac_f32 v33, v29, v29
    v_lshlrev_b32 v28, 16, v41
    v_and_b32 v29, s45, v41
    v_mfma_f32_32x32x16_bf16 v[160:175], a[24:27], a[16:19], v[160:175]
    buffer_load_dwordx4 v17, s[12:15], s40 offen offset:0 lds
    v_add_f32 v30, v30, v28
    v_add_f32 v31, v31, v29
    v_fmac_f32 v32, v28, v28
    s_waitcnt lgkmcnt(0)
    v_mfma_f32_32x32x16_bf16 v[176:191], a[48:51], a[28:31], v[176:191]
    s_waitcnt vmcnt(18) lgkmcnt(0)
    s_barrier
    v_mfma_f32_32x32x16_bf16 v[96:111], a[52:55], a[28:31], v[96:111]
    ds_read_b128 a[0:3], v4 offset:40960
    ds_read_b64_tr_b16 a[20:21], v6 offset:16384
    v_fmac_f32 v33, v29, v29
    v_lshlrev_b32 v28, 16, v42
    v_mfma_f32_32x32x16_bf16 v[112:127], a[52:55], a[32:35], v[112:127]
    ds_read_b64_tr_b16 a[22:23], v6 offset:18432
    ds_read_b64_tr_b16 a[24:25], v7 offset:16384
    v_and_b32 v29, s45, v42
    v_add_f32 v30, v30, v28
    v_mfma_f32_32x32x16_bf16 v[192:207], a[48:51], a[32:35], v[192:207]
    ds_read_b64_tr_b16 a[26:27], v7 offset:18432
    ds_read_b128 a[4:7], v4 offset:45056
    buffer_load_dwordx4 v18, s[12:15], s40 offen offset:1024 lds
    v_add_f32 v31, v31, v29
    v_mfma_f32_32x32x16_bf16 v[208:223], a[48:51], a[36:39], v[208:223]
    ds_read_b128 a[8:11], v4 offset:49152
    ds_read_b128 a[12:15], v4 offset:53248
    v_fmac_f32 v32, v28, v28
    v_fmac_f32 v33, v29, v29
    v_mfma_f32_32x32x16_bf16 v[128:143], a[52:55], a[36:39], v[128:143]
    ds_read_b128 a[16:19], v4 offset:57344
    v_lshlrev_b32 v28, 16, v43
    v_and_b32 v29, s45, v43
    v_add_f32 v30, v30, v28
    v_mfma_f32_32x32x16_bf16 v[144:159], a[52:55], a[40:43], v[144:159]
    buffer_load_dwordx4 v19, s[12:15], s40 offen offset:2048 lds
    v_add_f32 v31, v31, v29
    v_fmac_f32 v32, v28, v28
    v_fmac_f32 v33, v29, v29
    v_mfma_f32_32x32x16_bf16 v[224:239], a[48:51], a[40:43], v[224:239]
    v_lshlrev_b32 v28, 16, v44
    v_and_b32 v29, s45, v44
    v_add_f32 v30, v30, v28
    v_add_f32 v31, v31, v29
    v_mfma_f32_32x32x16_bf16 v[240:255], a[48:51], a[44:47], v[240:255]
    v_fmac_f32 v32, v28, v28
    v_fmac_f32 v33, v29, v29
    v_lshlrev_b32 v28, 16, v45
    v_and_b32 v29, s45, v45
    v_mfma_f32_32x32x16_bf16 v[160:175], a[52:55], a[44:47], v[160:175]
    buffer_load_dwordx4 v20, s[12:15], s40 offen offset:3072 lds
    s_cmp_ge_u32 s27, 4
    s_cselect_b32 s38, 3, 4
    s_lshl_b32 s38, s38, 7
    s_waitcnt lgkmcnt(0)
    v_mfma_f32_32x32x16_bf16 v[176:191], a[20:23], a[0:3], v[176:191]
    ds_read_b128 a[28:31], v5 offset:40960
    ds_read_b64_tr_b16 a[48:49], v6 offset:24576
    s_add_u32 s39, s38, s33
    s_add_u32 m0, s36, 20480
    s_add_u32 s38, s38, s32
    v_mfma_f32_32x32x16_bf16 v[96:111], a[24:27], a[0:3], v[96:111]
    ds_read_b64_tr_b16 a[50:51], v6 offset:26624
    ds_read_b64_tr_b16 a[52:53], v7 offset:24576
    v_add_f32 v30, v30, v28
    v_add_f32 v31, v31, v29
    v_mfma_f32_32x32x16_bf16 v[112:127], a[24:27], a[4:7], v[112:127]
    ds_read_b64_tr_b16 a[54:55], v7 offset:26624
    ds_read_b128 a[32:35], v5 offset:45056
    buffer_load_dwordx4 v12, s[8:11], s38 offen offset:0 lds
    v_fmac_f32 v32, v28, v28
    v_mfma_f32_32x32x16_bf16 v[192:207], a[20:23], a[4:7], v[192:207]
    ds_read_b128 a[36:39], v5 offset:49152
    ds_read_b128 a[40:43], v5 offset:53248
    v_fmac_f32 v33, v29, v29
    v_lshlrev_b32 v28, 16, v46
    v_mfma_f32_32x32x16_bf16 v[208:223], a[20:23], a[8:11], v[208:223]
    ds_read_b128 a[44:47], v5 offset:57344
    v_and_b32 v29, s45, v46
    v_add_f32 v30, v30, v28
    v_add_f32 v31, v31, v29
    v_mfma_f32_32x32x16_bf16 v[128:143], a[24:27], a[8:11], v[128:143]
    buffer_load_dwordx4 v13, s[8:11], s38 offen offset:1024 lds
    v_fmac_f32 v32, v28, v28
    v_fmac_f32 v33, v29, v29
    v_lshlrev_b32 v28, 16, v47
    v_mfma_f32_32x32x16_bf16 v[144:159], a[24:27], a[12:15], v[144:159]
    v_and_b32 v29, s45, v47
    v_add_f32 v30, v30, v28
    v_add_f32 v31, v31, v29
    v_fmac_f32 v32, v28, v28
    v_mfma_f32_32x32x16_bf16 v[224:239], a[20:23], a[12:15], v[224:239]
    buffer_load_dwordx4 v14, s[8:11], s38 offen offset:2048 lds
    v_fmac_f32 v33, v29, v29
    v_add_f32 v30, v30, v31
    v_add_f32 v32, v32, v33
    v_mfma_f32_32x32x16_bf16 v[240:255], a[20:23], a[16:19], v[240:255]
    s_nop 0
    v_add_f32_dpp v30, v30, v30 quad_perm:[1,0,3,2] row_mask:0xf bank_mask:0xf
    v_add_f32_dpp v32, v32, v32 quad_perm:[1,0,3,2] row_mask:0xf bank_mask:0xf
    s_nop 0
    v_mfma_f32_32x32x16_bf16 v[160:175], a[24:27], a[16:19], v[160:175]
    buffer_load_dwordx4 v15, s[8:11], s38 offen offset:3072 lds
    s_add_u32 m0, s37, 20480
    s_nop 0
    v_add_f32_dpp v30, v30, v30 quad_perm:[2,3,0,1] row_mask:0xf bank_mask:0xf
    s_waitcnt lgkmcnt(0)
    v_mfma_f32_32x32x16_bf16 v[176:191], a[48:51], a[28:31], v[176:191]
    s_waitcnt vmcnt(8) lgkmcnt(0)
    s_barrier
    v_mfma_f32_32x32x16_bf16 v[96:111], a[52:55], a[28:31], v[96:111]
    ds_read_b128 a[0:3], v2 offset:0
    ds_read_b64_tr_b16 a[20:21], v8 offset:0
    buffer_load_dwordx4 v16, s[8:11], s39 offen lds
    s_cmp_ge_u32 s27, 4
    s_cselect_b32 s40, 3, 4
    v_mfma_f32_32x32x16_bf16 v[112:127], a[52:55], a[32:35], v[112:127]
    ds_read_b64_tr_b16 a[22:23], v8 offset:2048
    ds_read_b64_tr_b16 a[24:25], v9 offset:0
    s_mul_i32 s40, s40, 245760
    s_add_u32 m0, s35, 0
    s_add_u32 s40, s40, s34
    v_mfma_f32_32x32x16_bf16 v[192:207], a[48:51], a[32:35], v[192:207]
    ds_read_b64_tr_b16 a[26:27], v9 offset:2048
    ds_read_b128 a[4:7], v2 offset:4096
    buffer_load_dwordx4 v17, s[12:15], s40 offen offset:0 lds
    v_add_f32_dpp v32, v32, v32 quad_perm:[2,3,0,1] row_mask:0xf bank_mask:0xf
    v_mfma_f32_32x32x16_bf16 v[208:223], a[48:51], a[36:39], v[208:223]
    ds_read_b128 a[8:11], v2 offset:8192
    ds_read_b128 a[12:15], v2 offset:12288
    s_nop 0
    v_add_f32_dpp v30, v30, v30 row_half_mirror row_mask:0xf bank_mask:0xf
    v_mfma_f32_32x32x16_bf16 v[128:143], a[52:55], a[36:39], v[128:143]
    ds_read_b128 a[16:19], v2 offset:16384
    s_cmp_ge_u32 s16, 5
    s_cselect_b32 s3, 1, 0
    s_cselect_b32 s4, 5, 0
    s_sub_u32 s3, s16, s3
    s_sub_u32 s4, s16, s4
    v_mfma_f32_32x32x16_bf16 v[144:159], a[52:55], a[40:43], v[144:159]
    s_cmp_lg_u32 s4, 4
    s_cselect_b32 vcc_lo, -1, 0
    s_cmp_lg_u32 s4, 0
    s_cselect_b32 vcc_hi, -1, 0
    s_lshl_b32 s4, s24, 4
    s_add_u32 s4, s4, s17
    s_cmp_lt_u32 s4, 12
    s_cselect_b64 vcc, vcc, 0
    v_and_b32 v48, 31, v1
    v_lshlrev_b32 v48, 10, v48
    v_lshrrev_b32 v49, 5, v1
    v_lshlrev_b32 v49, 6, v49
    v_sub_u32 v48, v48, v49
    v_add_u32 v48, 128, v48
    v_mov_b32 v49, 2146435072
    v_cndmask_b32 v48, v49, v48, vcc
    v_mfma_f32_32x32x16_bf16 v[224:239], a[48:51], a[40:43], v[224:239]
    s_lshl_b32 s3, s3, 7
    s_lshl_b32 s4, s17, 2
    s_add_u32 s3, s3, s4
    s_add_u32 s3, s3, 12566400
    v_mfma_f32_32x32x16_bf16 v[240:255], a[48:51], a[44:47], v[240:255]
    buffer_store_dword v35, v48, s[20:23], s3 offen sc0 sc1
    v_add_f32_dpp v32, v32, v32 row_half_mirror row_mask:0xf bank_mask:0xf
    s_nop 0
    v_add_f32_dpp v30, v30, v30 row_mirror row_mask:0xf bank_mask:0xf
    v_mfma_f32_32x32x16_bf16 v[160:175], a[52:55], a[44:47], v[160:175]
    buffer_load_dwordx4 v18, s[12:15], s40 offen offset:1024 lds
    v_add_f32_dpp v32, v32, v32 row_mirror row_mask:0xf bank_mask:0xf
    s_nop 0
    v_add_f32_dpp v30, v30, v30 row_bcast:15 row_mask:0xa bank_mask:0xf
    s_waitcnt lgkmcnt(0)
    v_mfma_f32_32x32x16_bf16 v[176:191], a[20:23], a[0:3], v[176:191]
    ds_read_b128 a[28:31], v3 offset:0
    ds_read_b64_tr_b16 a[48:49], v8 offset:8192
    buffer_load_dwordx4 v19, s[12:15], s40 offen offset:2048 lds
    v_add_f32_dpp v32, v32, v32 row_bcast:15 row_mask:0xa bank_mask:0xf
    v_mfma_f32_32x32x16_bf16 v[96:111], a[24:27], a[0:3], v[96:111]
    ds_read_b64_tr_b16 a[50:51], v8 offset:10240
    ds_read_b64_tr_b16 a[52:53], v9 offset:8192
    buffer_load_dwordx4 v20, s[12:15], s40 offen offset:3072 lds
    s_add_u32 m0, s35, 16384
    s_add_u32 s40, s40, 122880
    v_mfma_f32_32x32x16_bf16 v[112:127], a[24:27], a[4:7], v[112:127]
    ds_read_b64_tr_b16 a[54:55], v9 offset:10240
    ds_read_b128 a[32:35], v3 offset:4096
    s_nop 0
    v_mul_f32 v30, 0x3acccccd, v30
    v_mfma_f32_32x32x16_bf16 v[192:207], a[20:23], a[4:7], v[192:207]
    ds_read_b128 a[36:39], v3 offset:8192
    ds_read_b128 a[40:43], v3 offset:12288
    v_mul_f32 v32, 0x3acccccd, v32
    v_fma_f32 v32, -v30, v30, v32
    v_mfma_f32_32x32x16_bf16 v[208:223], a[20:23], a[8:11], v[208:223]
    ds_read_b128 a[44:47], v3 offset:16384
    v_max_f32 v32, 0, v32
    v_cvt_pk_bf16_f32 v36, -v30, -v30
    v_cvt_pk_bf16_f32 v32, v32, v32
    v_mfma_f32_32x32x16_bf16 v[128:143], a[24:27], a[8:11], v[128:143]
    v_and_b32 v32, s45, v32
    v_add_f32 v32, 0x3727c5ac, v32
    v_cvt_pk_bf16_f32 v32, v32, v32
    v_and_b32 v32, s45, v32
    v_mfma_f32_32x32x16_bf16 v[144:159], a[24:27], a[12:15], v[144:159]
    v_sqrt_f32 v32, v32
    v_mov_b32 v37, v36
    v_cvt_pk_bf16_f32 v32, v32, v32
    v_and_b32 v32, s45, v32
    v_mfma_f32_32x32x16_bf16 v[224:239], a[20:23], a[12:15], v[224:239]
    buffer_load_dwordx4 v17, s[12:15], s40 offen offset:0 lds
    v_rcp_f32 v38, v32
    v_and_b32 v28, 31, v1
    v_mul_f32 v39, v38, v38
    v_mfma_f32_32x32x16_bf16 v[240:255], a[20:23], a[16:19], v[240:255]
    v_mov_b32 v29, 2146435072
    s_lshl_b32 s28, s28, 5
    s_add_u32 s28, s28, 11698176
    v_cmp_eq_u32 vcc, 16, v28
    v_lshrrev_b32 v28, 5, v1
    v_lshlrev_b32 v28, 4, v28
    v_cndmask_b32 v28, v29, v28, vcc
    v_mfma_f32_32x32x16_bf16 v[160:175], a[24:27], a[16:19], v[160:175]
    buffer_store_dwordx4 v[36:39], v28, s[20:23], s28 offen sc1
    s_waitcnt lgkmcnt(0)
    v_mfma_f32_32x32x16_bf16 v[176:191], a[48:51], a[28:31], v[176:191]
    s_waitcnt vmcnt(12) lgkmcnt(0)
    s_barrier
    v_mfma_f32_32x32x16_bf16 v[96:111], a[52:55], a[28:31], v[96:111]
    ds_read_b128 a[0:3], v4 offset:0
    ds_read_b64_tr_b16 a[20:21], v8 offset:16384
    buffer_load_dwordx4 v18, s[12:15], s40 offen offset:1024 lds
    v_mfma_f32_32x32x16_bf16 v[112:127], a[52:55], a[32:35], v[112:127]
    ds_read_b64_tr_b16 a[22:23], v8 offset:18432
    ds_read_b64_tr_b16 a[24:25], v9 offset:16384
    v_mfma_f32_32x32x16_bf16 v[192:207], a[48:51], a[32:35], v[192:207]
    ds_read_b64_tr_b16 a[26:27], v9 offset:18432
    ds_read_b128 a[4:7], v4 offset:4096
    v_mfma_f32_32x32x16_bf16 v[208:223], a[48:51], a[36:39], v[208:223]
    ds_read_b128 a[8:11], v4 offset:8192
    ds_read_b128 a[12:15], v4 offset:12288
    buffer_load_dwordx4 v19, s[12:15], s40 offen offset:2048 lds
    v_mfma_f32_32x32x16_bf16 v[128:143], a[52:55], a[36:39], v[128:143]
    ds_read_b128 a[16:19], v4 offset:16384
    v_mfma_f32_32x32x16_bf16 v[144:159], a[52:55], a[40:43], v[144:159]
    v_mfma_f32_32x32x16_bf16 v[224:239], a[48:51], a[40:43], v[224:239]
    v_mfma_f32_32x32x16_bf16 v[240:255], a[48:51], a[44:47], v[240:255]
    buffer_load_dwordx4 v20, s[12:15], s40 offen offset:3072 lds
    s_cmp_ge_u32 s27, 5
    s_cselect_b32 s38, 4, 5
    s_lshl_b32 s38, s38, 7
    v_mfma_f32_32x32x16_bf16 v[160:175], a[52:55], a[44:47], v[160:175]
    s_add_u32 s39, s38, s33
    s_add_u32 m0, s36, 40960
    s_add_u32 s38, s38, s32
    s_waitcnt lgkmcnt(0)
    v_mfma_f32_32x32x16_bf16 v[176:191], a[20:23], a[0:3], v[176:191]
    ds_read_b128 a[28:31], v5 offset:0
    ds_read_b64_tr_b16 a[48:49], v8 offset:24576
    v_mfma_f32_32x32x16_bf16 v[96:111], a[24:27], a[0:3], v[96:111]
    ds_read_b64_tr_b16 a[50:51], v8 offset:26624
    ds_read_b64_tr_b16 a[52:53], v9 offset:24576
    buffer_load_dwordx4 v12, s[8:11], s38 offen offset:0 lds
    v_mfma_f32_32x32x16_bf16 v[112:127], a[24:27], a[4:7], v[112:127]
    ds_read_b64_tr_b16 a[54:55], v9 offset:26624
    ds_read_b128 a[32:35], v5 offset:4096
    v_mfma_f32_32x32x16_bf16 v[192:207], a[20:23], a[4:7], v[192:207]
    ds_read_b128 a[36:39], v5 offset:8192
    ds_read_b128 a[40:43], v5 offset:12288
    buffer_load_dwordx4 v13, s[8:11], s38 offen offset:1024 lds
    v_mfma_f32_32x32x16_bf16 v[208:223], a[20:23], a[8:11], v[208:223]
    ds_read_b128 a[44:47], v5 offset:16384
    v_mfma_f32_32x32x16_bf16 v[128:143], a[24:27], a[8:11], v[128:143]
    buffer_load_dwordx4 v14, s[8:11], s38 offen offset:2048 lds
    v_mfma_f32_32x32x16_bf16 v[144:159], a[24:27], a[12:15], v[144:159]
    v_mfma_f32_32x32x16_bf16 v[224:239], a[20:23], a[12:15], v[224:239]
    v_mfma_f32_32x32x16_bf16 v[240:255], a[20:23], a[16:19], v[240:255]
    buffer_load_dwordx4 v15, s[8:11], s38 offen offset:3072 lds
    s_add_u32 m0, s37, 40960
    s_nop 0
    v_mfma_f32_32x32x16_bf16 v[160:175], a[24:27], a[16:19], v[160:175]
    s_waitcnt lgkmcnt(0)
    v_mfma_f32_32x32x16_bf16 v[176:191], a[48:51], a[28:31], v[176:191]
    s_waitcnt vmcnt(9) lgkmcnt(0)
    s_barrier
    v_mfma_f32_32x32x16_bf16 v[96:111], a[52:55], a[28:31], v[96:111]
    ds_read_b128 a[0:3], v2 offset:20480
    ds_read_b64_tr_b16 a[20:21], v6 offset:0
    buffer_load_dwordx4 v16, s[8:11], s39 offen lds
    s_cmp_ge_u32 s27, 5
    s_cselect_b32 s40, 4, 5
    v_mfma_f32_32x32x16_bf16 v[112:127], a[52:55], a[32:35], v[112:127]
    ds_read_b64_tr_b16 a[22:23], v6 offset:2048
    ds_read_b64_tr_b16 a[24:25], v7 offset:0
    s_mul_i32 s40, s40, 245760
    s_add_u32 m0, s35, 32768
    s_add_u32 s40, s40, s34
    v_mfma_f32_32x32x16_bf16 v[192:207], a[48:51], a[32:35], v[192:207]
    ds_read_b64_tr_b16 a[26:27], v7 offset:2048
    ds_read_b128 a[4:7], v2 offset:24576
    buffer_load_dwordx4 v17, s[12:15], s40 offen offset:0 lds
    v_mfma_f32_32x32x16_bf16 v[208:223], a[48:51], a[36:39], v[208:223]
    ds_read_b128 a[8:11], v2 offset:28672
    ds_read_b128 a[12:15], v2 offset:32768
    v_mfma_f32_32x32x16_bf16 v[128:143], a[52:55], a[36:39], v[128:143]
    ds_read_b128 a[16:19], v2 offset:36864
    buffer_load_dwordx4 v18, s[12:15], s40 offen offset:1024 lds
    v_mfma_f32_32x32x16_bf16 v[144:159], a[52:55], a[40:43], v[144:159]
    v_mfma_f32_32x32x16_bf16 v[224:239], a[48:51], a[40:43], v[224:239]
    v_mfma_f32_32x32x16_bf16 v[240:255], a[48:51], a[44:47], v[240:255]
    buffer_load_dwordx4 v19, s[12:15], s40 offen offset:2048 lds
    v_mfma_f32_32x32x16_bf16 v[160:175], a[52:55], a[44:47], v[160:175]
    s_waitcnt lgkmcnt(0)
    v_mfma_f32_32x32x16_bf16 v[176:191], a[20:23], a[0:3], v[176:191]
    ds_read_b128 a[28:31], v3 offset:20480
    ds_read_b64_tr_b16 a[48:49], v6 offset:8192
    buffer_load_dwordx4 v20, s[12:15], s40 offen offset:3072 lds
    s_add_u32 m0, s35, 49152
    s_add_u32 s40, s40, 122880
    v_mfma_f32_32x32x16_bf16 v[96:111], a[24:27], a[0:3], v[96:111]
    ds_read_b64_tr_b16 a[50:51], v6 offset:10240
    ds_read_b64_tr_b16 a[52:53], v7 offset:8192
    v_mfma_f32_32x32x16_bf16 v[112:127], a[24:27], a[4:7], v[112:127]
    ds_read_b64_tr_b16 a[54:55], v7 offset:10240
    ds_read_b128 a[32:35], v3 offset:24576
    v_mfma_f32_32x32x16_bf16 v[192:207], a[20:23], a[4:7], v[192:207]
    ds_read_b128 a[36:39], v3 offset:28672
    ds_read_b128 a[40:43], v3 offset:32768
    v_mfma_f32_32x32x16_bf16 v[208:223], a[20:23], a[8:11], v[208:223]
    ds_read_b128 a[44:47], v3 offset:36864
    v_mfma_f32_32x32x16_bf16 v[128:143], a[24:27], a[8:11], v[128:143]
    buffer_load_dwordx4 v17, s[12:15], s40 offen offset:0 lds
    v_mfma_f32_32x32x16_bf16 v[144:159], a[24:27], a[12:15], v[144:159]
    v_mfma_f32_32x32x16_bf16 v[224:239], a[20:23], a[12:15], v[224:239]
    v_mfma_f32_32x32x16_bf16 v[240:255], a[20:23], a[16:19], v[240:255]
    buffer_load_dwordx4 v18, s[12:15], s40 offen offset:1024 lds
    v_mfma_f32_32x32x16_bf16 v[160:175], a[24:27], a[16:19], v[160:175]
    s_waitcnt lgkmcnt(0)
    v_mfma_f32_32x32x16_bf16 v[176:191], a[48:51], a[28:31], v[176:191]
    s_waitcnt vmcnt(11) lgkmcnt(0)
    s_barrier
    v_mfma_f32_32x32x16_bf16 v[96:111], a[52:55], a[28:31], v[96:111]
    ds_read_b128 a[0:3], v4 offset:20480
    ds_read_b64_tr_b16 a[20:21], v6 offset:16384
    buffer_load_dwordx4 v19, s[12:15], s40 offen offset:2048 lds
    v_mfma_f32_32x32x16_bf16 v[112:127], a[52:55], a[32:35], v[112:127]
    ds_read_b64_tr_b16 a[22:23], v6 offset:18432
    ds_read_b64_tr_b16 a[24:25], v7 offset:16384
    v_mfma_f32_32x32x16_bf16 v[192:207], a[48:51], a[32:35], v[192:207]
    ds_read_b64_tr_b16 a[26:27], v7 offset:18432
    ds_read_b128 a[4:7], v4 offset:24576
    v_mfma_f32_32x32x16_bf16 v[208:223], a[48:51], a[36:39], v[208:223]
    ds_read_b128 a[8:11], v4 offset:28672
    ds_read_b128 a[12:15], v4 offset:32768
    buffer_load_dwordx4 v20, s[12:15], s40 offen offset:3072 lds
    s_cmp_ge_u32 s27, 6
    s_cselect_b32 s38, 5, 6
    v_mfma_f32_32x32x16_bf16 v[128:143], a[52:55], a[36:39], v[128:143]
    ds_read_b128 a[16:19], v4 offset:36864
    buffer_store_dword v35, v23, s[20:23], s82 offen sc0 sc1
    s_lshl_b32 s38, s38, 7
    s_add_u32 s39, s38, s33
    v_mfma_f32_32x32x16_bf16 v[144:159], a[52:55], a[40:43], v[144:159]
    s_add_u32 m0, s36, 0
    s_add_u32 s38, s38, s32
    v_mfma_f32_32x32x16_bf16 v[224:239], a[48:51], a[40:43], v[224:239]
    v_mfma_f32_32x32x16_bf16 v[240:255], a[48:51], a[44:47], v[240:255]
    buffer_load_dwordx4 v12, s[8:11], s38 offen offset:0 lds
    v_mfma_f32_32x32x16_bf16 v[160:175], a[52:55], a[44:47], v[160:175]
    s_waitcnt lgkmcnt(0)
    v_mfma_f32_32x32x16_bf16 v[176:191], a[20:23], a[0:3], v[176:191]
    ds_read_b128 a[28:31], v5 offset:20480
    ds_read_b64_tr_b16 a[48:49], v6 offset:24576
    buffer_load_dwordx4 v13, s[8:11], s38 offen offset:1024 lds
    v_mfma_f32_32x32x16_bf16 v[96:111], a[24:27], a[0:3], v[96:111]
    ds_read_b64_tr_b16 a[50:51], v6 offset:26624
    ds_read_b64_tr_b16 a[52:53], v7 offset:24576
    v_mfma_f32_32x32x16_bf16 v[112:127], a[24:27], a[4:7], v[112:127]
    ds_read_b64_tr_b16 a[54:55], v7 offset:26624
    ds_read_b128 a[32:35], v5 offset:24576
    v_mfma_f32_32x32x16_bf16 v[192:207], a[20:23], a[4:7], v[192:207]
    ds_read_b128 a[36:39], v5 offset:28672
    ds_read_b128 a[40:43], v5 offset:32768
    buffer_load_dwordx4 v14, s[8:11], s38 offen offset:2048 lds
    v_mfma_f32_32x32x16_bf16 v[208:223], a[20:23], a[8:11], v[208:223]
    ds_read_b128 a[44:47], v5 offset:36864
    v_mfma_f32_32x32x16_bf16 v[128:143], a[24:27], a[8:11], v[128:143]
    buffer_load_dwordx4 v15, s[8:11], s38 offen offset:3072 lds
    s_add_u32 m0, s37, 0
    s_nop 0
    v_mfma_f32_32x32x16_bf16 v[144:159], a[24:27], a[12:15], v[144:159]
    v_mfma_f32_32x32x16_bf16 v[224:239], a[20:23], a[12:15], v[224:239]
    buffer_load_dwordx4 v16, s[8:11], s39 offen lds
    s_cmp_ge_u32 s27, 6
    s_cselect_b32 s40, 5, 6
    s_mul_i32 s40, s40, 245760
    v_mfma_f32_32x32x16_bf16 v[240:255], a[20:23], a[16:19], v[240:255]
    s_add_u32 m0, s35, 0
    s_add_u32 s40, s40, s34
    buffer_load_dwordx4 v17, s[12:15], s40 offen offset:0 lds
    v_mfma_f32_32x32x16_bf16 v[160:175], a[24:27], a[16:19], v[160:175]
    s_waitcnt lgkmcnt(0)
    v_mfma_f32_32x32x16_bf16 v[176:191], a[48:51], a[28:31], v[176:191]
    s_waitcnt vmcnt(11) lgkmcnt(0)
    s_barrier
    v_mfma_f32_32x32x16_bf16 v[96:111], a[52:55], a[28:31], v[96:111]
    ds_read_b128 a[0:3], v2 offset:40960
    ds_read_b64_tr_b16 a[20:21], v8 offset:0
    buffer_load_dwordx4 v18, s[12:15], s40 offen offset:1024 lds
    v_mfma_f32_32x32x16_bf16 v[112:127], a[52:55], a[32:35], v[112:127]
    ds_read_b64_tr_b16 a[22:23], v8 offset:2048
    ds_read_b64_tr_b16 a[24:25], v9 offset:0
    v_mfma_f32_32x32x16_bf16 v[192:207], a[48:51], a[32:35], v[192:207]
    ds_read_b64_tr_b16 a[26:27], v9 offset:2048
    ds_read_b128 a[4:7], v2 offset:45056
    v_mfma_f32_32x32x16_bf16 v[208:223], a[48:51], a[36:39], v[208:223]
    ds_read_b128 a[8:11], v2 offset:49152
    ds_read_b128 a[12:15], v2 offset:53248
    v_mfma_f32_32x32x16_bf16 v[128:143], a[52:55], a[36:39], v[128:143]
    ds_read_b128 a[16:19], v2 offset:57344
    buffer_load_dwordx4 v19, s[12:15], s40 offen offset:2048 lds
    v_mfma_f32_32x32x16_bf16 v[144:159], a[52:55], a[40:43], v[144:159]
    v_mfma_f32_32x32x16_bf16 v[224:239], a[48:51], a[40:43], v[224:239]
    v_mfma_f32_32x32x16_bf16 v[240:255], a[48:51], a[44:47], v[240:255]
    buffer_load_dwordx4 v20, s[12:15], s40 offen offset:3072 lds
    s_add_u32 m0, s35, 16384
    s_add_u32 s40, s40, 122880
    v_mfma_f32_32x32x16_bf16 v[160:175], a[52:55], a[44:47], v[160:175]
    s_waitcnt lgkmcnt(0)
    v_mfma_f32_32x32x16_bf16 v[176:191], a[20:23], a[0:3], v[176:191]
    ds_read_b128 a[28:31], v3 offset:40960
    ds_read_b64_tr_b16 a[48:49], v8 offset:8192
    v_mfma_f32_32x32x16_bf16 v[96:111], a[24:27], a[0:3], v[96:111]
    ds_read_b64_tr_b16 a[50:51], v8 offset:10240
    ds_read_b64_tr_b16 a[52:53], v9 offset:8192
    buffer_load_dwordx4 v17, s[12:15], s40 offen offset:0 lds
    v_mfma_f32_32x32x16_bf16 v[112:127], a[24:27], a[4:7], v[112:127]
    ds_read_b64_tr_b16 a[54:55], v9 offset:10240
    ds_read_b128 a[32:35], v3 offset:45056
    v_mfma_f32_32x32x16_bf16 v[192:207], a[20:23], a[4:7], v[192:207]
    ds_read_b128 a[36:39], v3 offset:49152
    ds_read_b128 a[40:43], v3 offset:53248
    v_mfma_f32_32x32x16_bf16 v[208:223], a[20:23], a[8:11], v[208:223]
    ds_read_b128 a[44:47], v3 offset:57344
    v_mfma_f32_32x32x16_bf16 v[128:143], a[24:27], a[8:11], v[128:143]
    buffer_load_dwordx4 v18, s[12:15], s40 offen offset:1024 lds
    v_mfma_f32_32x32x16_bf16 v[144:159], a[24:27], a[12:15], v[144:159]
    v_mfma_f32_32x32x16_bf16 v[224:239], a[20:23], a[12:15], v[224:239]
    v_mfma_f32_32x32x16_bf16 v[240:255], a[20:23], a[16:19], v[240:255]
    buffer_load_dwordx4 v19, s[12:15], s40 offen offset:2048 lds
    v_mfma_f32_32x32x16_bf16 v[160:175], a[24:27], a[16:19], v[160:175]
    s_waitcnt lgkmcnt(0)
    v_mfma_f32_32x32x16_bf16 v[176:191], a[48:51], a[28:31], v[176:191]
    s_waitcnt vmcnt(13) lgkmcnt(0)
    s_barrier
    v_mfma_f32_32x32x16_bf16 v[96:111], a[52:55], a[28:31], v[96:111]
    ds_read_b128 a[0:3], v4 offset:40960
    ds_read_b64_tr_b16 a[20:21], v8 offset:16384
    buffer_load_dwordx4 v20, s[12:15], s40 offen offset:3072 lds
    s_cmp_ge_u32 s27, 7
    s_cselect_b32 s38, 6, 7
    v_mfma_f32_32x32x16_bf16 v[112:127], a[52:55], a[32:35], v[112:127]
    ds_read_b64_tr_b16 a[22:23], v8 offset:18432
    ds_read_b64_tr_b16 a[24:25], v9 offset:16384
    s_lshl_b32 s38, s38, 7
    s_add_u32 s39, s38, s33
    v_mfma_f32_32x32x16_bf16 v[192:207], a[48:51], a[32:35], v[192:207]
    ds_read_b64_tr_b16 a[26:27], v9 offset:18432
    ds_read_b128 a[4:7], v4 offset:45056
    s_add_u32 m0, s36, 20480
    s_add_u32 s38, s38, s32
    v_mfma_f32_32x32x16_bf16 v[208:223], a[48:51], a[36:39], v[208:223]
    ds_read_b128 a[8:11], v4 offset:49152
    ds_read_b128 a[12:15], v4 offset:53248
    buffer_load_dwordx4 v12, s[8:11], s38 offen offset:0 lds
    v_mfma_f32_32x32x16_bf16 v[128:143], a[52:55], a[36:39], v[128:143]
    ds_read_b128 a[16:19], v4 offset:57344
    v_mfma_f32_32x32x16_bf16 v[144:159], a[52:55], a[40:43], v[144:159]
    v_mfma_f32_32x32x16_bf16 v[224:239], a[48:51], a[40:43], v[224:239]
    buffer_load_dwordx4 v13, s[8:11], s38 offen offset:1024 lds
    v_mfma_f32_32x32x16_bf16 v[240:255], a[48:51], a[44:47], v[240:255]
    v_mfma_f32_32x32x16_bf16 v[160:175], a[52:55], a[44:47], v[160:175]
    buffer_load_dwordx4 v14, s[8:11], s38 offen offset:2048 lds
    s_waitcnt lgkmcnt(0)
    v_mfma_f32_32x32x16_bf16 v[176:191], a[20:23], a[0:3], v[176:191]
    ds_read_b128 a[28:31], v5 offset:40960
    ds_read_b64_tr_b16 a[48:49], v8 offset:24576
    v_mfma_f32_32x32x16_bf16 v[96:111], a[24:27], a[0:3], v[96:111]
    ds_read_b64_tr_b16 a[50:51], v8 offset:26624
    ds_read_b64_tr_b16 a[52:53], v9 offset:24576
    buffer_load_dwordx4 v15, s[8:11], s38 offen offset:3072 lds
    s_add_u32 m0, s37, 20480
    s_nop 0
    v_mfma_f32_32x32x16_bf16 v[112:127], a[24:27], a[4:7], v[112:127]
    ds_read_b64_tr_b16 a[54:55], v9 offset:26624
    ds_read_b128 a[32:35], v5 offset:45056
    v_mfma_f32_32x32x16_bf16 v[192:207], a[20:23], a[4:7], v[192:207]
    ds_read_b128 a[36:39], v5 offset:49152
    ds_read_b128 a[40:43], v5 offset:53248
    buffer_load_dwordx4 v16, s[8:11], s39 offen lds
    s_cmp_ge_u32 s27, 7
    s_cselect_b32 s40, 6, 7
    v_mfma_f32_32x32x16_bf16 v[208:223], a[20:23], a[8:11], v[208:223]
    ds_read_b128 a[44:47], v5 offset:57344
    s_mul_i32 s40, s40, 245760
    s_add_u32 m0, s35, 32768
    s_add_u32 s40, s40, s34
    v_mfma_f32_32x32x16_bf16 v[128:143], a[24:27], a[8:11], v[128:143]
    buffer_load_dwordx4 v17, s[12:15], s40 offen offset:0 lds
    v_mfma_f32_32x32x16_bf16 v[144:159], a[24:27], a[12:15], v[144:159]
    v_mfma_f32_32x32x16_bf16 v[224:239], a[20:23], a[12:15], v[224:239]
    buffer_load_dwordx4 v18, s[12:15], s40 offen offset:1024 lds
    v_mfma_f32_32x32x16_bf16 v[240:255], a[20:23], a[16:19], v[240:255]
    v_mfma_f32_32x32x16_bf16 v[160:175], a[24:27], a[16:19], v[160:175]
    s_waitcnt lgkmcnt(0)
    v_mfma_f32_32x32x16_bf16 v[176:191], a[48:51], a[28:31], v[176:191]
    s_waitcnt vmcnt(11) lgkmcnt(0)
    s_barrier
    v_mfma_f32_32x32x16_bf16 v[96:111], a[52:55], a[28:31], v[96:111]
    ds_read_b128 a[0:3], v2 offset:0
    ds_read_b64_tr_b16 a[20:21], v6 offset:0
    buffer_load_dwordx4 v19, s[12:15], s40 offen offset:2048 lds
    s_lshl_b32 s30, s25, 15
    v_mfma_f32_32x32x16_bf16 v[112:127], a[52:55], a[32:35], v[112:127]
    ds_read_b64_tr_b16 a[22:23], v6 offset:2048
    ds_read_b64_tr_b16 a[24:25], v7 offset:0
    s_lshl_b32 s31, s26, 7
    s_add_u32 s30, s30, s31
    v_mfma_f32_32x32x16_bf16 v[192:207], a[48:51], a[32:35], v[192:207]
    ds_read_b64_tr_b16 a[26:27], v7 offset:2048
    ds_read_b128 a[4:7], v2 offset:4096
    s_add_u32 s53, s30, 11976704
    v_mfma_f32_32x32x16_bf16 v[208:223], a[48:51], a[36:39], v[208:223]
    ds_read_b128 a[8:11], v2 offset:8192
    ds_read_b128 a[12:15], v2 offset:12288
    buffer_load_dwordx4 v20, s[12:15], s40 offen offset:3072 lds
    s_add_u32 m0, s35, 49152
    s_add_u32 s40, s40, 122880
    v_mfma_f32_32x32x16_bf16 v[128:143], a[52:55], a[36:39], v[128:143]
    ds_read_b128 a[16:19], v2 offset:16384
    v_mfma_f32_32x32x16_bf16 v[144:159], a[52:55], a[40:43], v[144:159]
    v_mfma_f32_32x32x16_bf16 v[224:239], a[48:51], a[40:43], v[224:239]
    buffer_load_dwordx4 v17, s[12:15], s40 offen offset:0 lds
    v_mfma_f32_32x32x16_bf16 v[240:255], a[48:51], a[44:47], v[240:255]
    v_mfma_f32_32x32x16_bf16 v[160:175], a[52:55], a[44:47], v[160:175]
    s_waitcnt lgkmcnt(0)
    v_mfma_f32_32x32x16_bf16 v[176:191], a[20:23], a[0:3], v[176:191]
    ds_read_b128 a[28:31], v3 offset:0
    ds_read_b64_tr_b16 a[48:49], v6 offset:8192
    v_mfma_f32_32x32x16_bf16 v[96:111], a[24:27], a[0:3], v[96:111]
    ds_read_b64_tr_b16 a[50:51], v6 offset:10240
    ds_read_b64_tr_b16 a[52:53], v7 offset:8192
    buffer_load_dwordx4 v18, s[12:15], s40 offen offset:1024 lds
    v_mfma_f32_32x32x16_bf16 v[112:127], a[24:27], a[4:7], v[112:127]
    ds_read_b64_tr_b16 a[54:55], v7 offset:10240
    ds_read_b128 a[32:35], v3 offset:4096
    v_mfma_f32_32x32x16_bf16 v[192:207], a[20:23], a[4:7], v[192:207]
    ds_read_b128 a[36:39], v3 offset:8192
    ds_read_b128 a[40:43], v3 offset:12288
    v_mfma_f32_32x32x16_bf16 v[208:223], a[20:23], a[8:11], v[208:223]
    ds_read_b128 a[44:47], v3 offset:16384
    buffer_load_dwordx4 v19, s[12:15], s40 offen offset:2048 lds
    v_mfma_f32_32x32x16_bf16 v[128:143], a[24:27], a[8:11], v[128:143]
    v_mfma_f32_32x32x16_bf16 v[144:159], a[24:27], a[12:15], v[144:159]
    v_mfma_f32_32x32x16_bf16 v[224:239], a[20:23], a[12:15], v[224:239]
    buffer_load_dwordx4 v20, s[12:15], s40 offen offset:3072 lds
    s_cmp_ge_u32 s27, 8
    s_cselect_b32 s38, 7, 8
    s_lshl_b32 s38, s38, 7
    v_mfma_f32_32x32x16_bf16 v[240:255], a[20:23], a[16:19], v[240:255]
    s_add_u32 s39, s38, s33
    s_add_u32 m0, s36, 40960
    s_add_u32 s38, s38, s32
    v_mfma_f32_32x32x16_bf16 v[160:175], a[24:27], a[16:19], v[160:175]
    s_waitcnt lgkmcnt(0)
    v_mfma_f32_32x32x16_bf16 v[176:191], a[48:51], a[28:31], v[176:191]
    s_waitcnt vmcnt(13) lgkmcnt(0)
    s_barrier
    v_mfma_f32_32x32x16_bf16 v[96:111], a[52:55], a[28:31], v[96:111]
    ds_read_b128 a[0:3], v4 offset:0
    ds_read_b64_tr_b16 a[20:21], v6 offset:16384
    buffer_load_dwordx4 v12, s[8:11], s38 offen offset:0 lds
    v_mfma_f32_32x32x16_bf16 v[112:127], a[52:55], a[32:35], v[112:127]
    ds_read_b64_tr_b16 a[22:23], v6 offset:18432
    ds_read_b64_tr_b16 a[24:25], v7 offset:16384
    v_mfma_f32_32x32x16_bf16 v[192:207], a[48:51], a[32:35], v[192:207]
    ds_read_b64_tr_b16 a[26:27], v7 offset:18432
    ds_read_b128 a[4:7], v4 offset:4096
    buffer_load_dwordx4 v13, s[8:11], s38 offen offset:1024 lds
    v_mfma_f32_32x32x16_bf16 v[208:223], a[48:51], a[36:39], v[208:223]
    ds_read_b128 a[8:11], v4 offset:8192
    ds_read_b128 a[12:15], v4 offset:12288
    v_mfma_f32_32x32x16_bf16 v[128:143], a[52:55], a[36:39], v[128:143]
    ds_read_b128 a[16:19], v4 offset:16384
    s_cmp_eq_u32 s24, 0
    s_cselect_b32 s82, 0, 2146435072
    v_lshlrev_b32 v52, 2, v1
    v_add_u32 v52, s82, v52
    v_mfma_f32_32x32x16_bf16 v[144:159], a[52:55], a[40:43], v[144:159]
    s_mov_b32 s4, -1
    s_cmp_lg_u32 s25, 0
    s_cselect_b32 s5, 3, 0
    s_lshl_b32 s82, s83, 8
    s_add_u32 s82, s82, 12500992
    v_mfma_f32_32x32x16_bf16 v[224:239], a[48:51], a[40:43], v[224:239]
    buffer_load_dword v48, v52, s[20:23], s82 offen sc1 nt
    v_mfma_f32_32x32x16_bf16 v[240:255], a[48:51], a[44:47], v[240:255]
    buffer_load_dwordx4 v14, s[8:11], s38 offen offset:2048 lds
    v_mfma_f32_32x32x16_bf16 v[160:175], a[52:55], a[44:47], v[160:175]
    buffer_load_dwordx4 v15, s[8:11], s38 offen offset:3072 lds
    s_add_u32 m0, s37, 40960
    s_nop 0
    s_waitcnt lgkmcnt(0)
    v_mfma_f32_32x32x16_bf16 v[176:191], a[20:23], a[0:3], v[176:191]
    ds_read_b128 a[28:31], v5 offset:0
    ds_read_b64_tr_b16 a[48:49], v6 offset:24576
    v_mfma_f32_32x32x16_bf16 v[96:111], a[24:27], a[0:3], v[96:111]
    ds_read_b64_tr_b16 a[50:51], v6 offset:26624
    ds_read_b64_tr_b16 a[52:53], v7 offset:24576
    buffer_load_dwordx4 v16, s[8:11], s39 offen lds
    s_cmp_ge_u32 s27, 8
    s_cselect_b32 s40, 7, 8
    v_mfma_f32_32x32x16_bf16 v[112:127], a[24:27], a[4:7], v[112:127]
    ds_read_b64_tr_b16 a[54:55], v7 offset:26624
    ds_read_b128 a[32:35], v5 offset:4096
    s_mul_i32 s40, s40, 245760
    s_add_u32 m0, s35, 0
    s_add_u32 s40, s40, s34
    v_mfma_f32_32x32x16_bf16 v[192:207], a[20:23], a[4:7], v[192:207]
    ds_read_b128 a[36:39], v5 offset:8192
    ds_read_b128 a[40:43], v5 offset:12288
    buffer_load_dwordx4 v17, s[12:15], s40 offen offset:0 lds
    v_mfma_f32_32x32x16_bf16 v[208:223], a[20:23], a[8:11], v[208:223]
    ds_read_b128 a[44:47], v5 offset:16384
    v_mfma_f32_32x32x16_bf16 v[128:143], a[24:27], a[8:11], v[128:143]
    buffer_load_dwordx4 v18, s[12:15], s40 offen offset:1024 lds
    v_mfma_f32_32x32x16_bf16 v[144:159], a[24:27], a[12:15], v[144:159]
    v_mfma_f32_32x32x16_bf16 v[224:239], a[20:23], a[12:15], v[224:239]
    v_mfma_f32_32x32x16_bf16 v[240:255], a[20:23], a[16:19], v[240:255]
    v_mfma_f32_32x32x16_bf16 v[160:175], a[24:27], a[16:19], v[160:175]
    buffer_load_dwordx4 v19, s[12:15], s40 offen offset:2048 lds
    s_waitcnt lgkmcnt(0)
    v_mfma_f32_32x32x16_bf16 v[176:191], a[48:51], a[28:31], v[176:191]
    s_waitcnt vmcnt(6) lgkmcnt(0)
    s_cmp_lg_u32 s24, 0
    s_cbranch_scc1 LA_ok
    v_cmp_ne_u32 vcc, s52, v48
    s_and_b64 vcc, vcc, s[4:5]
    s_cbranch_scc1 LA_slow
LA_ok:
    s_barrier
    v_mfma_f32_32x32x16_bf16 v[96:111], a[52:55], a[28:31], v[96:111]
    ds_read_b128 a[0:3], v2 offset:20480
    ds_read_b64_tr_b16 a[20:21], v8 offset:0
    v_and_b32 v59, 31, v1
    s_lshl_b32 s28, s25, 7
    v_mfma_f32_32x32x16_bf16 v[112:127], a[52:55], a[32:35], v[112:127]
    ds_read_b64_tr_b16 a[22:23], v8 offset:2048
    ds_read_b64_tr_b16 a[24:25], v9 offset:0
    buffer_load_dwordx4 v20, s[12:15], s40 offen offset:3072 lds
    s_add_u32 m0, s35, 16384
    s_add_u32 s40, s40, 122880
    v_mfma_f32_32x32x16_bf16 v[192:207], a[48:51], a[32:35], v[192:207]
    ds_read_b64_tr_b16 a[26:27], v9 offset:2048
    ds_read_b128 a[4:7], v2 offset:24576
    v_add_u32 v59, s28, v59
    v_subrev_u32 v61, 32, v59
    v_mfma_f32_32x32x16_bf16 v[208:223], a[48:51], a[36:39], v[208:223]
    ds_read_b128 a[8:11], v2 offset:28672
    ds_read_b128 a[12:15], v2 offset:32768
    v_max_i32 v61, 0, v61
    v_lshlrev_b32 v61, 4, v61
    v_mfma_f32_32x32x16_bf16 v[128:143], a[52:55], a[36:39], v[128:143]
    ds_read_b128 a[16:19], v2 offset:36864
    v_cmp_gt_u32 vcc, 32, v0
    v_lshrrev_b32 v60, 5, v0
    v_mul_u32_u24 v60, 32640, v60
    v_lshl_add_u32 v23, v0, 2, v60
    v_mov_b32 v60, 2146435072
    v_cndmask_b32 v23, v60, v23, vcc
    v_mfma_f32_32x32x16_bf16 v[144:159], a[52:55], a[40:43], v[144:159]
    s_lshl_b32 s3, s43, 3
    s_add_u32 s3, s3, s44
    s_lshl_b32 s3, s3, 7
    s_add_u32 s3, s3, 12566528
    v_mfma_f32_32x32x16_bf16 v[224:239], a[48:51], a[40:43], v[224:239]
    buffer_load_dword v60, v23, s[20:23], s3 offen sc1 nt
    v_lshlrev_b32 v59, 4, v59
    s_mov_b32 s28, 11698176
    v_mfma_f32_32x32x16_bf16 v[240:255], a[48:51], a[44:47], v[240:255]
    buffer_load_dwordx4 v17, s[12:15], s40 offen offset:0 lds
    v_mfma_f32_32x32x16_bf16 v[160:175], a[52:55], a[44:47], v[160:175]
    buffer_load_dwordx4 v[28:31], v61, s[20:23], s28 offen sc1
    s_waitcnt lgkmcnt(0)
    v_mfma_f32_32x32x16_bf16 v[176:191], a[20:23], a[0:3], v[176:191]
    ds_read_b128 a[28:31], v3 offset:20480
    ds_read_b64_tr_b16 a[48:49], v8 offset:8192
    buffer_load_dwordx4 v18, s[12:15], s40 offen offset:1024 lds
    v_mfma_f32_32x32x16_bf16 v[96:111], a[24:27], a[0:3], v[96:111]
    ds_read_b64_tr_b16 a[50:51], v8 offset:10240
    ds_read_b64_tr_b16 a[52:53], v9 offset:8192
    buffer_load_dwordx4 v[32:35], v59, s[20:23], s28 offen offset:0 sc1
    v_mfma_f32_32x32x16_bf16 v[112:127], a[24:27], a[4:7], v[112:127]
    ds_read_b64_tr_b16 a[54:55], v9 offset:10240
    ds_read_b128 a[32:35], v3 offset:24576
    buffer_load_dwordx4 v[36:39], v59, s[20:23], s28 offen offset:512 sc1
    v_mfma_f32_32x32x16_bf16 v[192:207], a[20:23], a[4:7], v[192:207]
    ds_read_b128 a[36:39], v3 offset:28672
    ds_read_b128 a[40:43], v3 offset:32768
    buffer_load_dwordx4 v[40:43], v59, s[20:23], s28 offen offset:1024 sc1
    v_mfma_f32_32x32x16_bf16 v[208:223], a[20:23], a[8:11], v[208:223]
    ds_read_b128 a[44:47], v3 offset:36864
    buffer_load_dwordx4 v[44:47], v59, s[20:23], s28 offen offset:1536 sc1
    v_and_b32 v59, 31, v1
    v_lshrrev_b32 v61, 5, v1
    v_mfma_f32_32x32x16_bf16 v[128:143], a[24:27], a[8:11], v[128:143]
    v_mul_u32_u24 v61, 7680, v61
    v_lshl_add_u32 v59, v59, 2, v61
    buffer_load_dword v64, v59, s[20:23], s54 offen offset:0 sc1
    v_mfma_f32_32x32x16_bf16 v[144:159], a[24:27], a[12:15], v[144:159]
    buffer_load_dwordx4 v19, s[12:15], s40 offen offset:2048 lds
    v_mfma_f32_32x32x16_bf16 v[224:239], a[20:23], a[12:15], v[224:239]
    buffer_load_dword v69, v59, s[20:23], s54 offen offset:128 sc1
    v_mfma_f32_32x32x16_bf16 v[240:255], a[20:23], a[16:19], v[240:255]
    buffer_load_dword v65, v59, s[20:23], s54 offen offset:1536 sc1
    v_mfma_f32_32x32x16_bf16 v[160:175], a[24:27], a[16:19], v[160:175]
    buffer_load_dword v70, v59, s[20:23], s54 offen offset:1664 sc1
    s_add_u32 s54, s54, 3072
    s_waitcnt lgkmcnt(0)
    v_mfma_f32_32x32x16_bf16 v[176:191], a[48:51], a[28:31], v[176:191]
    s_waitcnt vmcnt(12) lgkmcnt(0)
    s_cmp_lg_u32 s24, 0
    s_cbranch_scc1 LA_okw
    v_cmp_ne_u32 vcc, s52, v60
    s_and_b32 vcc_lo, vcc_lo, 0x0fff0fff
    s_cbranch_scc1 LA_sloww
LA_okw:
    s_barrier
    v_mfma_f32_32x32x16_bf16 v[96:111], a[52:55], a[28:31], v[96:111]
    ds_read_b128 a[0:3], v4 offset:20480
    ds_read_b64_tr_b16 a[20:21], v8 offset:16384
    buffer_load_dwordx4 v20, s[12:15], s40 offen offset:3072 lds
    s_cmp_ge_u32 s27, 9
    s_cselect_b32 s38, 8, 9
    v_mfma_f32_32x32x16_bf16 v[112:127], a[52:55], a[32:35], v[112:127]
    ds_read_b64_tr_b16 a[22:23], v8 offset:18432
    ds_read_b64_tr_b16 a[24:25], v9 offset:16384
    s_lshl_b32 s38, s38, 7
    s_add_u32 s39, s38, s33
    v_mfma_f32_32x32x16_bf16 v[192:207], a[48:51], a[32:35], v[192:207]
    ds_read_b64_tr_b16 a[26:27], v9 offset:18432
    ds_read_b128 a[4:7], v4 offset:24576
    s_add_u32 m0, s36, 0
    s_add_u32 s38, s38, s32
    v_mfma_f32_32x32x16_bf16 v[208:223], a[48:51], a[36:39], v[208:223]
    ds_read_b128 a[8:11], v4 offset:28672
    ds_read_b128 a[12:15], v4 offset:32768
    buffer_load_dwordx4 v12, s[8:11], s38 offen offset:0 lds
    v_mfma_f32_32x32x16_bf16 v[128:143], a[52:55], a[36:39], v[128:143]
    ds_read_b128 a[16:19], v4 offset:36864
    buffer_load_dword v66, v59, s[20:23], s54 offen offset:0 sc1
    v_mfma_f32_32x32x16_bf16 v[144:159], a[52:55], a[40:43], v[144:159]
    buffer_load_dword v71, v59, s[20:23], s54 offen offset:128 sc1
    v_mfma_f32_32x32x16_bf16 v[224:239], a[48:51], a[40:43], v[224:239]
    buffer_load_dword v67, v59, s[20:23], s54 offen offset:1536 sc1
    v_mfma_f32_32x32x16_bf16 v[240:255], a[48:51], a[44:47], v[240:255]
    buffer_load_dwordx4 v13, s[8:11], s38 offen offset:1024 lds
    v_mfma_f32_32x32x16_bf16 v[160:175], a[52:55], a[44:47], v[160:175]
    buffer_load_dword v72, v59, s[20:23], s54 offen offset:1664 sc1
    s_add_u32 s54, s54, 3072
    s_waitcnt lgkmcnt(0)
    v_mfma_f32_32x32x16_bf16 v[176:191], a[20:23], a[0:3], v[176:191]
    ds_read_b128 a[28:31], v5 offset:20480
    ds_read_b64_tr_b16 a[48:49], v8 offset:24576
    buffer_load_dword v68, v59, s[20:23], s54 offen offset:0 sc1
    v_mfma_f32_32x32x16_bf16 v[96:111], a[24:27], a[0:3], v[96:111]
    ds_read_b64_tr_b16 a[50:51], v8 offset:26624
    ds_read_b64_tr_b16 a[52:53], v9 offset:24576
    buffer_load_dwordx4 v14, s[8:11], s38 offen offset:2048 lds
    v_mfma_f32_32x32x16_bf16 v[112:127], a[24:27], a[4:7], v[112:127]
    ds_read_b64_tr_b16 a[54:55], v9 offset:26624
    ds_read_b128 a[32:35], v5 offset:24576
    buffer_load_dword v73, v59, s[20:23], s54 offen offset:128 sc1
    v_mfma_f32_32x32x16_bf16 v[192:207], a[20:23], a[4:7], v[192:207]
    ds_read_b128 a[36:39], v5 offset:28672
    ds_read_b128 a[40:43], v5 offset:32768
    v_mfma_f32_32x32x16_bf16 v[208:223], a[20:23], a[8:11], v[208:223]
    ds_read_b128 a[44:47], v5 offset:36864
    buffer_load_dwordx4 v15, s[8:11], s38 offen offset:3072 lds
    s_add_u32 m0, s37, 0
    s_nop 0
    v_mfma_f32_32x32x16_bf16 v[128:143], a[24:27], a[8:11], v[128:143]
    v_mfma_f32_32x32x16_bf16 v[144:159], a[24:27], a[12:15], v[144:159]
    buffer_load_dwordx4 v16, s[8:11], s39 offen lds
    s_cmp_ge_u32 s27, 9
    s_cselect_b32 s40, 8, 9
    s_mul_i32 s40, s40, 245760
    v_mfma_f32_32x32x16_bf16 v[224:239], a[20:23], a[12:15], v[224:239]
    s_add_u32 m0, s35, 32768
    s_add_u32 s40, s40, s34
    buffer_load_dwordx4 v17, s[12:15], s40 offen offset:0 lds
    v_mfma_f32_32x32x16_bf16 v[240:255], a[20:23], a[16:19], v[240:255]
    v_mfma_f32_32x32x16_bf16 v[160:175], a[24:27], a[16:19], v[160:175]
    s_waitcnt lgkmcnt(0)
    v_mfma_f32_32x32x16_bf16 v[176:191], a[48:51], a[28:31], v[176:191]
    s_waitcnt lgkmcnt(0)
    s_barrier
    v_mfma_f32_32x32x16_bf16 v[96:111], a[52:55], a[28:31], v[96:111]
    ds_read_b128 a[0:3], v2 offset:40960
    ds_read_b64_tr_b16 a[20:21], v6 offset:0
    buffer_load_dwordx4 v18, s[12:15], s40 offen offset:1024 lds
    v_mfma_f32_32x32x16_bf16 v[112:127], a[52:55], a[32:35], v[112:127]
    ds_read_b64_tr_b16 a[22:23], v6 offset:2048
    ds_read_b64_tr_b16 a[24:25], v7 offset:0
    v_mfma_f32_32x32x16_bf16 v[192:207], a[48:51], a[32:35], v[192:207]
    ds_read_b64_tr_b16 a[26:27], v7 offset:2048
    ds_read_b128 a[4:7], v2 offset:45056
    v_mfma_f32_32x32x16_bf16 v[208:223], a[48:51], a[36:39], v[208:223]
    ds_read_b128 a[8:11], v2 offset:49152
    ds_read_b128 a[12:15], v2 offset:53248
    buffer_load_dwordx4 v19, s[12:15], s40 offen offset:2048 lds
    v_mfma_f32_32x32x16_bf16 v[128:143], a[52:55], a[36:39], v[128:143]
    ds_read_b128 a[16:19], v2 offset:57344
    v_mfma_f32_32x32x16_bf16 v[144:159], a[52:55], a[40:43], v[144:159]
    v_mfma_f32_32x32x16_bf16 v[224:239], a[48:51], a[40:43], v[224:239]
    buffer_load_dwordx4 v20, s[12:15], s40 offen offset:3072 lds
    s_add_u32 m0, s35, 49152
    s_add_u32 s40, s40, 122880
    v_mfma_f32_32x32x16_bf16 v[240:255], a[48:51], a[44:47], v[240:255]
    v_mfma_f32_32x32x16_bf16 v[160:175], a[52:55], a[44:47], v[160:175]
    s_waitcnt lgkmcnt(0)
    v_mfma_f32_32x32x16_bf16 v[176:191], a[20:23], a[0:3], v[176:191]
    ds_read_b128 a[28:31], v3 offset:40960
    ds_read_b64_tr_b16 a[48:49], v6 offset:8192
    s_waitcnt vmcnt(6)
    v_add_f32 v64, v64, v65
    v_mfma_f32_32x32x16_bf16 v[96:111], a[24:27], a[0:3], v[96:111]
    ds_read_b64_tr_b16 a[50:51], v6 offset:10240
    ds_read_b64_tr_b16 a[52:53], v7 offset:8192
    buffer_load_dwordx4 v17, s[12:15], s40 offen offset:0 lds
    v_add_f32 v66, v66, v67
    v_mfma_f32_32x32x16_bf16 v[112:127], a[24:27], a[4:7], v[112:127]
    ds_read_b64_tr_b16 a[54:55], v7 offset:10240
    ds_read_b128 a[32:35], v3 offset:45056
    v_add_f32 v64, v64, v68
    v_add_f32 v64, v64, v66
    v_mfma_f32_32x32x16_bf16 v[192:207], a[20:23], a[4:7], v[192:207]
    ds_read_b128 a[36:39], v3 offset:49152
    ds_read_b128 a[40:43], v3 offset:53248
    v_and_b32 v65, s45, v64
    v_sub_f32 v64, v64, v65
    v_mfma_f32_32x32x16_bf16 v[208:223], a[20:23], a[8:11], v[208:223]
    ds_read_b128 a[44:47], v3 offset:57344
    buffer_load_dwordx4 v18, s[12:15], s40 offen offset:1024 lds
    v_and_b32 v66, s45, v64
    v_sub_f32 v64, v64, v66
    v_mfma_f32_32x32x16_bf16 v[128:143], a[24:27], a[8:11], v[128:143]
    v_cvt_pk_bf16_f32 v24, v65, v66
    v_cvt_pk_bf16_f32 v25, v64, 0
    v_add_f32 v69, v69, v70
    v_add_f32 v71, v71, v72
    v_mfma_f32_32x32x16_bf16 v[144:159], a[24:27], a[12:15], v[144:159]
    v_add_f32 v69, v69, v73
    v_add_f32 v69, v69, v71
    v_and_b32 v70, s45, v69
    v_sub_f32 v69, v69, v70
    v_mfma_f32_32x32x16_bf16 v[224:239], a[20:23], a[12:15], v[224:239]
    buffer_load_dwordx4 v19, s[12:15], s40 offen offset:2048 lds
    v_and_b32 v71, s45, v69
    v_sub_f32 v69, v69, v71
    v_cvt_pk_bf16_f32 v26, v70, v71
    v_mfma_f32_32x32x16_bf16 v[240:255], a[20:23], a[16:19], v[240:255]
    v_cvt_pk_bf16_f32 v27, v69, 0
    v_mfma_f32_32x32x16_bf16 v[160:175], a[24:27], a[16:19], v[160:175]
    s_waitcnt lgkmcnt(0)
    v_mfma_f32_32x32x16_bf16 v[176:191], a[48:51], a[28:31], v[176:191]
    s_waitcnt lgkmcnt(0)
    s_barrier
    v_mfma_f32_32x32x16_bf16 v[96:111], a[52:55], a[28:31], v[96:111]
    ds_read_b128 a[0:3], v4 offset:40960
    ds_read_b64_tr_b16 a[20:21], v6 offset:16384
    buffer_load_dwordx4 v20, s[12:15], s40 offen offset:3072 lds
    s_cmp_ge_u32 s6, 12
    s_cselect_b32 s51, 12, 0
    s_sub_i32 s51, 0, s51
    s_mul_i32 s51, s51, 40960
    s_add_u32 s51, s51, s46
    v_mfma_f32_32x32x16_bf16 v[112:127], a[52:55], a[32:35], v[112:127]
    ds_read_b64_tr_b16 a[22:23], v6 offset:18432
    ds_read_b64_tr_b16 a[24:25], v7 offset:16384
    s_add_u32 s3, s24, 0
    s_and_b32 s3, s3, 3
    v_mfma_f32_32x32x16_bf16 v[192:207], a[48:51], a[32:35], v[192:207]
    ds_read_b64_tr_b16 a[26:27], v7 offset:18432
    ds_read_b128 a[4:7], v4 offset:45056
    s_lshl_b32 s60, s3, 10
    s_mul_i32 s4, s3, 30720
    v_mfma_f32_32x32x16_bf16 v[208:223], a[48:51], a[36:39], v[208:223]
    ds_read_b128 a[8:11], v4 offset:49152
    ds_read_b128 a[12:15], v4 offset:53248
    buffer_load_dwordx4 a[56:59], v62, s[20:23], s51 offen sc1
    s_add_u32 s3, s24, 1
    v_mfma_f32_32x32x16_bf16 v[128:143], a[52:55], a[36:39], v[128:143]
    ds_read_b128 a[16:19], v4 offset:57344
    s_and_b32 s3, s3, 3
    s_lshl_b32 s61, s3, 10
    s_mul_i32 s5, s3, 30720
    v_mfma_f32_32x32x16_bf16 v[144:159], a[52:55], a[40:43], v[144:159]
    buffer_load_dwordx4 a[60:63], v63, s[20:23], s51 offen offset:0 sc1
    s_add_u32 s3, s24, 2
    s_and_b32 s3, s3, 3
    s_lshl_b32 s62, s3, 10
    v_mfma_f32_32x32x16_bf16 v[224:239], a[48:51], a[40:43], v[224:239]
    s_mul_i32 s54, s3, 30720
    s_add_u32 s54, s54, 10240
    s_add_u32 s3, s24, 3
    s_and_b32 s3, s3, 3
    v_mfma_f32_32x32x16_bf16 v[240:255], a[48:51], a[44:47], v[240:255]
    buffer_load_dwordx4 a[64:67], v63, s[20:23], s51 offen offset:1024 sc1
    s_lshl_b32 s63, s3, 10
    s_mul_i32 s82, s3, 30720
    s_add_u32 s82, s82, 20480
    v_mfma_f32_32x32x16_bf16 v[160:175], a[52:55], a[44:47], v[160:175]
    s_cmp_ge_u32 s6, 12
    s_cselect_b32 s3, 49152, 0
    s_sub_u32 s12, s47, s3
    s_add_u32 s12, s12, 0
    s_waitcnt lgkmcnt(0)
    v_mfma_f32_32x32x16_bf16 v[176:191], a[20:23], a[0:3], v[176:191]
    ds_read_b128 a[28:31], v5 offset:40960
    ds_read_b64_tr_b16 a[48:49], v6 offset:24576
    buffer_load_dwordx4 a[68:71], v63, s[20:23], s51 offen offset:2048 sc1
    s_add_u32 s13, s12, 4096
    v_mfma_f32_32x32x16_bf16 v[96:111], a[24:27], a[0:3], v[96:111]
    ds_read_b64_tr_b16 a[50:51], v6 offset:26624
    ds_read_b64_tr_b16 a[52:53], v7 offset:24576
    s_add_u32 s14, s13, 4096
    s_cmp_ge_u32 s6, 9
    s_cselect_b32 s3, 49152, 0
    v_mfma_f32_32x32x16_bf16 v[112:127], a[24:27], a[4:7], v[112:127]
    ds_read_b64_tr_b16 a[54:55], v7 offset:26624
    ds_read_b128 a[32:35], v5 offset:45056
    buffer_load_dwordx4 a[72:75], v63, s[20:23], s51 offen offset:3072 sc1
    s_cmp_ge_u32 s6, 11
    s_cselect_b32 s51, 12, 0
    s_sub_i32 s51, 1, s51
    s_mul_i32 s51, s51, 40960
    s_add_u32 s51, s51, s46
    v_mfma_f32_32x32x16_bf16 v[192:207], a[20:23], a[4:7], v[192:207]
    ds_read_b128 a[36:39], v5 offset:49152
    ds_read_b128 a[40:43], v5 offset:53248
    s_sub_u32 s15, s47, s3
    s_add_u32 s15, s15, 12288
    v_mfma_f32_32x32x16_bf16 v[208:223], a[20:23], a[8:11], v[208:223]
    ds_read_b128 a[44:47], v5 offset:57344
    s_add_u32 s16, s15, 4096
    s_add_u32 s17, s16, 4096
    s_cmp_ge_u32 s6, 6
    s_cselect_b32 s3, 49152, 0
    v_mfma_f32_32x32x16_bf16 v[128:143], a[24:27], a[8:11], v[128:143]
    buffer_load_dwordx4 a[76:79], v62, s[20:23], s51 offen sc1
    s_sub_u32 s18, s47, s3
    s_add_u32 s18, s18, 24576
    s_add_u32 s19, s18, 4096
    v_mfma_f32_32x32x16_bf16 v[144:159], a[24:27], a[12:15], v[144:159]
    s_add_u32 s32, s19, 4096
    s_cmp_ge_u32 s6, 3
    s_cselect_b32 s3, 49152, 0
    s_sub_u32 s33, s47, s3
    v_mfma_f32_32x32x16_bf16 v[224:239], a[20:23], a[12:15], v[224:239]
    buffer_load_dwordx4 a[80:83], v63, s[20:23], s51 offen offset:0 sc1
    s_add_u32 s33, s33, 36864
    s_add_u32 s34, s33, 4096
    s_add_u32 s35, s34, 4096
    v_mfma_f32_32x32x16_bf16 v[240:255], a[20:23], a[16:19], v[240:255]
    s_cmp_ge_u32 s7, 5
    s_cselect_b32 s3, 20480, 0
    s_sub_u32 s36, s55, s3
    s_add_u32 s36, s36, 0
    v_mfma_f32_32x32x16_bf16 v[160:175], a[24:27], a[16:19], v[160:175]
    buffer_load_dwordx4 a[84:87], v63, s[20:23], s51 offen offset:1024 sc1
    s_cmp_ge_u32 s7, 4
    s_cselect_b32 s3, 20480, 0
    s_sub_u32 s37, s55, s3
    v_mfma_f32_32x32x8_bf16 v[176:191], v[24:25], v[28:29], v[176:191]
    s_add_u32 s37, s37, 4096
    s_cmp_ge_u32 s7, 3
    s_cselect_b32 s3, 20480, 0
    s_sub_u32 s38, s55, s3
    v_mfma_f32_32x32x8_bf16 v[96:111], v[26:27], v[28:29], v[96:111]
    buffer_load_dwordx4 a[88:91], v63, s[20:23], s51 offen offset:2048 sc1
    s_add_u32 s38, s38, 8192
    s_cmp_ge_u32 s7, 2
    s_cselect_b32 s3, 20480, 0
    v_mfma_f32_32x32x8_bf16 v[192:207], v[24:25], v[32:33], v[192:207]
    s_sub_u32 s39, s55, s3
    s_add_u32 s39, s39, 12288
    s_cmp_ge_u32 s7, 1
    s_cselect_b32 s3, 20480, 0
    v_mfma_f32_32x32x8_bf16 v[112:127], v[26:27], v[32:33], v[112:127]
    buffer_load_dwordx4 a[92:95], v63, s[20:23], s51 offen offset:3072 sc1
    s_cmp_ge_u32 s6, 10
    s_cselect_b32 s51, 12, 0
    s_sub_i32 s51, 2, s51
    s_mul_i32 s51, s51, 40960
    s_add_u32 s51, s51, s46
    v_mfma_f32_32x32x8_bf16 v[208:223], v[24:25], v[36:37], v[208:223]
    s_sub_u32 s40, s55, s3
    s_add_u32 s40, s40, 16384
    s_lshl_b32 s41, s43, 3
    s_add_u32 s41, s41, s44
    v_mfma_f32_32x32x8_bf16 v[128:143], v[26:27], v[36:37], v[128:143]
    s_lshl_b32 s41, s41, 11
    s_lshl_b32 s3, s24, 8
    s_add_u32 s41, s41, s3
    s_add_u32 s41, s41, 11976704
    v_mfma_f32_32x32x8_bf16 v[224:239], v[24:25], v[40:41], v[224:239]
    buffer_load_dwordx4 a[96:99], v62, s[20:23], s51 offen sc1
    s_mov_b32 s49, 200000
    s_lshl_b32 s83, s25, 1
    s_and_b32 s3, s24, 1
    v_mfma_f32_32x32x8_bf16 v[144:159], v[26:27], v[40:41], v[144:159]
    s_add_u32 s83, s83, s3
    s_mul_i32 s83, s83, 278528
    s_mul_i32 s89, s26, 10
    s_lshr_b32 s3, s24, 1
    v_mfma_f32_32x32x8_bf16 v[240:255], v[24:25], v[44:45], v[240:255]
    buffer_load_dwordx4 a[100:103], v63, s[20:23], s51 offen offset:0 sc1
    s_mul_i32 s3, s3, 5
    s_add_u32 s89, s89, s3
    s_add_u32 s3, s89, 0
    v_mfma_f32_32x32x8_bf16 v[160:175], v[26:27], v[44:45], v[160:175]
    s_lshr_b32 s84, s3, 2
    s_lshl_b32 s84, s84, 12
    s_and_b32 s3, s3, 3
    s_lshl_b32 s3, s3, 8
    s_waitcnt lgkmcnt(0)
    v_mfma_f32_32x32x16_bf16 v[176:191], a[48:51], a[28:31], v[176:191]
    s_waitcnt vmcnt(12) lgkmcnt(0)
    s_barrier
    v_mfma_f32_32x32x16_bf16 v[96:111], a[52:55], a[28:31], v[96:111]
    ds_read_b64_tr_b16 a[20:21], v8 offset:0
    ds_read_b64_tr_b16 a[22:23], v8 offset:2048
    buffer_load_dwordx4 a[104:107], v63, s[20:23], s51 offen offset:1024 sc1
    s_add_u32 s84, s84, s3
    v_mfma_f32_32x32x16_bf16 v[112:127], a[52:55], a[32:35], v[112:127]
    ds_read_b128 a[0:3], v2 offset:0
    ds_read_b128 a[4:7], v2 offset:4096
    buffer_load_dwordx4 a[108:111], v63, s[20:23], s51 offen offset:2048 sc1
    s_add_u32 s3, s89, 1
    v_mfma_f32_32x32x16_bf16 v[192:207], a[48:51], a[32:35], v[192:207]
    ds_read_b128 a[8:11], v2 offset:8192
    ds_read_b128 a[12:15], v2 offset:12288
    s_lshr_b32 s85, s3, 2
    s_lshl_b32 s85, s85, 12
    v_mfma_f32_32x32x16_bf16 v[208:223], a[48:51], a[36:39], v[208:223]
    ds_read_b128 a[16:19], v2 offset:16384
    buffer_load_dwordx4 a[112:115], v63, s[20:23], s51 offen offset:3072 sc1
    s_cmp_ge_u32 s6, 9
    s_cselect_b32 s51, 12, 0
    s_sub_i32 s51, 3, s51
    s_mul_i32 s51, s51, 40960
    s_add_u32 s51, s51, s46
    v_mfma_f32_32x32x16_bf16 v[128:143], a[52:55], a[36:39], v[128:143]
    s_and_b32 s3, s3, 3
    s_lshl_b32 s3, s3, 8
    s_add_u32 s85, s85, s3
    s_add_u32 s3, s89, 2
    v_mfma_f32_32x32x16_bf16 v[144:159], a[52:55], a[40:43], v[144:159]
    buffer_load_dwordx4 a[116:119], v62, s[20:23], s51 offen sc1
    s_lshr_b32 s86, s3, 2
    s_lshl_b32 s86, s86, 12
    s_and_b32 s3, s3, 3
    v_mfma_f32_32x32x16_bf16 v[224:239], a[48:51], a[40:43], v[224:239]
    s_lshl_b32 s3, s3, 8
    s_add_u32 s86, s86, s3
    s_add_u32 s3, s89, 3
    s_lshr_b32 s87, s3, 2
    v_mfma_f32_32x32x16_bf16 v[240:255], a[48:51], a[44:47], v[240:255]
    s_lshl_b32 s87, s87, 12
    s_and_b32 s3, s3, 3
    s_lshl_b32 s3, s3, 8
    s_add_u32 s87, s87, s3
    v_mfma_f32_32x32x16_bf16 v[160:175], a[52:55], a[44:47], v[160:175]
    buffer_load_dwordx4 a[120:123], v63, s[20:23], s51 offen offset:0 sc1
    s_add_u32 s3, s89, 4
    s_lshr_b32 s88, s3, 2
    s_lshl_b32 s88, s88, 12
    s_waitcnt lgkmcnt(0)
    v_mfma_f32_32x32x16_bf16 v[192:207], a[20:23], a[4:7], v[192:207]
    ds_read_b64_tr_b16 a[48:49], v8 offset:8192
    ds_read_b64_tr_b16 a[50:51], v8 offset:10240
    buffer_load_dwordx4 a[124:127], v63, s[20:23], s51 offen offset:1024 sc1
    v_and_b32 v56, 31, v1
    v_subrev_u32 v56, 16, v56
    v_mfma_f32_32x32x16_bf16 v[208:223], a[20:23], a[8:11], v[208:223]
    ds_read_b128 a[28:31], v3 offset:0
    ds_read_b128 a[32:35], v3 offset:4096
    v_ashrrev_i32 v57, 2, v56
    v_lshlrev_b32 v57, 1, v57
    v_and_b32 v58, 1, v56
    v_mfma_f32_32x32x16_bf16 v[224:239], a[20:23], a[12:15], v[224:239]
    ds_read_b128 a[36:39], v3 offset:8192
    ds_read_b128 a[40:43], v3 offset:12288
    v_add_u32 v57, v57, v58
    v_bfe_u32 v58, v56, 1, 1
    v_mul_u32_u24 v58, 72, v58
    v_mfma_f32_32x32x16_bf16 v[240:255], a[20:23], a[16:19], v[240:255]
    ds_read_b128 a[44:47], v3 offset:16384
    ds_read_b64_tr_b16 v[52:53], v8 offset:16384
    v_add_u32 v57, v57, v58
    v_add_u32 v57, 8, v57
    s_mul_i32 s28, s24, 18432
    v_mfma_f32_32x32x16_bf16 v[176:191], a[20:23], a[0:3], v[176:191]
    ds_read_b64_tr_b16 v[54:55], v8 offset:18432
    ds_read_b128 a[24:27], v4 offset:0
    buffer_load_dwordx4 a[128:131], v63, s[20:23], s51 offen offset:2048 sc1
    s_add_u32 s28, s28, 20480
    s_sub_u32 s29, s28, 640
    s_waitcnt lgkmcnt(3)
    v_mfma_f32_32x32x16_bf16 v[192:207], a[48:51], a[32:35], v[192:207]
    ds_read_b128 a[52:55], v4 offset:4096
    ds_read_b128 v[88:91], v4 offset:8192
    s_add_u32 s30, s28, 11136
    v_lshrrev_b32 v58, 5, v1
    v_lshlrev_b32 v58, 3, v58
    v_mfma_f32_32x32x16_bf16 v[208:223], a[48:51], a[36:39], v[208:223]
    ds_read_b128 v[92:95], v4 offset:12288
    ds_read_b128 v[48:51], v4 offset:16384
    v_mul_u32_u24 v56, 80, v57
    v_add3_u32 v60, v56, v58, s29
    v_mul_u32_u24 v56, 48, v57
    v_mfma_f32_32x32x16_bf16 v[224:239], a[48:51], a[40:43], v[224:239]
    ds_read_b64_tr_b16 a[20:21], v8 offset:24576
    ds_read_b64_tr_b16 a[22:23], v8 offset:26624
    v_add3_u32 v61, v56, v58, s30
    v_add_u32 v56, 131072, v62
    s_mov_b32 vcc_lo, 0xffff0000
    s_mov_b32 vcc_hi, 0xffff0000
    v_cndmask_b32 v59, v56, v60, vcc
    v_mfma_f32_32x32x16_bf16 v[240:255], a[48:51], a[44:47], v[240:255]
    ds_read_b128 a[0:3], v5 offset:0
    ds_read_b128 a[4:7], v5 offset:4096
    buffer_load_dwordx4 a[132:135], v63, s[20:23], s51 offen offset:3072 sc1
    s_and_b32 s3, s3, 3
    s_lshl_b32 s3, s3, 8
    v_mfma_f32_32x32x16_bf16 v[176:191], a[48:51], a[28:31], v[176:191]
    ds_read_b128 a[8:11], v5 offset:8192
    ds_read_b128 a[12:15], v5 offset:12288
    s_add_u32 s88, s88, s3
    s_sub_u32 s87, s87, s84
    s_sub_u32 s88, s88, s85
    s_waitcnt lgkmcnt(6)
    v_mfma_f32_32x32x16_bf16 v[192:207], v[52:55], a[52:55], v[192:207]
    ds_read_b128 a[16:19], v5 offset:16384
    ds_read_b64_tr_b16 a[48:49], v9 offset:0
    s_add_u32 s84, s84, s83
    s_add_u32 s85, s85, s83
    s_add_u32 s86, s86, s83
    v_mfma_f32_32x32x16_bf16 v[208:223], v[52:55], v[88:91], v[208:223]
    ds_read_b64_tr_b16 a[50:51], v9 offset:2048
    ds_read_b128 a[28:31], v2 offset:0
    s_mul_i32 s89, s24, 20480
    s_add_u32 s89, s89, 73728
    s_cmp_eq_u32 s24, 0
    s_cselect_b32 s89, 0, s89
    v_mfma_f32_32x32x16_bf16 v[224:239], v[52:55], v[92:95], v[224:239]
    ds_read_b128 a[32:35], v2 offset:4096
    ds_read_b128 a[36:39], v2 offset:8192
    s_cmp_ge_u32 s6, 8
    s_cselect_b32 s51, 12, 0
    s_sub_i32 s51, 4, s51
    s_mul_i32 s51, s51, 40960
    s_add_u32 s51, s51, s46
    buffer_load_dwordx4 a[136:139], v62, s[20:23], s51 offen sc1
    v_mfma_f32_32x32x16_bf16 v[240:255], v[52:55], v[48:51], v[240:255]
    ds_read_b128 a[40:43], v2 offset:12288
    ds_read_b128 a[44:47], v2 offset:16384
    v_mfma_f32_32x32x16_bf16 v[176:191], v[52:55], a[24:27], v[176:191]
    s_waitcnt lgkmcnt(7)
    v_mfma_f32_32x32x16_bf16 v[192:207], a[20:23], a[4:7], v[192:207]
    ds_read_b64_tr_b16 v[52:53], v9 offset:8192
    ds_read_b64_tr_b16 v[54:55], v9 offset:10240
    s_nop 1
    v_mfma_f32_32x32x16_bf16 v[208:223], a[20:23], a[8:11], v[208:223]
    ds_read_b128 a[24:27], v3 offset:0
    ds_read_b128 a[52:55], v3 offset:4096
    buffer_load_dwordx4 a[140:143], v63, s[20:23], s51 offen offset:0 sc1
    s_nop 0
    v_mfma_f32_32x32x16_bf16 v[224:239], a[20:23], a[12:15], v[224:239]
    ds_read_b128 v[88:91], v3 offset:8192
    ds_read_b128 v[92:95], v3 offset:12288
    s_nop 1
    v_mfma_f32_32x32x16_bf16 v[240:255], a[20:23], a[16:19], v[240:255]
    ds_read_b128 v[48:51], v3 offset:16384
    v_mul_f32 v192, v192, v34
    v_mul_f32 v193, v193, v34
    v_mul_f32 v194, v194, v34
    v_mul_f32 v195, v195, v34
    v_mfma_f32_32x32x16_bf16 v[176:191], a[20:23], a[0:3], v[176:191]
    v_mul_f32 v196, v196, v34
    v_mul_f32 v197, v197, v34
    v_mul_f32 v198, v198, v34
    v_mul_f32 v199, v199, v34
    v_mul_f32 v200, v200, v34
    s_waitcnt lgkmcnt(7)
    v_mfma_f32_32x32x16_bf16 v[112:127], a[48:51], a[32:35], v[112:127]
    ds_read_b64_tr_b16 a[20:21], v9 offset:16384
    ds_read_b64_tr_b16 a[22:23], v9 offset:18432
    buffer_load_dwordx4 a[144:147], v63, s[20:23], s51 offen offset:1024 sc1
    v_mul_f32 v201, v201, v34
    v_mul_f32 v202, v202, v34
    v_mfma_f32_32x32x16_bf16 v[128:143], a[48:51], a[36:39], v[128:143]
    ds_read_b128 a[0:3], v4 offset:0
    ds_read_b128 a[4:7], v4 offset:4096
    v_mul_f32 v203, v203, v34
    v_mul_f32 v204, v204, v34
    v_mul_f32 v205, v205, v34
    v_mfma_f32_32x32x16_bf16 v[144:159], a[48:51], a[40:43], v[144:159]
    ds_read_b128 a[8:11], v4 offset:8192
    ds_read_b128 a[12:15], v4 offset:12288
    v_mul_f32 v206, v206, v34
    v_mul_f32 v207, v207, v34
    v_cvt_pk_bf16_f32 v64, v192, v193
    v_mfma_f32_32x32x16_bf16 v[160:175], a[48:51], a[44:47], v[160:175]
    ds_read_b128 a[16:19], v4 offset:16384
    v_cvt_pk_bf16_f32 v65, v194, v195
    v_cvt_pk_bf16_f32 v66, v196, v197
    v_cvt_pk_bf16_f32 v67, v198, v199
    v_cvt_pk_bf16_f32 v68, v200, v201
    v_mfma_f32_32x32x16_bf16 v[96:111], a[48:51], a[28:31], v[96:111]
    buffer_load_dwordx4 a[148:151], v63, s[20:23], s51 offen offset:2048 sc1
    v_cvt_pk_bf16_f32 v69, v202, v203
    v_cvt_pk_bf16_f32 v70, v204, v205
    v_cvt_pk_bf16_f32 v71, v206, v207
    ds_write_b64 v60, v[64:65] offset:1280
    s_waitcnt lgkmcnt(8)
    v_mfma_f32_32x32x16_bf16 v[112:127], v[52:55], a[52:55], v[112:127]
    ds_read_b64_tr_b16 a[48:49], v9 offset:24576
    ds_read_b64_tr_b16 a[50:51], v9 offset:26624
    ds_write_b64 v60, v[66:67] offset:1296
    ds_write_b64 v60, v[68:69] offset:1312
    ds_write_b64 v60, v[70:71] offset:1328
    v_mfma_f32_32x32x16_bf16 v[128:143], v[52:55], v[88:91], v[128:143]
    ds_read_b128 a[28:31], v5 offset:0
    ds_read_b128 a[32:35], v5 offset:4096
    v_mul_f32 v208, v208, v38
    v_mul_f32 v209, v209, v38
    v_mul_f32 v210, v210, v38
    v_mfma_f32_32x32x16_bf16 v[144:159], v[52:55], v[92:95], v[144:159]
    ds_read_b128 a[36:39], v5 offset:8192
    ds_read_b128 a[40:43], v5 offset:12288
    v_mul_f32 v211, v211, v38
    v_mul_f32 v212, v212, v38
    v_mul_f32 v213, v213, v38
    v_mfma_f32_32x32x16_bf16 v[160:175], v[52:55], v[48:51], v[160:175]
    ds_read_b128 a[44:47], v5 offset:16384
    buffer_load_dwordx4 a[152:155], v63, s[20:23], s51 offen offset:3072 sc1
    v_mul_f32 v214, v214, v38
    v_mul_f32 v215, v215, v38
    v_mul_f32 v216, v216, v38
    v_mfma_f32_32x32x16_bf16 v[96:111], v[52:55], a[24:27], v[96:111]
    v_mul_f32 v217, v217, v38
    v_mul_f32 v218, v218, v38
    v_mul_f32 v219, v219, v38
    v_mul_f32 v220, v220, v38
    v_mul_f32 v221, v221, v38
    s_waitcnt lgkmcnt(11)
    v_mfma_f32_32x32x16_bf16 v[112:127], a[20:23], a[4:7], v[112:127]
    v_mul_f32 v222, v222, v38
    v_mul_f32 v223, v223, v38
    v_cvt_pk_bf16_f32 v72, v208, v209
    v_cvt_pk_bf16_f32 v73, v210, v211
    v_cvt_pk_bf16_f32 v74, v212, v213
    s_waitcnt lgkmcnt(0)
    v_mfma_f32_32x32x16_bf16 v[112:127], a[48:51], a[32:35], v[112:127]
    v_cvt_pk_bf16_f32 v75, v214, v215
    v_cvt_pk_bf16_f32 v76, v216, v217
    v_cvt_pk_bf16_f32 v77, v218, v219
    v_cvt_pk_bf16_f32 v78, v220, v221
    v_cvt_pk_bf16_f32 v79, v222, v223
    v_mfma_f32_32x32x16_bf16 v[128:143], a[20:23], a[8:11], v[128:143]
    s_cmp_ge_u32 s6, 7
    s_cselect_b32 s51, 12, 0
    s_sub_i32 s51, 5, s51
    s_mul_i32 s51, s51, 40960
    s_add_u32 s51, s51, s46
    buffer_load_dwordx4 a[156:159], v62, s[20:23], s51 offen sc1
    ds_write_b64 v60, v[72:73] offset:2560
    ds_write_b64 v60, v[74:75] offset:2576
    ds_write_b64 v60, v[76:77] offset:2592
    ds_write_b64 v60, v[78:79] offset:2608
    v_mfma_f32_32x32x16_bf16 v[128:143], a[48:51], a[36:39], v[128:143]
    v_mul_f32 v224, v224, v42
    v_mul_f32 v225, v225, v42
    v_mul_f32 v226, v226, v42
    v_mul_f32 v227, v227, v42
    v_mul_f32 v228, v228, v42
    v_mfma_f32_32x32x16_bf16 v[144:159], a[20:23], a[12:15], v[144:159]
    v_mul_f32 v229, v229, v42
    v_mul_f32 v230, v230, v42
    v_mul_f32 v231, v231, v42
    v_mul_f32 v232, v232, v42
    v_mul_f32 v233, v233, v42
    v_mfma_f32_32x32x16_bf16 v[144:159], a[48:51], a[40:43], v[144:159]
    v_mul_f32 v234, v234, v42
    v_mul_f32 v235, v235, v42
    v_mul_f32 v236, v236, v42
    v_mul_f32 v237, v237, v42
    v_mul_f32 v238, v238, v42
    v_mfma_f32_32x32x16_bf16 v[160:175], a[20:23], a[16:19], v[160:175]
    buffer_load_dwordx4 a[160:163], v63, s[20:23], s51 offen offset:0 sc1
    v_mul_f32 v239, v239, v42
    v_cvt_pk_bf16_f32 v80, v224, v225
    v_cvt_pk_bf16_f32 v81, v226, v227
    v_cvt_pk_bf16_f32 v82, v228, v229
    v_mfma_f32_32x32x16_bf16 v[160:175], a[48:51], a[44:47], v[160:175]
    v_cvt_pk_bf16_f32 v83, v230, v231
    v_cvt_pk_bf16_f32 v84, v232, v233
    v_cvt_pk_bf16_f32 v85, v234, v235
    v_cvt_pk_bf16_f32 v86, v236, v237
    v_cvt_pk_bf16_f32 v87, v238, v239
    v_mfma_f32_32x32x16_bf16 v[96:111], a[20:23], a[0:3], v[96:111]
    ds_write_b64 v60, v[80:81] offset:3840
    ds_write_b64 v60, v[82:83] offset:3856
    ds_write_b64 v60, v[84:85] offset:3872
    ds_write_b64 v60, v[86:87] offset:3888
    v_mul_f32 v240, v240, v46
    v_mfma_f32_32x32x16_bf16 v[96:111], a[48:51], a[28:31], v[96:111]
    v_mul_f32 v241, v241, v46
    v_mul_f32 v242, v242, v46
    v_mul_f32 v243, v243, v46
    v_mul_f32 v244, v244, v46
    v_mul_f32 v245, v245, v46
    v_mul_f32 v246, v246, v46
    v_mul_f32 v247, v247, v46
    v_mul_f32 v248, v248, v46
    v_mul_f32 v249, v249, v46
    v_mul_f32 v250, v250, v46
    v_mul_f32 v251, v251, v46
    v_pk_mul_f32 v[252:253], v[252:253], v[46:47] op_sel:[0,0] op_sel_hi:[1,0]
    v_pk_mul_f32 v[254:255], v[254:255], v[46:47] op_sel:[0,0] op_sel_hi:[1,0]
    v_cvt_pk_bf16_f32 v64, v240, v241
    v_cvt_pk_bf16_f32 v65, v242, v243
    v_cvt_pk_bf16_f32 v66, v244, v245
    v_cvt_pk_bf16_f32 v67, v246, v247
    v_cvt_pk_bf16_f32 v68, v248, v249
    v_cvt_pk_bf16_f32 v69, v250, v251
    v_cvt_pk_bf16_f32 v70, v252, v253
    v_cvt_pk_bf16_f32 v71, v254, v255
    ds_write_b64 v60, v[64:65] offset:5120
    ds_write_b64 v60, v[66:67] offset:5136
    ds_write_b64 v60, v[68:69] offset:5152
    ds_write_b64 v60, v[70:71] offset:5168
    v_pk_mul_f32 v[176:177], v[176:177], v[30:31] op_sel:[0,0] op_sel_hi:[1,0]
    v_pk_mul_f32 v[178:179], v[178:179], v[30:31] op_sel:[0,0] op_sel_hi:[1,0]
    v_pk_mul_f32 v[180:181], v[180:181], v[30:31] op_sel:[0,0] op_sel_hi:[1,0]
    v_pk_mul_f32 v[182:183], v[182:183], v[30:31] op_sel:[0,0] op_sel_hi:[1,0]
    v_pk_mul_f32 v[184:185], v[184:185], v[30:31] op_sel:[0,0] op_sel_hi:[1,0]
    v_pk_mul_f32 v[186:187], v[186:187], v[30:31] op_sel:[0,0] op_sel_hi:[1,0]
    v_pk_mul_f32 v[188:189], v[188:189], v[30:31] op_sel:[0,0] op_sel_hi:[1,0]
    v_pk_mul_f32 v[190:191], v[190:191], v[30:31] op_sel:[0,0] op_sel_hi:[1,0]
    v_cvt_pk_bf16_f32 v72, v176, v177
    v_cvt_pk_bf16_f32 v73, v178, v179
    v_cvt_pk_bf16_f32 v74, v180, v181
    v_cvt_pk_bf16_f32 v75, v182, v183
    v_cvt_pk_bf16_f32 v76, v184, v185
    v_cvt_pk_bf16_f32 v77, v186, v187
    v_cvt_pk_bf16_f32 v78, v188, v189
    v_cvt_pk_bf16_f32 v79, v190, v191
    ds_write_b64 v59, v[72:73] offset:0
    ds_write_b64 v59, v[74:75] offset:16
    ds_write_b64 v59, v[76:77] offset:32
    ds_write_b64 v59, v[78:79] offset:48
    v_pk_mul_f32 v[112:113], v[112:113], v[34:35] op_sel:[0,0] op_sel_hi:[1,0]
    v_pk_mul_f32 v[114:115], v[114:115], v[34:35] op_sel:[0,0] op_sel_hi:[1,0]
    v_pk_mul_f32 v[116:117], v[116:117], v[34:35] op_sel:[0,0] op_sel_hi:[1,0]
    v_pk_mul_f32 v[118:119], v[118:119], v[34:35] op_sel:[0,0] op_sel_hi:[1,0]
    v_pk_mul_f32 v[120:121], v[120:121], v[34:35] op_sel:[0,0] op_sel_hi:[1,0]
    v_pk_mul_f32 v[122:123], v[122:123], v[34:35] op_sel:[0,0] op_sel_hi:[1,0]
    v_pk_mul_f32 v[124:125], v[124:125], v[34:35] op_sel:[0,0] op_sel_hi:[1,0]
    v_pk_mul_f32 v[126:127], v[126:127], v[34:35] op_sel:[0,0] op_sel_hi:[1,0]
    v_cvt_pk_bf16_f32 v80, v112, v113
    v_cvt_pk_bf16_f32 v81, v114, v115
    v_cvt_pk_bf16_f32 v82, v116, v117
    v_cvt_pk_bf16_f32 v83, v118, v119
    v_cvt_pk_bf16_f32 v84, v120, v121
    v_cvt_pk_bf16_f32 v85, v122, v123
    v_cvt_pk_bf16_f32 v86, v124, v125
    v_cvt_pk_bf16_f32 v87, v126, v127
    ds_write_b64 v60, v[80:81] offset:1344
    ds_write_b64 v61, v[82:83] offset:768
    ds_write_b64 v61, v[84:85] offset:784
    ds_write_b64 v61, v[86:87] offset:800
    v_pk_mul_f32 v[128:129], v[128:129], v[38:39] op_sel:[0,0] op_sel_hi:[1,0]
    v_pk_mul_f32 v[130:131], v[130:131], v[38:39] op_sel:[0,0] op_sel_hi:[1,0]
    v_pk_mul_f32 v[132:133], v[132:133], v[38:39] op_sel:[0,0] op_sel_hi:[1,0]
    v_pk_mul_f32 v[134:135], v[134:135], v[38:39] op_sel:[0,0] op_sel_hi:[1,0]
    v_pk_mul_f32 v[136:137], v[136:137], v[38:39] op_sel:[0,0] op_sel_hi:[1,0]
    v_pk_mul_f32 v[138:139], v[138:139], v[38:39] op_sel:[0,0] op_sel_hi:[1,0]
    v_pk_mul_f32 v[140:141], v[140:141], v[38:39] op_sel:[0,0] op_sel_hi:[1,0]
    v_pk_mul_f32 v[142:143], v[142:143], v[38:39] op_sel:[0,0] op_sel_hi:[1,0]
    v_cvt_pk_bf16_f32 v64, v128, v129
    v_cvt_pk_bf16_f32 v65, v130, v131
    v_cvt_pk_bf16_f32 v66, v132, v133
    v_cvt_pk_bf16_f32 v67, v134, v135
    v_cvt_pk_bf16_f32 v68, v136, v137
    v_cvt_pk_bf16_f32 v69, v138, v139
    v_cvt_pk_bf16_f32 v70, v140, v141
    v_cvt_pk_bf16_f32 v71, v142, v143
    ds_write_b64 v60, v[64:65] offset:2624
    ds_write_b64 v61, v[66:67] offset:1536
    ds_write_b64 v61, v[68:69] offset:1552
    ds_write_b64 v61, v[70:71] offset:1568
    v_pk_mul_f32 v[144:145], v[144:145], v[42:43] op_sel:[0,0] op_sel_hi:[1,0]
    v_pk_mul_f32 v[146:147], v[146:147], v[42:43] op_sel:[0,0] op_sel_hi:[1,0]
    v_pk_mul_f32 v[148:149], v[148:149], v[42:43] op_sel:[0,0] op_sel_hi:[1,0]
    v_pk_mul_f32 v[150:151], v[150:151], v[42:43] op_sel:[0,0] op_sel_hi:[1,0]
    v_pk_mul_f32 v[152:153], v[152:153], v[42:43] op_sel:[0,0] op_sel_hi:[1,0]
    v_pk_mul_f32 v[154:155], v[154:155], v[42:43] op_sel:[0,0] op_sel_hi:[1,0]
    v_pk_mul_f32 v[156:157], v[156:157], v[42:43] op_sel:[0,0] op_sel_hi:[1,0]
    v_pk_mul_f32 v[158:159], v[158:159], v[42:43] op_sel:[0,0] op_sel_hi:[1,0]
    v_cvt_pk_bf16_f32 v72, v144, v145
    v_cvt_pk_bf16_f32 v73, v146, v147
    v_cvt_pk_bf16_f32 v74, v148, v149
    v_cvt_pk_bf16_f32 v75, v150, v151
    v_cvt_pk_bf16_f32 v76, v152, v153
    v_cvt_pk_bf16_f32 v77, v154, v155
    v_cvt_pk_bf16_f32 v78, v156, v157
    v_cvt_pk_bf16_f32 v79, v158, v159
    ds_write_b64 v60, v[72:73] offset:3904
    ds_write_b64 v61, v[74:75] offset:2304
    ds_write_b64 v61, v[76:77] offset:2320
    ds_write_b64 v61, v[78:79] offset:2336
    v_pk_mul_f32 v[160:161], v[160:161], v[46:47] op_sel:[0,0] op_sel_hi:[1,0]
    v_pk_mul_f32 v[162:163], v[162:163], v[46:47] op_sel:[0,0] op_sel_hi:[1,0]
    v_pk_mul_f32 v[164:165], v[164:165], v[46:47] op_sel:[0,0] op_sel_hi:[1,0]
    v_pk_mul_f32 v[166:167], v[166:167], v[46:47] op_sel:[0,0] op_sel_hi:[1,0]
    v_pk_mul_f32 v[168:169], v[168:169], v[46:47] op_sel:[0,0] op_sel_hi:[1,0]
    v_pk_mul_f32 v[170:171], v[170:171], v[46:47] op_sel:[0,0] op_sel_hi:[1,0]
    v_pk_mul_f32 v[172:173], v[172:173], v[46:47] op_sel:[0,0] op_sel_hi:[1,0]
    v_pk_mul_f32 v[174:175], v[174:175], v[46:47] op_sel:[0,0] op_sel_hi:[1,0]
    v_cvt_pk_bf16_f32 v80, v160, v161
    v_cvt_pk_bf16_f32 v81, v162, v163
    v_cvt_pk_bf16_f32 v82, v164, v165
    v_cvt_pk_bf16_f32 v83, v166, v167
    v_cvt_pk_bf16_f32 v84, v168, v169
    v_cvt_pk_bf16_f32 v85, v170, v171
    v_cvt_pk_bf16_f32 v86, v172, v173
    v_cvt_pk_bf16_f32 v87, v174, v175
    ds_write_b64 v60, v[80:81] offset:5184
    ds_write_b64 v61, v[82:83] offset:3072
    ds_write_b64 v61, v[84:85] offset:3088
    ds_write_b64 v61, v[86:87] offset:3104
    v_pk_mul_f32 v[96:97], v[96:97], v[30:31] op_sel:[0,0] op_sel_hi:[1,0]
    v_pk_mul_f32 v[98:99], v[98:99], v[30:31] op_sel:[0,0] op_sel_hi:[1,0]
    v_cvt_pk_bf16_f32 v64, v96, v97
    v_cvt_pk_bf16_f32 v65, v98, v99
    ds_write_b64 v59, v[64:65] offset:64
    s_and_b32 s28, s24, 2
    s_mul_i32 s28, s28, 18432
    s_add_u32 s28, s28, 20480
    s_and_b32 s31, s24, 1
    s_lshl_b32 s31, s31, 5
    v_and_b32 v20, 31, v1
    v_add_u32 v20, s31, v20
    v_lshrrev_b32 v21, 5, v1
    v_mul_u32_u24 v22, 18432, v21
    v_add_u32 v22, s28, v22
    v_mad_u32_u24 v60, v20, 5, 0
    v_lshl_add_u32 v60, v60, 4, v22
    v_mad_u32_u24 v61, v20, 3, 0
    v_lshl_add_u32 v61, v61, 4, v22

    s_waitcnt lgkmcnt(0)
    s_barrier
    ds_read_b128 v[36:39], v61 offset:11904
    ds_read_b128 v[40:43], v61 offset:11920
    ds_read_b64 v[44:45], v61 offset:11936
    ds_read_b128 v[48:51], v61 offset:15360
    ds_read_b128 v[52:55], v61 offset:15376
    ds_read_b64 v[56:57], v61 offset:15392
    ds_read_b128 v[64:67], v60 offset:6400
    ds_read_b128 v[68:71], v60 offset:6416
    ds_read_b128 v[72:75], v60 offset:6432
    ds_read_b128 v[84:87], v60 offset:640
    ds_read_b128 v[88:91], v60 offset:656
    ds_read_b128 v[92:95], v60 offset:672
    ds_read_b128 v[104:107], v60 offset:6240
    ds_read_b128 v[108:111], v60 offset:6256
    ds_read_b128 v[112:115], v60 offset:6272
    v_mov_b32 v2, 0
    v_mov_b32 v3, 0
    v_mov_b32 v4, 0
    v_mov_b32 v5, 0
    v_mov_b32 v6, 0
    v_mov_b32 v7, 0
    v_mov_b32 v8, 0
    v_mov_b32 v9, 0
    v_mov_b32 v10, 0
    v_mov_b32 v11, 0
    v_mov_b32 v12, 0
    v_mov_b32 v13, 0
    v_mov_b32 v14, 0
    v_mov_b32 v15, 0
    v_mov_b32 v16, 0
    v_mov_b32 v17, 0
    s_waitcnt lgkmcnt(3)
    v_dot2c_f32_bf16 v10, v48, v64
    v_dot2c_f32_bf16 v2, v36, v84
    buffer_load_dwordx4 a[164:167], v63, s[20:23], s51 offen offset:1024 sc1
    v_dot2c_f32_bf16 v11, v48, v84
    v_dot2c_f32_bf16 v10, v49, v65
    ds_read_b128 v[124:127], v60 offset:480
    v_dot2c_f32_bf16 v2, v37, v85
    v_dot2c_f32_bf16 v11, v49, v85
    v_dot2c_f32_bf16 v10, v50, v66
    v_dot2c_f32_bf16 v2, v38, v86
    ds_read_b128 v[128:131], v60 offset:496
    v_dot2c_f32_bf16 v11, v50, v86
    v_dot2c_f32_bf16 v10, v51, v67
    buffer_load_dwordx4 a[168:171], v63, s[20:23], s51 offen offset:2048 sc1
    v_dot2c_f32_bf16 v2, v39, v87
    v_dot2c_f32_bf16 v11, v51, v87
    ds_read_b128 v[132:135], v60 offset:512
    v_dot2c_f32_bf16 v10, v52, v68
    v_dot2c_f32_bf16 v2, v40, v88
    v_dot2c_f32_bf16 v11, v52, v88
    v_dot2c_f32_bf16 v10, v53, v69
    ds_read_b128 v[144:147], v60 offset:6080
    v_dot2c_f32_bf16 v2, v41, v89
    v_dot2c_f32_bf16 v11, v53, v89
    buffer_load_dwordx4 a[172:175], v63, s[20:23], s51 offen offset:3072 sc1
    v_dot2c_f32_bf16 v10, v54, v70
    v_dot2c_f32_bf16 v2, v42, v90
    ds_read_b128 v[148:151], v60 offset:6096
    v_dot2c_f32_bf16 v11, v54, v90
    v_dot2c_f32_bf16 v10, v55, v71
    v_dot2c_f32_bf16 v2, v43, v91
    v_dot2c_f32_bf16 v11, v55, v91
    ds_read_b128 v[152:155], v60 offset:6112
    v_dot2c_f32_bf16 v10, v56, v72
    v_dot2c_f32_bf16 v2, v44, v92
    s_cmp_ge_u32 s6, 6
    s_cselect_b32 s51, 12, 0
    s_sub_i32 s51, 6, s51
    s_mul_i32 s51, s51, 40960
    s_add_u32 s51, s51, s46
    buffer_load_dwordx4 a[176:179], v62, s[20:23], s51 offen sc1
    v_dot2c_f32_bf16 v11, v56, v92
    v_dot2c_f32_bf16 v10, v57, v73
    ds_read_b128 v[164:167], v60 offset:320
    v_dot2c_f32_bf16 v2, v45, v93
    v_dot2c_f32_bf16 v11, v57, v93
    s_waitcnt lgkmcnt(4)
    v_dot2c_f32_bf16 v3, v36, v104
    v_dot2c_f32_bf16 v12, v48, v104
    buffer_load_dwordx4 a[180:183], v63, s[20:23], s51 offen offset:0 sc1
    v_dot2c_f32_bf16 v4, v36, v124
    v_dot2c_f32_bf16 v13, v48, v124
    ds_read_b128 v[168:171], v60 offset:336
    v_dot2c_f32_bf16 v3, v37, v105
    v_dot2c_f32_bf16 v12, v49, v105
    v_dot2c_f32_bf16 v4, v37, v125
    v_dot2c_f32_bf16 v13, v49, v125
    ds_read_b128 v[172:175], v60 offset:352
    v_dot2c_f32_bf16 v3, v38, v106
    v_dot2c_f32_bf16 v12, v50, v106
    buffer_load_dwordx4 a[184:187], v63, s[20:23], s51 offen offset:1024 sc1
    v_dot2c_f32_bf16 v4, v38, v126
    v_dot2c_f32_bf16 v13, v50, v126
    ds_read_b128 v[184:187], v60 offset:5920
    v_dot2c_f32_bf16 v3, v39, v107
    v_dot2c_f32_bf16 v12, v51, v107
    v_dot2c_f32_bf16 v4, v39, v127
    v_dot2c_f32_bf16 v13, v51, v127
    ds_read_b128 v[188:191], v60 offset:5936
    v_dot2c_f32_bf16 v3, v40, v108
    v_dot2c_f32_bf16 v12, v52, v108
    buffer_load_dwordx4 a[188:191], v63, s[20:23], s51 offen offset:2048 sc1
    v_dot2c_f32_bf16 v4, v40, v128
    v_dot2c_f32_bf16 v13, v52, v128
    ds_read_b128 v[192:195], v60 offset:5952
    v_dot2c_f32_bf16 v3, v41, v109
    v_dot2c_f32_bf16 v12, v53, v109
    v_dot2c_f32_bf16 v4, v41, v129
    v_dot2c_f32_bf16 v13, v53, v129
    ds_read_b128 v[204:207], v60 offset:160
    v_dot2c_f32_bf16 v3, v42, v110
    v_dot2c_f32_bf16 v12, v54, v110
    buffer_load_dwordx4 a[192:195], v63, s[20:23], s51 offen offset:3072 sc1
    v_dot2c_f32_bf16 v4, v42, v130
    v_dot2c_f32_bf16 v13, v54, v130
    ds_read_b128 v[208:211], v60 offset:176
    v_dot2c_f32_bf16 v3, v43, v111
    v_dot2c_f32_bf16 v12, v55, v111
    v_dot2c_f32_bf16 v4, v43, v131
    v_dot2c_f32_bf16 v13, v55, v131
    ds_read_b128 v[212:215], v60 offset:192
    v_dot2c_f32_bf16 v3, v44, v112
    v_dot2c_f32_bf16 v12, v56, v112
    s_cmp_ge_u32 s6, 5
    s_cselect_b32 s51, 12, 0
    s_sub_i32 s51, 7, s51
    s_mul_i32 s51, s51, 40960
    s_add_u32 s51, s51, s46
    buffer_load_dwordx4 a[196:199], v62, s[20:23], s51 offen sc1
    v_dot2c_f32_bf16 v4, v44, v132
    v_dot2c_f32_bf16 v13, v56, v132
    ds_read_b128 v[224:227], v60 offset:5760
    v_dot2c_f32_bf16 v3, v45, v113
    v_dot2c_f32_bf16 v12, v57, v113
    v_dot2c_f32_bf16 v4, v45, v133
    v_dot2c_f32_bf16 v13, v57, v133
    ds_read_b128 v[228:231], v60 offset:5776
    s_waitcnt lgkmcnt(8)
    v_dot2c_f32_bf16 v5, v36, v144
    v_dot2c_f32_bf16 v14, v48, v144
    buffer_load_dwordx4 a[200:203], v63, s[20:23], s51 offen offset:0 sc1
    v_dot2c_f32_bf16 v6, v36, v164
    v_dot2c_f32_bf16 v15, v48, v164
    ds_read_b128 v[232:235], v60 offset:5792
    v_dot2c_f32_bf16 v5, v37, v145
    v_dot2c_f32_bf16 v14, v49, v145
    v_dot2c_f32_bf16 v6, v37, v165
    v_dot2c_f32_bf16 v15, v49, v165
    ds_read_b128 v[76:79], v60 offset:6448
    v_dot2c_f32_bf16 v5, v38, v146
    v_dot2c_f32_bf16 v14, v50, v146
    buffer_load_dwordx4 a[204:207], v63, s[20:23], s51 offen offset:1024 sc1
    v_dot2c_f32_bf16 v6, v38, v166
    v_dot2c_f32_bf16 v15, v50, v166
    ds_read_b128 v[80:83], v60 offset:6464
    v_dot2c_f32_bf16 v5, v39, v147
    v_dot2c_f32_bf16 v14, v51, v147
    v_dot2c_f32_bf16 v6, v39, v167
    v_dot2c_f32_bf16 v15, v51, v167
    ds_read_b128 v[96:99], v60 offset:688
    v_dot2c_f32_bf16 v5, v40, v148
    v_dot2c_f32_bf16 v14, v52, v148
    buffer_load_dwordx4 a[208:211], v63, s[20:23], s51 offen offset:2048 sc1
    v_dot2c_f32_bf16 v6, v40, v168
    v_dot2c_f32_bf16 v15, v52, v168
    ds_read_b128 v[100:103], v60 offset:704
    v_dot2c_f32_bf16 v5, v41, v149
    v_dot2c_f32_bf16 v14, v53, v149
    v_dot2c_f32_bf16 v6, v41, v169
    v_dot2c_f32_bf16 v15, v53, v169
    ds_read_b128 v[116:119], v60 offset:6288
    v_dot2c_f32_bf16 v5, v42, v150
    v_dot2c_f32_bf16 v14, v54, v150
    buffer_load_dwordx4 a[212:215], v63, s[20:23], s51 offen offset:3072 sc1
    v_dot2c_f32_bf16 v6, v42, v170
    v_dot2c_f32_bf16 v15, v54, v170
    ds_read_b128 v[120:123], v60 offset:6304
    v_dot2c_f32_bf16 v5, v43, v151
    v_dot2c_f32_bf16 v14, v55, v151
    v_dot2c_f32_bf16 v6, v43, v171
    v_dot2c_f32_bf16 v15, v55, v171
    ds_read_b128 v[136:139], v60 offset:528
    v_dot2c_f32_bf16 v5, v44, v152
    v_dot2c_f32_bf16 v14, v56, v152
    s_cmp_ge_u32 s7, 5
    s_cselect_b32 s51, 5, 0
    s_sub_i32 s51, 0, s51
    s_mul_i32 s51, s51, 40960
    s_add_u32 s51, s51, s50
    buffer_load_dwordx4 a[216:219], v62, s[20:23], s51 offen sc1
    v_dot2c_f32_bf16 v6, v44, v172
    v_dot2c_f32_bf16 v15, v56, v172
    ds_read_b128 v[140:143], v60 offset:544
    v_dot2c_f32_bf16 v5, v45, v153
    v_dot2c_f32_bf16 v14, v57, v153
    v_dot2c_f32_bf16 v6, v45, v173
    v_dot2c_f32_bf16 v15, v57, v173
    ds_read_b128 v[156:159], v60 offset:6128
    s_waitcnt lgkmcnt(12)
    v_dot2c_f32_bf16 v7, v36, v184
    v_dot2c_f32_bf16 v16, v48, v184
    buffer_load_dwordx4 a[220:223], v63, s[20:23], s51 offen offset:0 sc1
    v_dot2c_f32_bf16 v8, v36, v204
    v_dot2c_f32_bf16 v17, v48, v204
    ds_read_b128 v[160:163], v60 offset:6144
    v_dot2c_f32_bf16 v7, v37, v185
    v_dot2c_f32_bf16 v16, v49, v185
    v_dot2c_f32_bf16 v8, v37, v205
    v_dot2c_f32_bf16 v17, v49, v205
    ds_read_b128 v[176:179], v60 offset:368
    v_dot2c_f32_bf16 v7, v38, v186
    v_dot2c_f32_bf16 v16, v50, v186
    buffer_load_dwordx4 a[224:227], v63, s[20:23], s51 offen offset:1024 sc1
    v_dot2c_f32_bf16 v8, v38, v206
    v_dot2c_f32_bf16 v17, v50, v206
    ds_read_b128 v[180:183], v60 offset:384
    v_dot2c_f32_bf16 v7, v39, v187
    v_dot2c_f32_bf16 v16, v51, v187
    v_dot2c_f32_bf16 v8, v39, v207
    v_dot2c_f32_bf16 v17, v51, v207
    ds_read_b128 v[196:199], v60 offset:5968
    v_dot2c_f32_bf16 v7, v40, v188
    v_dot2c_f32_bf16 v16, v52, v188
    buffer_load_dwordx4 a[228:231], v63, s[20:23], s51 offen offset:2048 sc1
    v_dot2c_f32_bf16 v8, v40, v208
    v_dot2c_f32_bf16 v17, v52, v208
    ds_read_b128 v[200:203], v60 offset:5984
    v_dot2c_f32_bf16 v7, v41, v189
    v_dot2c_f32_bf16 v16, v53, v189
    v_dot2c_f32_bf16 v8, v41, v209
    v_dot2c_f32_bf16 v17, v53, v209
    ds_read_b128 v[216:219], v60 offset:208
    v_dot2c_f32_bf16 v7, v42, v190
    v_dot2c_f32_bf16 v16, v54, v190
    buffer_load_dwordx4 a[232:235], v63, s[20:23], s51 offen offset:3072 sc1
    v_dot2c_f32_bf16 v8, v42, v210
    v_dot2c_f32_bf16 v17, v54, v210
    ds_read_b128 v[220:223], v60 offset:224
    v_dot2c_f32_bf16 v7, v43, v191
    v_dot2c_f32_bf16 v16, v55, v191
    v_dot2c_f32_bf16 v8, v43, v211
    v_dot2c_f32_bf16 v17, v55, v211
    ds_read_b128 v[236:239], v60 offset:5808
    v_dot2c_f32_bf16 v7, v44, v192
    v_dot2c_f32_bf16 v16, v56, v192
    s_cmp_ge_u32 s7, 4
    s_cselect_b32 s51, 5, 0
    s_sub_i32 s51, 1, s51
    s_mul_i32 s51, s51, 40960
    s_add_u32 s51, s51, s50
    buffer_load_dwordx4 a[236:239], v62, s[20:23], s51 offen sc1
    v_dot2c_f32_bf16 v8, v44, v212
    v_dot2c_f32_bf16 v17, v56, v212
    ds_read_b128 v[240:243], v60 offset:5824
    v_dot2c_f32_bf16 v7, v45, v193
    v_dot2c_f32_bf16 v16, v57, v193
    v_dot2c_f32_bf16 v8, v45, v213
    v_dot2c_f32_bf16 v17, v57, v213
    s_waitcnt lgkmcnt(15)
    v_dot2c_f32_bf16 v9, v36, v224
    v_dot2c_f32_bf16 v9, v37, v225
    buffer_load_dwordx4 a[240:243], v63, s[20:23], s51 offen offset:0 sc1
    v_dot2c_f32_bf16 v9, v38, v226
    v_dot2c_f32_bf16 v9, v39, v227
    v_dot2c_f32_bf16 v9, v40, v228
    v_dot2c_f32_bf16 v9, v41, v229
    v_dot2c_f32_bf16 v9, v42, v230
    v_dot2c_f32_bf16 v9, v43, v231
    v_dot2c_f32_bf16 v9, v44, v232
    v_dot2c_f32_bf16 v9, v45, v233
    buffer_load_dwordx4 a[244:247], v63, s[20:23], s51 offen offset:1024 sc1
    s_cmp_lg_u32 s25, 0
    s_cbranch_scc1 LA_nomask
    v_lshrrev_b32 v18, 1, v20
    v_lshlrev_b32 v18, 2, v18
    v_and_b32 v19, 1, v20
    v_add_u32 v18, v18, v19
    v_mov_b32 v19, 0xf149f2ca

    v_cmp_gt_u32 vcc, 2, v18
    s_nop 1
    v_cndmask_b32 v3, v3, v19, vcc
    v_cndmask_b32 v12, v12, v19, vcc
    v_cmp_gt_u32 vcc, 4, v18
    s_nop 1
    v_cndmask_b32 v4, v4, v19, vcc
    v_cndmask_b32 v13, v13, v19, vcc
    v_cmp_gt_u32 vcc, 6, v18
    s_nop 1
    v_cndmask_b32 v5, v5, v19, vcc
    v_cndmask_b32 v14, v14, v19, vcc
    v_cmp_gt_u32 vcc, 8, v18
    s_nop 1
    v_cndmask_b32 v6, v6, v19, vcc
    v_cndmask_b32 v15, v15, v19, vcc
    v_cmp_gt_u32 vcc, 10, v18
    s_nop 1
    v_cndmask_b32 v7, v7, v19, vcc
    v_cndmask_b32 v16, v16, v19, vcc
    v_cmp_gt_u32 vcc, 12, v18
    s_nop 1
    v_cndmask_b32 v8, v8, v19, vcc
    v_cndmask_b32 v17, v17, v19, vcc
    v_cmp_gt_u32 vcc, 14, v18
    s_nop 1
    v_cndmask_b32 v9, v9, v19, vcc
LA_nomask:
    s_mov_b32 s29, 0x3ea52b5c
    s_nop 1
    v_max3_f32 v18, v2, v3, v4
    v_max3_f32 v19, v10, v11, v12
    v_max3_f32 v18, v18, v5, v6
    v_max3_f32 v19, v19, v13, v14
    v_max3_f32 v18, v18, v7, v8
    v_max3_f32 v19, v19, v15, v16
    v_max_f32 v18, v18, v9
    v_max_f32 v19, v19, v17
    v_mul_f32 v18, s29, v18
    v_mul_f32 v19, s29, v19
    v_fma_f32 v2, v2, s29, -v18
    v_fma_f32 v3, v3, s29, -v18
    v_fma_f32 v4, v4, s29, -v18
    v_fma_f32 v5, v5, s29, -v18
    v_fma_f32 v6, v6, s29, -v18
    v_fma_f32 v7, v7, s29, -v18
    v_fma_f32 v8, v8, s29, -v18
    v_fma_f32 v9, v9, s29, -v18
    v_fma_f32 v10, v10, s29, -v19
    v_fma_f32 v11, v11, s29, -v19
    v_fma_f32 v12, v12, s29, -v19
    v_fma_f32 v13, v13, s29, -v19
    v_fma_f32 v14, v14, s29, -v19
    v_fma_f32 v15, v15, s29, -v19
    v_fma_f32 v16, v16, s29, -v19
    v_fma_f32 v17, v17, s29, -v19
    v_exp_f32 v2, v2
    v_exp_f32 v3, v3
    v_exp_f32 v4, v4
    v_exp_f32 v5, v5
    v_exp_f32 v6, v6
    v_exp_f32 v7, v7
    v_exp_f32 v8, v8
    v_exp_f32 v9, v9
    v_exp_f32 v10, v10
    v_exp_f32 v11, v11
    v_exp_f32 v12, v12
    v_exp_f32 v13, v13
    v_exp_f32 v14, v14
    v_exp_f32 v15, v15
    v_exp_f32 v16, v16
    v_exp_f32 v17, v17
    s_nop 0
    v_pk_add_f32 v[24:25], v[2:3], v[4:5]
    v_pk_add_f32 v[26:27], v[6:7], v[8:9]
    v_pk_add_f32 v[28:29], v[10:11], v[12:13]
    v_pk_add_f32 v[30:31], v[14:15], v[16:17]
    v_pk_add_f32 v[24:25], v[24:25], v[26:27]
    v_pk_add_f32 v[28:29], v[28:29], v[30:31]
    v_add_f32 v18, v24, v25
    v_add_f32 v19, v28, v29
    v_rcp_f32 v18, v18
    v_rcp_f32 v19, v19
    s_nop 0
    v_pk_mul_f32 v[2:3], v[2:3], v[18:19] op_sel:[0,0] op_sel_hi:[1,0]
    v_pk_mul_f32 v[4:5], v[4:5], v[18:19] op_sel:[0,0] op_sel_hi:[1,0]
    v_pk_mul_f32 v[6:7], v[6:7], v[18:19] op_sel:[0,0] op_sel_hi:[1,0]
    v_pk_mul_f32 v[8:9], v[8:9], v[18:19] op_sel:[0,0] op_sel_hi:[1,0]
    v_pk_mul_f32 v[10:11], v[10:11], v[18:19] op_sel:[0,1] op_sel_hi:[1,1]
    v_pk_mul_f32 v[12:13], v[12:13], v[18:19] op_sel:[0,1] op_sel_hi:[1,1]
    v_pk_mul_f32 v[14:15], v[14:15], v[18:19] op_sel:[0,1] op_sel_hi:[1,1]
    v_pk_mul_f32 v[16:17], v[16:17], v[18:19] op_sel:[0,1] op_sel_hi:[1,1]
    v_bfe_u32 v47, v1, 3, 2
    v_lshlrev_b32 v47, 10, v47
    v_and_b32 v48, 7, v1
    v_lshl_add_u32 v47, v48, 4, v47
    v_lshl_add_u32 v46, v21, 7, v47
    v_mad_u32_u24 v44, v21, s87, v47
    v_mad_u32_u24 v45, v21, s88, v47
    v_lshlrev_b32 v56, 7, v1
    v_cmp_gt_u32 vcc, 2, v1
    v_mov_b32 v57, 2146435072
    v_add_u32 v58, s89, v62
    v_cndmask_b32 v56, v57, v56, vcc

    s_waitcnt lgkmcnt(0)
    v_lshlrev_b32 v244, 16, v74
    v_and_b32 v245, s45, v74
    v_lshlrev_b32 v246, 16, v75
    v_and_b32 v247, s45, v75
    v_lshlrev_b32 v248, 16, v76
    v_and_b32 v249, s45, v76
    v_lshlrev_b32 v250, 16, v77
    v_and_b32 v251, s45, v77
    v_lshlrev_b32 v252, 16, v78
    v_and_b32 v253, s45, v78
    buffer_load_dwordx4 a[248:251], v63, s[20:23], s51 offen offset:2048 sc1
    v_pk_mul_f32 v[64:65], v[244:245], v[10:11] op_sel:[0,0] op_sel_hi:[1,0]
    v_pk_mul_f32 v[66:67], v[246:247], v[10:11] op_sel:[0,0] op_sel_hi:[1,0]
    v_pk_mul_f32 v[68:69], v[248:249], v[10:11] op_sel:[0,0] op_sel_hi:[1,0]
    v_pk_mul_f32 v[70:71], v[250:251], v[10:11] op_sel:[0,0] op_sel_hi:[1,0]
    v_pk_mul_f32 v[72:73], v[252:253], v[10:11] op_sel:[0,0] op_sel_hi:[1,0]
    v_lshlrev_b32 v244, 16, v79
    v_and_b32 v245, s45, v79
    v_lshlrev_b32 v246, 16, v80
    v_and_b32 v247, s45, v80
    v_lshlrev_b32 v248, 16, v81
    v_and_b32 v249, s45, v81
    v_lshlrev_b32 v250, 16, v82
    v_and_b32 v251, s45, v82
    v_lshlrev_b32 v252, 16, v83
    v_and_b32 v253, s45, v83
    buffer_load_dwordx4 a[252:255], v63, s[20:23], s51 offen offset:3072 sc1
    v_pk_mul_f32 v[84:85], v[244:245], v[10:11] op_sel:[0,0] op_sel_hi:[1,0]
    v_pk_mul_f32 v[86:87], v[246:247], v[10:11] op_sel:[0,0] op_sel_hi:[1,0]
    v_pk_mul_f32 v[88:89], v[248:249], v[10:11] op_sel:[0,0] op_sel_hi:[1,0]
    v_pk_mul_f32 v[90:91], v[250:251], v[10:11] op_sel:[0,0] op_sel_hi:[1,0]
    v_pk_mul_f32 v[92:93], v[252:253], v[10:11] op_sel:[0,0] op_sel_hi:[1,0]
    v_lshlrev_b32 v244, 16, v94
    v_and_b32 v245, s45, v94
    v_lshlrev_b32 v246, 16, v95
    v_and_b32 v247, s45, v95
    v_lshlrev_b32 v248, 16, v96
    v_and_b32 v249, s45, v96
    v_lshlrev_b32 v250, 16, v97
    v_and_b32 v251, s45, v97
    v_lshlrev_b32 v252, 16, v98
    v_and_b32 v253, s45, v98
    s_cmp_ge_u32 s6, 4
    s_cselect_b32 s51, 12, 0
    s_sub_i32 s51, 8, s51
    s_mul_i32 s51, s51, 40960
    s_add_u32 s51, s51, s46
    s_add_u32 m0, s89, 0
    s_nop 0
    buffer_load_dwordx4 v62, s[20:23], s51 offen offset:0 sc1 lds
    v_pk_mul_f32 v[24:25], v[244:245], v[2:3] op_sel:[0,0] op_sel_hi:[1,0]
    v_pk_mul_f32 v[26:27], v[246:247], v[2:3] op_sel:[0,0] op_sel_hi:[1,0]
    v_pk_mul_f32 v[28:29], v[248:249], v[2:3] op_sel:[0,0] op_sel_hi:[1,0]
    v_pk_mul_f32 v[30:31], v[250:251], v[2:3] op_sel:[0,0] op_sel_hi:[1,0]
    v_pk_mul_f32 v[32:33], v[252:253], v[2:3] op_sel:[0,0] op_sel_hi:[1,0]
    v_pk_fma_f32 v[64:65], v[244:245], v[10:11], v[64:65] op_sel:[0,1,0] op_sel_hi:[1,1,1]
    v_pk_fma_f32 v[66:67], v[246:247], v[10:11], v[66:67] op_sel:[0,1,0] op_sel_hi:[1,1,1]
    v_pk_fma_f32 v[68:69], v[248:249], v[10:11], v[68:69] op_sel:[0,1,0] op_sel_hi:[1,1,1]
    v_pk_fma_f32 v[70:71], v[250:251], v[10:11], v[70:71] op_sel:[0,1,0] op_sel_hi:[1,1,1]
    v_pk_fma_f32 v[72:73], v[252:253], v[10:11], v[72:73] op_sel:[0,1,0] op_sel_hi:[1,1,1]
    v_lshlrev_b32 v244, 16, v99
    v_and_b32 v245, s45, v99
    v_lshlrev_b32 v246, 16, v100
    v_and_b32 v247, s45, v100
    v_lshlrev_b32 v248, 16, v101
    v_and_b32 v249, s45, v101
    v_lshlrev_b32 v250, 16, v102
    v_and_b32 v251, s45, v102
    v_lshlrev_b32 v252, 16, v103
    v_and_b32 v253, s45, v103
    buffer_load_dwordx4 v62, s[20:23], s51 offen offset:1024 sc1 lds
    v_pk_mul_f32 v[34:35], v[244:245], v[2:3] op_sel:[0,0] op_sel_hi:[1,0]
    v_pk_mul_f32 v[36:37], v[246:247], v[2:3] op_sel:[0,0] op_sel_hi:[1,0]
    v_pk_mul_f32 v[38:39], v[248:249], v[2:3] op_sel:[0,0] op_sel_hi:[1,0]
    v_pk_mul_f32 v[40:41], v[250:251], v[2:3] op_sel:[0,0] op_sel_hi:[1,0]
    v_pk_mul_f32 v[42:43], v[252:253], v[2:3] op_sel:[0,0] op_sel_hi:[1,0]
    v_pk_fma_f32 v[84:85], v[244:245], v[10:11], v[84:85] op_sel:[0,1,0] op_sel_hi:[1,1,1]
    v_pk_fma_f32 v[86:87], v[246:247], v[10:11], v[86:87] op_sel:[0,1,0] op_sel_hi:[1,1,1]
    v_pk_fma_f32 v[88:89], v[248:249], v[10:11], v[88:89] op_sel:[0,1,0] op_sel_hi:[1,1,1]
    v_pk_fma_f32 v[90:91], v[250:251], v[10:11], v[90:91] op_sel:[0,1,0] op_sel_hi:[1,1,1]
    v_pk_fma_f32 v[92:93], v[252:253], v[10:11], v[92:93] op_sel:[0,1,0] op_sel_hi:[1,1,1]
    v_lshlrev_b32 v244, 16, v114
    v_and_b32 v245, s45, v114
    v_lshlrev_b32 v246, 16, v115
    v_and_b32 v247, s45, v115
    v_lshlrev_b32 v248, 16, v116
    v_and_b32 v249, s45, v116
    v_lshlrev_b32 v250, 16, v117
    v_and_b32 v251, s45, v117
    v_lshlrev_b32 v252, 16, v118
    v_and_b32 v253, s45, v118
    buffer_load_dwordx4 v62, s[20:23], s51 offen offset:2048 sc1 lds
    v_pk_fma_f32 v[24:25], v[244:245], v[2:3], v[24:25] op_sel:[0,1,0] op_sel_hi:[1,1,1]
    v_pk_fma_f32 v[26:27], v[246:247], v[2:3], v[26:27] op_sel:[0,1,0] op_sel_hi:[1,1,1]
    v_pk_fma_f32 v[28:29], v[248:249], v[2:3], v[28:29] op_sel:[0,1,0] op_sel_hi:[1,1,1]
    v_pk_fma_f32 v[30:31], v[250:251], v[2:3], v[30:31] op_sel:[0,1,0] op_sel_hi:[1,1,1]
    v_pk_fma_f32 v[32:33], v[252:253], v[2:3], v[32:33] op_sel:[0,1,0] op_sel_hi:[1,1,1]
    v_pk_fma_f32 v[64:65], v[244:245], v[12:13], v[64:65] op_sel:[0,0,0] op_sel_hi:[1,0,1]
    v_pk_fma_f32 v[66:67], v[246:247], v[12:13], v[66:67] op_sel:[0,0,0] op_sel_hi:[1,0,1]
    v_pk_fma_f32 v[68:69], v[248:249], v[12:13], v[68:69] op_sel:[0,0,0] op_sel_hi:[1,0,1]
    v_pk_fma_f32 v[70:71], v[250:251], v[12:13], v[70:71] op_sel:[0,0,0] op_sel_hi:[1,0,1]
    v_pk_fma_f32 v[72:73], v[252:253], v[12:13], v[72:73] op_sel:[0,0,0] op_sel_hi:[1,0,1]
    v_lshlrev_b32 v244, 16, v119
    v_and_b32 v245, s45, v119
    v_lshlrev_b32 v246, 16, v120
    v_and_b32 v247, s45, v120
    v_lshlrev_b32 v248, 16, v121
    v_and_b32 v249, s45, v121
    v_lshlrev_b32 v250, 16, v122
    v_and_b32 v251, s45, v122
    v_lshlrev_b32 v252, 16, v123
    v_and_b32 v253, s45, v123
    buffer_load_dwordx4 v62, s[20:23], s51 offen offset:3072 sc1 lds
    v_pk_fma_f32 v[34:35], v[244:245], v[2:3], v[34:35] op_sel:[0,1,0] op_sel_hi:[1,1,1]
    v_pk_fma_f32 v[36:37], v[246:247], v[2:3], v[36:37] op_sel:[0,1,0] op_sel_hi:[1,1,1]
    v_pk_fma_f32 v[38:39], v[248:249], v[2:3], v[38:39] op_sel:[0,1,0] op_sel_hi:[1,1,1]
    v_pk_fma_f32 v[40:41], v[250:251], v[2:3], v[40:41] op_sel:[0,1,0] op_sel_hi:[1,1,1]
    v_pk_fma_f32 v[42:43], v[252:253], v[2:3], v[42:43] op_sel:[0,1,0] op_sel_hi:[1,1,1]
    v_pk_fma_f32 v[84:85], v[244:245], v[12:13], v[84:85] op_sel:[0,0,0] op_sel_hi:[1,0,1]
    v_pk_fma_f32 v[86:87], v[246:247], v[12:13], v[86:87] op_sel:[0,0,0] op_sel_hi:[1,0,1]
    v_pk_fma_f32 v[88:89], v[248:249], v[12:13], v[88:89] op_sel:[0,0,0] op_sel_hi:[1,0,1]
    v_pk_fma_f32 v[90:91], v[250:251], v[12:13], v[90:91] op_sel:[0,0,0] op_sel_hi:[1,0,1]
    v_pk_fma_f32 v[92:93], v[252:253], v[12:13], v[92:93] op_sel:[0,0,0] op_sel_hi:[1,0,1]
    v_lshlrev_b32 v244, 16, v134
    v_and_b32 v245, s45, v134
    v_lshlrev_b32 v246, 16, v135
    v_and_b32 v247, s45, v135
    v_lshlrev_b32 v248, 16, v136
    v_and_b32 v249, s45, v136
    v_lshlrev_b32 v250, 16, v137
    v_and_b32 v251, s45, v137
    v_lshlrev_b32 v252, 16, v138
    v_and_b32 v253, s45, v138
    s_add_u32 m0, s89, 1024
    s_nop 0
    buffer_load_dwordx4 v63, s[20:23], s51 offen offset:3072 sc1 lds
    v_pk_fma_f32 v[24:25], v[244:245], v[4:5], v[24:25] op_sel:[0,0,0] op_sel_hi:[1,0,1]
    v_pk_fma_f32 v[26:27], v[246:247], v[4:5], v[26:27] op_sel:[0,0,0] op_sel_hi:[1,0,1]
    v_pk_fma_f32 v[28:29], v[248:249], v[4:5], v[28:29] op_sel:[0,0,0] op_sel_hi:[1,0,1]
    v_pk_fma_f32 v[30:31], v[250:251], v[4:5], v[30:31] op_sel:[0,0,0] op_sel_hi:[1,0,1]
    v_pk_fma_f32 v[32:33], v[252:253], v[4:5], v[32:33] op_sel:[0,0,0] op_sel_hi:[1,0,1]
    v_pk_fma_f32 v[64:65], v[244:245], v[12:13], v[64:65] op_sel:[0,1,0] op_sel_hi:[1,1,1]
    v_pk_fma_f32 v[66:67], v[246:247], v[12:13], v[66:67] op_sel:[0,1,0] op_sel_hi:[1,1,1]
    v_pk_fma_f32 v[68:69], v[248:249], v[12:13], v[68:69] op_sel:[0,1,0] op_sel_hi:[1,1,1]
    v_pk_fma_f32 v[70:71], v[250:251], v[12:13], v[70:71] op_sel:[0,1,0] op_sel_hi:[1,1,1]
    v_pk_fma_f32 v[72:73], v[252:253], v[12:13], v[72:73] op_sel:[0,1,0] op_sel_hi:[1,1,1]
    v_lshlrev_b32 v244, 16, v139
    v_and_b32 v245, s45, v139
    v_lshlrev_b32 v246, 16, v140
    v_and_b32 v247, s45, v140
    v_lshlrev_b32 v248, 16, v141
    v_and_b32 v249, s45, v141
    v_lshlrev_b32 v250, 16, v142
    v_and_b32 v251, s45, v142
    v_lshlrev_b32 v252, 16, v143
    v_and_b32 v253, s45, v143
    s_cmp_ge_u32 s6, 3
    s_cselect_b32 s51, 12, 0
    s_sub_i32 s51, 9, s51
    s_mul_i32 s51, s51, 40960
    s_add_u32 s51, s51, s46
    s_add_u32 m0, s89, 5120
    s_nop 0
    buffer_load_dwordx4 v62, s[20:23], s51 offen offset:0 sc1 lds
    v_pk_fma_f32 v[34:35], v[244:245], v[4:5], v[34:35] op_sel:[0,0,0] op_sel_hi:[1,0,1]
    v_pk_fma_f32 v[36:37], v[246:247], v[4:5], v[36:37] op_sel:[0,0,0] op_sel_hi:[1,0,1]
    v_pk_fma_f32 v[38:39], v[248:249], v[4:5], v[38:39] op_sel:[0,0,0] op_sel_hi:[1,0,1]
    v_pk_fma_f32 v[40:41], v[250:251], v[4:5], v[40:41] op_sel:[0,0,0] op_sel_hi:[1,0,1]
    v_pk_fma_f32 v[42:43], v[252:253], v[4:5], v[42:43] op_sel:[0,0,0] op_sel_hi:[1,0,1]
    v_pk_fma_f32 v[84:85], v[244:245], v[12:13], v[84:85] op_sel:[0,1,0] op_sel_hi:[1,1,1]
    v_pk_fma_f32 v[86:87], v[246:247], v[12:13], v[86:87] op_sel:[0,1,0] op_sel_hi:[1,1,1]
    v_pk_fma_f32 v[88:89], v[248:249], v[12:13], v[88:89] op_sel:[0,1,0] op_sel_hi:[1,1,1]
    v_pk_fma_f32 v[90:91], v[250:251], v[12:13], v[90:91] op_sel:[0,1,0] op_sel_hi:[1,1,1]
    v_pk_fma_f32 v[92:93], v[252:253], v[12:13], v[92:93] op_sel:[0,1,0] op_sel_hi:[1,1,1]
    v_lshlrev_b32 v244, 16, v154
    v_and_b32 v245, s45, v154
    v_lshlrev_b32 v246, 16, v155
    v_and_b32 v247, s45, v155
    v_lshlrev_b32 v248, 16, v156
    v_and_b32 v249, s45, v156
    v_lshlrev_b32 v250, 16, v157
    v_and_b32 v251, s45, v157
    v_lshlrev_b32 v252, 16, v158
    v_and_b32 v253, s45, v158
    buffer_load_dwordx4 v62, s[20:23], s51 offen offset:1024 sc1 lds
    buffer_load_dwordx4 v62, s[20:23], s51 offen offset:2048 sc1 lds
    v_pk_fma_f32 v[24:25], v[244:245], v[4:5], v[24:25] op_sel:[0,1,0] op_sel_hi:[1,1,1]
    v_pk_fma_f32 v[26:27], v[246:247], v[4:5], v[26:27] op_sel:[0,1,0] op_sel_hi:[1,1,1]
    v_pk_fma_f32 v[28:29], v[248:249], v[4:5], v[28:29] op_sel:[0,1,0] op_sel_hi:[1,1,1]
    v_pk_fma_f32 v[30:31], v[250:251], v[4:5], v[30:31] op_sel:[0,1,0] op_sel_hi:[1,1,1]
    v_pk_fma_f32 v[32:33], v[252:253], v[4:5], v[32:33] op_sel:[0,1,0] op_sel_hi:[1,1,1]
    v_pk_fma_f32 v[64:65], v[244:245], v[14:15], v[64:65] op_sel:[0,0,0] op_sel_hi:[1,0,1]
    v_pk_fma_f32 v[66:67], v[246:247], v[14:15], v[66:67] op_sel:[0,0,0] op_sel_hi:[1,0,1]
    v_pk_fma_f32 v[68:69], v[248:249], v[14:15], v[68:69] op_sel:[0,0,0] op_sel_hi:[1,0,1]
    v_pk_fma_f32 v[70:71], v[250:251], v[14:15], v[70:71] op_sel:[0,0,0] op_sel_hi:[1,0,1]
    v_pk_fma_f32 v[72:73], v[252:253], v[14:15], v[72:73] op_sel:[0,0,0] op_sel_hi:[1,0,1]
    v_lshlrev_b32 v244, 16, v159
    v_and_b32 v245, s45, v159
    v_lshlrev_b32 v246, 16, v160
    v_and_b32 v247, s45, v160
    v_lshlrev_b32 v248, 16, v161
    v_and_b32 v249, s45, v161
    v_lshlrev_b32 v250, 16, v162
    v_and_b32 v251, s45, v162
    v_lshlrev_b32 v252, 16, v163
    v_and_b32 v253, s45, v163
    buffer_load_dwordx4 v62, s[20:23], s51 offen offset:3072 sc1 lds
    s_add_u32 m0, s89, 6144
    s_nop 0
    buffer_load_dwordx4 v63, s[20:23], s51 offen offset:3072 sc1 lds
    v_pk_fma_f32 v[34:35], v[244:245], v[4:5], v[34:35] op_sel:[0,1,0] op_sel_hi:[1,1,1]
    v_pk_fma_f32 v[36:37], v[246:247], v[4:5], v[36:37] op_sel:[0,1,0] op_sel_hi:[1,1,1]
    v_pk_fma_f32 v[38:39], v[248:249], v[4:5], v[38:39] op_sel:[0,1,0] op_sel_hi:[1,1,1]
    v_pk_fma_f32 v[40:41], v[250:251], v[4:5], v[40:41] op_sel:[0,1,0] op_sel_hi:[1,1,1]
    v_pk_fma_f32 v[42:43], v[252:253], v[4:5], v[42:43] op_sel:[0,1,0] op_sel_hi:[1,1,1]
    v_pk_fma_f32 v[84:85], v[244:245], v[14:15], v[84:85] op_sel:[0,0,0] op_sel_hi:[1,0,1]
    v_pk_fma_f32 v[86:87], v[246:247], v[14:15], v[86:87] op_sel:[0,0,0] op_sel_hi:[1,0,1]
    v_pk_fma_f32 v[88:89], v[248:249], v[14:15], v[88:89] op_sel:[0,0,0] op_sel_hi:[1,0,1]
    v_pk_fma_f32 v[90:91], v[250:251], v[14:15], v[90:91] op_sel:[0,0,0] op_sel_hi:[1,0,1]
    v_pk_fma_f32 v[92:93], v[252:253], v[14:15], v[92:93] op_sel:[0,0,0] op_sel_hi:[1,0,1]
    v_lshlrev_b32 v244, 16, v174
    v_and_b32 v245, s45, v174
    v_lshlrev_b32 v246, 16, v175
    v_and_b32 v247, s45, v175
    v_lshlrev_b32 v248, 16, v176
    v_and_b32 v249, s45, v176
    v_lshlrev_b32 v250, 16, v177
    v_and_b32 v251, s45, v177
    v_lshlrev_b32 v252, 16, v178
    v_and_b32 v253, s45, v178
    s_cmp_ge_u32 s6, 2
    s_cselect_b32 s51, 12, 0
    s_sub_i32 s51, 10, s51
    s_mul_i32 s51, s51, 40960
    s_add_u32 s51, s51, s46
    s_add_u32 m0, s89, 10240
    s_nop 0
    buffer_load_dwordx4 v62, s[20:23], s51 offen offset:0 sc1 lds
    buffer_load_dwordx4 v62, s[20:23], s51 offen offset:1024 sc1 lds
    v_pk_fma_f32 v[24:25], v[244:245], v[6:7], v[24:25] op_sel:[0,0,0] op_sel_hi:[1,0,1]
    v_pk_fma_f32 v[26:27], v[246:247], v[6:7], v[26:27] op_sel:[0,0,0] op_sel_hi:[1,0,1]
    v_pk_fma_f32 v[28:29], v[248:249], v[6:7], v[28:29] op_sel:[0,0,0] op_sel_hi:[1,0,1]
    v_pk_fma_f32 v[30:31], v[250:251], v[6:7], v[30:31] op_sel:[0,0,0] op_sel_hi:[1,0,1]
    v_pk_fma_f32 v[32:33], v[252:253], v[6:7], v[32:33] op_sel:[0,0,0] op_sel_hi:[1,0,1]
    v_pk_fma_f32 v[64:65], v[244:245], v[14:15], v[64:65] op_sel:[0,1,0] op_sel_hi:[1,1,1]
    v_pk_fma_f32 v[66:67], v[246:247], v[14:15], v[66:67] op_sel:[0,1,0] op_sel_hi:[1,1,1]
    v_pk_fma_f32 v[68:69], v[248:249], v[14:15], v[68:69] op_sel:[0,1,0] op_sel_hi:[1,1,1]
    v_pk_fma_f32 v[70:71], v[250:251], v[14:15], v[70:71] op_sel:[0,1,0] op_sel_hi:[1,1,1]
    v_pk_fma_f32 v[72:73], v[252:253], v[14:15], v[72:73] op_sel:[0,1,0] op_sel_hi:[1,1,1]
    v_lshlrev_b32 v244, 16, v179
    v_and_b32 v245, s45, v179
    v_lshlrev_b32 v246, 16, v180
    v_and_b32 v247, s45, v180
    v_lshlrev_b32 v248, 16, v181
    v_and_b32 v249, s45, v181
    v_lshlrev_b32 v250, 16, v182
    v_and_b32 v251, s45, v182
    v_lshlrev_b32 v252, 16, v183
    v_and_b32 v253, s45, v183
    buffer_load_dwordx4 v62, s[20:23], s51 offen offset:2048 sc1 lds
    buffer_load_dwordx4 v62, s[20:23], s51 offen offset:3072 sc1 lds
    v_pk_fma_f32 v[34:35], v[244:245], v[6:7], v[34:35] op_sel:[0,0,0] op_sel_hi:[1,0,1]
    v_pk_fma_f32 v[36:37], v[246:247], v[6:7], v[36:37] op_sel:[0,0,0] op_sel_hi:[1,0,1]
    v_pk_fma_f32 v[38:39], v[248:249], v[6:7], v[38:39] op_sel:[0,0,0] op_sel_hi:[1,0,1]
    v_pk_fma_f32 v[40:41], v[250:251], v[6:7], v[40:41] op_sel:[0,0,0] op_sel_hi:[1,0,1]
    v_pk_fma_f32 v[42:43], v[252:253], v[6:7], v[42:43] op_sel:[0,0,0] op_sel_hi:[1,0,1]
    v_pk_fma_f32 v[84:85], v[244:245], v[14:15], v[84:85] op_sel:[0,1,0] op_sel_hi:[1,1,1]
    v_pk_fma_f32 v[86:87], v[246:247], v[14:15], v[86:87] op_sel:[0,1,0] op_sel_hi:[1,1,1]
    v_pk_fma_f32 v[88:89], v[248:249], v[14:15], v[88:89] op_sel:[0,1,0] op_sel_hi:[1,1,1]
    v_pk_fma_f32 v[90:91], v[250:251], v[14:15], v[90:91] op_sel:[0,1,0] op_sel_hi:[1,1,1]
    v_pk_fma_f32 v[92:93], v[252:253], v[14:15], v[92:93] op_sel:[0,1,0] op_sel_hi:[1,1,1]
    v_lshlrev_b32 v244, 16, v194
    v_and_b32 v245, s45, v194
    v_lshlrev_b32 v246, 16, v195
    v_and_b32 v247, s45, v195
    v_lshlrev_b32 v248, 16, v196
    v_and_b32 v249, s45, v196
    v_lshlrev_b32 v250, 16, v197
    v_and_b32 v251, s45, v197
    v_lshlrev_b32 v252, 16, v198
    v_and_b32 v253, s45, v198
    s_add_u32 m0, s89, 11264
    s_nop 0
    buffer_load_dwordx4 v63, s[20:23], s51 offen offset:3072 sc1 lds
    s_cmp_ge_u32 s6, 1
    s_cselect_b32 s51, 12, 0
    s_sub_i32 s51, 11, s51
    s_mul_i32 s51, s51, 40960
    s_add_u32 s51, s51, s46
    s_add_u32 m0, s89, 15360
    s_nop 0
    buffer_load_dwordx4 v62, s[20:23], s51 offen offset:0 sc1 lds
    v_pk_fma_f32 v[24:25], v[244:245], v[6:7], v[24:25] op_sel:[0,1,0] op_sel_hi:[1,1,1]
    v_pk_fma_f32 v[26:27], v[246:247], v[6:7], v[26:27] op_sel:[0,1,0] op_sel_hi:[1,1,1]
    v_pk_fma_f32 v[28:29], v[248:249], v[6:7], v[28:29] op_sel:[0,1,0] op_sel_hi:[1,1,1]
    v_pk_fma_f32 v[30:31], v[250:251], v[6:7], v[30:31] op_sel:[0,1,0] op_sel_hi:[1,1,1]
    v_pk_fma_f32 v[32:33], v[252:253], v[6:7], v[32:33] op_sel:[0,1,0] op_sel_hi:[1,1,1]
    v_pk_fma_f32 v[64:65], v[244:245], v[16:17], v[64:65] op_sel:[0,0,0] op_sel_hi:[1,0,1]
    v_pk_fma_f32 v[66:67], v[246:247], v[16:17], v[66:67] op_sel:[0,0,0] op_sel_hi:[1,0,1]
    v_pk_fma_f32 v[68:69], v[248:249], v[16:17], v[68:69] op_sel:[0,0,0] op_sel_hi:[1,0,1]
    v_pk_fma_f32 v[70:71], v[250:251], v[16:17], v[70:71] op_sel:[0,0,0] op_sel_hi:[1,0,1]
    v_pk_fma_f32 v[72:73], v[252:253], v[16:17], v[72:73] op_sel:[0,0,0] op_sel_hi:[1,0,1]
    v_lshlrev_b32 v244, 16, v199
    v_and_b32 v245, s45, v199
    v_lshlrev_b32 v246, 16, v200
    v_and_b32 v247, s45, v200
    v_lshlrev_b32 v248, 16, v201
    v_and_b32 v249, s45, v201
    v_lshlrev_b32 v250, 16, v202
    v_and_b32 v251, s45, v202
    v_lshlrev_b32 v252, 16, v203
    v_and_b32 v253, s45, v203
    buffer_load_dwordx4 v62, s[20:23], s51 offen offset:1024 sc1 lds
    buffer_load_dwordx4 v62, s[20:23], s51 offen offset:2048 sc1 lds
    v_pk_fma_f32 v[34:35], v[244:245], v[6:7], v[34:35] op_sel:[0,1,0] op_sel_hi:[1,1,1]
    v_pk_fma_f32 v[36:37], v[246:247], v[6:7], v[36:37] op_sel:[0,1,0] op_sel_hi:[1,1,1]
    v_pk_fma_f32 v[38:39], v[248:249], v[6:7], v[38:39] op_sel:[0,1,0] op_sel_hi:[1,1,1]
    v_pk_fma_f32 v[40:41], v[250:251], v[6:7], v[40:41] op_sel:[0,1,0] op_sel_hi:[1,1,1]
    v_pk_fma_f32 v[42:43], v[252:253], v[6:7], v[42:43] op_sel:[0,1,0] op_sel_hi:[1,1,1]
    v_pk_fma_f32 v[84:85], v[244:245], v[16:17], v[84:85] op_sel:[0,0,0] op_sel_hi:[1,0,1]
    v_pk_fma_f32 v[86:87], v[246:247], v[16:17], v[86:87] op_sel:[0,0,0] op_sel_hi:[1,0,1]
    v_pk_fma_f32 v[88:89], v[248:249], v[16:17], v[88:89] op_sel:[0,0,0] op_sel_hi:[1,0,1]
    v_pk_fma_f32 v[90:91], v[250:251], v[16:17], v[90:91] op_sel:[0,0,0] op_sel_hi:[1,0,1]
    v_pk_fma_f32 v[92:93], v[252:253], v[16:17], v[92:93] op_sel:[0,0,0] op_sel_hi:[1,0,1]
    v_lshlrev_b32 v244, 16, v214
    v_and_b32 v245, s45, v214
    v_lshlrev_b32 v246, 16, v215
    v_and_b32 v247, s45, v215
    v_lshlrev_b32 v248, 16, v216
    v_and_b32 v249, s45, v216
    v_lshlrev_b32 v250, 16, v217
    v_and_b32 v251, s45, v217
    v_lshlrev_b32 v252, 16, v218
    v_and_b32 v253, s45, v218
    buffer_load_dwordx4 v62, s[20:23], s51 offen offset:3072 sc1 lds
    s_add_u32 m0, s89, 16384
    s_nop 0
    buffer_load_dwordx4 v63, s[20:23], s51 offen offset:3072 sc1 lds
    buffer_load_dword v57, v56, s[20:23], s41 offen offset:1024 sc1 nt
    v_pk_fma_f32 v[24:25], v[244:245], v[8:9], v[24:25] op_sel:[0,0,0] op_sel_hi:[1,0,1]
    v_pk_fma_f32 v[26:27], v[246:247], v[8:9], v[26:27] op_sel:[0,0,0] op_sel_hi:[1,0,1]
    v_pk_fma_f32 v[28:29], v[248:249], v[8:9], v[28:29] op_sel:[0,0,0] op_sel_hi:[1,0,1]
    v_pk_fma_f32 v[30:31], v[250:251], v[8:9], v[30:31] op_sel:[0,0,0] op_sel_hi:[1,0,1]
    v_pk_fma_f32 v[32:33], v[252:253], v[8:9], v[32:33] op_sel:[0,0,0] op_sel_hi:[1,0,1]
    v_pk_fma_f32 v[64:65], v[244:245], v[16:17], v[64:65] op_sel:[0,1,0] op_sel_hi:[1,1,1]
    v_pk_fma_f32 v[66:67], v[246:247], v[16:17], v[66:67] op_sel:[0,1,0] op_sel_hi:[1,1,1]
    v_pk_fma_f32 v[68:69], v[248:249], v[16:17], v[68:69] op_sel:[0,1,0] op_sel_hi:[1,1,1]
    v_pk_fma_f32 v[70:71], v[250:251], v[16:17], v[70:71] op_sel:[0,1,0] op_sel_hi:[1,1,1]
    v_pk_fma_f32 v[72:73], v[252:253], v[16:17], v[72:73] op_sel:[0,1,0] op_sel_hi:[1,1,1]
    v_lshlrev_b32 v244, 16, v219
    v_and_b32 v245, s45, v219
    v_lshlrev_b32 v246, 16, v220
    v_and_b32 v247, s45, v220
    v_lshlrev_b32 v248, 16, v221
    v_and_b32 v249, s45, v221
    v_lshlrev_b32 v250, 16, v222
    v_and_b32 v251, s45, v222
    v_lshlrev_b32 v252, 16, v223
    v_and_b32 v253, s45, v223
    v_pk_fma_f32 v[34:35], v[244:245], v[8:9], v[34:35] op_sel:[0,0,0] op_sel_hi:[1,0,1]
    v_pk_fma_f32 v[36:37], v[246:247], v[8:9], v[36:37] op_sel:[0,0,0] op_sel_hi:[1,0,1]
    v_pk_fma_f32 v[38:39], v[248:249], v[8:9], v[38:39] op_sel:[0,0,0] op_sel_hi:[1,0,1]
    v_pk_fma_f32 v[40:41], v[250:251], v[8:9], v[40:41] op_sel:[0,0,0] op_sel_hi:[1,0,1]
    v_pk_fma_f32 v[42:43], v[252:253], v[8:9], v[42:43] op_sel:[0,0,0] op_sel_hi:[1,0,1]
    v_pk_fma_f32 v[84:85], v[244:245], v[16:17], v[84:85] op_sel:[0,1,0] op_sel_hi:[1,1,1]
    v_pk_fma_f32 v[86:87], v[246:247], v[16:17], v[86:87] op_sel:[0,1,0] op_sel_hi:[1,1,1]
    v_pk_fma_f32 v[88:89], v[248:249], v[16:17], v[88:89] op_sel:[0,1,0] op_sel_hi:[1,1,1]
    v_pk_fma_f32 v[90:91], v[250:251], v[16:17], v[90:91] op_sel:[0,1,0] op_sel_hi:[1,1,1]
    v_pk_fma_f32 v[92:93], v[252:253], v[16:17], v[92:93] op_sel:[0,1,0] op_sel_hi:[1,1,1]
    v_lshlrev_b32 v244, 16, v234
    v_and_b32 v245, s45, v234
    v_lshlrev_b32 v246, 16, v235
    v_and_b32 v247, s45, v235
    v_lshlrev_b32 v248, 16, v236
    v_and_b32 v249, s45, v236
    v_lshlrev_b32 v250, 16, v237
    v_and_b32 v251, s45, v237
    v_lshlrev_b32 v252, 16, v238
    v_and_b32 v253, s45, v238
    v_pk_fma_f32 v[24:25], v[244:245], v[8:9], v[24:25] op_sel:[0,1,0] op_sel_hi:[1,1,1]
    v_pk_fma_f32 v[26:27], v[246:247], v[8:9], v[26:27] op_sel:[0,1,0] op_sel_hi:[1,1,1]
    v_pk_fma_f32 v[28:29], v[248:249], v[8:9], v[28:29] op_sel:[0,1,0] op_sel_hi:[1,1,1]
    v_pk_fma_f32 v[30:31], v[250:251], v[8:9], v[30:31] op_sel:[0,1,0] op_sel_hi:[1,1,1]
    v_pk_fma_f32 v[32:33], v[252:253], v[8:9], v[32:33] op_sel:[0,1,0] op_sel_hi:[1,1,1]
    v_lshlrev_b32 v244, 16, v239
    v_and_b32 v245, s45, v239
    v_lshlrev_b32 v246, 16, v240
    v_and_b32 v247, s45, v240
    v_lshlrev_b32 v248, 16, v241
    v_and_b32 v249, s45, v241
    v_lshlrev_b32 v250, 16, v242
    v_and_b32 v251, s45, v242
    v_lshlrev_b32 v252, 16, v243
    v_and_b32 v253, s45, v243
    v_pk_fma_f32 v[34:35], v[244:245], v[8:9], v[34:35] op_sel:[0,1,0] op_sel_hi:[1,1,1]
    v_pk_fma_f32 v[36:37], v[246:247], v[8:9], v[36:37] op_sel:[0,1,0] op_sel_hi:[1,1,1]
    v_pk_fma_f32 v[38:39], v[248:249], v[8:9], v[38:39] op_sel:[0,1,0] op_sel_hi:[1,1,1]
    v_pk_fma_f32 v[40:41], v[250:251], v[8:9], v[40:41] op_sel:[0,1,0] op_sel_hi:[1,1,1]
    v_pk_fma_f32 v[42:43], v[252:253], v[8:9], v[42:43] op_sel:[0,1,0] op_sel_hi:[1,1,1]
    v_cvt_pk_bf16_f32 v136, v40, v41
    v_cvt_pk_bf16_f32 v137, v42, v43
    v_cvt_pk_bf16_f32 v120, v24, v25
    v_cvt_pk_bf16_f32 v121, v26, v27
    v_cvt_pk_bf16_f32 v122, v28, v29
    v_cvt_pk_bf16_f32 v123, v30, v31
    v_cvt_pk_bf16_f32 v124, v32, v33
    v_cvt_pk_bf16_f32 v125, v34, v35
    v_cvt_pk_bf16_f32 v126, v36, v37
    v_cvt_pk_bf16_f32 v127, v38, v39
    v_cvt_pk_bf16_f32 v138, v90, v91
    v_cvt_pk_bf16_f32 v139, v92, v93
    v_cvt_pk_bf16_f32 v128, v64, v65
    v_cvt_pk_bf16_f32 v129, v66, v67
    v_cvt_pk_bf16_f32 v130, v68, v69
    v_cvt_pk_bf16_f32 v131, v70, v71
    v_cvt_pk_bf16_f32 v132, v72, v73
    v_cvt_pk_bf16_f32 v133, v84, v85
    v_cvt_pk_bf16_f32 v134, v86, v87
    v_cvt_pk_bf16_f32 v135, v88, v89
    v_permlane32_swap_b32 v136, v138
    v_permlane32_swap_b32 v137, v139
    buffer_store_dwordx4 v[120:123], v44, s[20:23], s84 offen offset:0 sc1
    buffer_store_dwordx4 v[124:127], v45, s[20:23], s85 offen offset:0 sc1
    buffer_store_dwordx4 v[128:131], v44, s[20:23], s84 offen offset:128 sc1
    buffer_store_dwordx4 v[132:135], v45, s[20:23], s85 offen offset:128 sc1
    buffer_store_dwordx4 v[136:139], v46, s[20:23], s86 offen sc1
    v_add_u32 v10, s60, v62
    v_add_u32 v11, s61, v62
    v_add_u32 v14, s62, v62
    v_add_u32 v15, s63, v62
    s_waitcnt vmcnt(5)
    v_cmp_ne_u32 vcc, s52, v57
    s_and_b32 vcc_lo, vcc_lo, 3
    s_cbranch_scc1 LA_slowh
    buffer_load_dwordx4 v[96:99], v10, s[20:23], s12 offen sc1
    buffer_load_dwordx4 v[100:103], v11, s[20:23], s12 offen sc1
    buffer_load_dwordx4 v[104:107], v14, s[20:23], s12 offen sc1
    buffer_load_dwordx4 v[108:111], v15, s[20:23], s12 offen sc1
    buffer_load_dwordx4 v[112:115], v10, s[20:23], s13 offen sc1
    buffer_load_dwordx4 v[116:119], v11, s[20:23], s13 offen sc1
    buffer_load_dwordx4 v[120:123], v14, s[20:23], s13 offen sc1
    buffer_load_dwordx4 v[124:127], v15, s[20:23], s13 offen sc1
    buffer_load_dwordx4 v[128:131], v10, s[20:23], s14 offen sc1
    buffer_load_dwordx4 v[132:135], v11, s[20:23], s14 offen sc1
    buffer_load_dwordx4 v[136:139], v14, s[20:23], s14 offen sc1
    buffer_load_dwordx4 v[140:143], v15, s[20:23], s14 offen sc1
    buffer_load_dwordx4 v[144:147], v10, s[20:23], s15 offen sc1
    buffer_load_dwordx4 v[148:151], v11, s[20:23], s15 offen sc1
    buffer_load_dwordx4 v[152:155], v14, s[20:23], s15 offen sc1
    buffer_load_dwordx4 v[156:159], v15, s[20:23], s15 offen sc1
    ds_read_b128 v[160:163], v58 offset:0
    ds_read_b128 v[164:167], v58 offset:1024
    ds_read_b128 v[168:171], v58 offset:2048
    ds_read_b128 v[172:175], v58 offset:3072
    ds_read_b128 v[176:179], v58 offset:4096
    ds_read_b128 v[180:183], v58 offset:5120
    ds_read_b128 v[184:187], v58 offset:6144
    ds_read_b128 v[188:191], v58 offset:7168
    ds_read_b128 v[192:195], v58 offset:8192
    ds_read_b128 v[196:199], v58 offset:9216
    ds_read_b128 v[200:203], v58 offset:10240
    ds_read_b128 v[204:207], v58 offset:11264
    ds_read_b128 v[208:211], v58 offset:12288
    ds_read_b128 v[212:215], v58 offset:13312
    ds_read_b128 v[216:219], v58 offset:14336
    ds_read_b128 v[220:223], v58 offset:15360
    ds_read_b128 v[224:227], v58 offset:16384
    ds_read_b128 v[228:231], v58 offset:17408
    ds_read_b128 v[232:235], v58 offset:18432
    ds_read_b128 v[236:239], v58 offset:19456
    v_cmp_gt_u32 vcc, 64, v0
    v_mov_b32 v12, 2146435072
    v_lshrrev_b32 v13, 2, v0
    v_lshlrev_b32 v13, 11, v13
    v_and_b32 v6, 3, v0
    v_lshl_add_u32 v13, v6, 4, v13
    v_cndmask_b32 v12, v12, v13, vcc
    v_mov_b32 v244, s52
    v_mov_b32 v245, s52
    v_mov_b32 v246, s52
    v_mov_b32 v247, s52
    v_and_b32 v9, 1, v1
    v_bfe_u32 v6, v1, 3, 1
    v_lshl_add_u32 v9, v6, 1, v9
    v_bfe_u32 v6, v1, 1, 2
    v_lshl_add_u32 v9, v6, 2, v9
    v_mul_u32_u24 v5, 1280, v9
    v_lshrrev_b32 v6, 4, v1
    v_lshl_add_u32 v5, v6, 3, v5
    v_lshlrev_b32 v9, 4, v9
    v_cmp_gt_u32 vcc, 2, v1
    v_lshlrev_b32 v4, 7, v1
    v_mov_b32 v7, 2146435072
    v_cndmask_b32 v4, v7, v4, vcc
    v_mov_b32 v13, s52
    v_add_u32 v8, s4, v62
    v_add_u32 v2, s5, v62
    v_add_u32 v3, s54, v62
    v_add_u32 v6, s82, v62
    s_mov_b32 s30, 0xbfb8aa3b
    s_waitcnt lgkmcnt(0)
    s_branch L_go2
LA_slowh:
    ds_read_b128 v[160:163], v58 offset:0
    ds_read_b128 v[164:167], v58 offset:1024
    ds_read_b128 v[168:171], v58 offset:2048
    ds_read_b128 v[172:175], v58 offset:3072
    ds_read_b128 v[176:179], v58 offset:4096
    ds_read_b128 v[180:183], v58 offset:5120
    ds_read_b128 v[184:187], v58 offset:6144
    ds_read_b128 v[188:191], v58 offset:7168
    ds_read_b128 v[192:195], v58 offset:8192
    ds_read_b128 v[196:199], v58 offset:9216
    ds_read_b128 v[200:203], v58 offset:10240
    ds_read_b128 v[204:207], v58 offset:11264
    ds_read_b128 v[208:211], v58 offset:12288
    ds_read_b128 v[212:215], v58 offset:13312
    ds_read_b128 v[216:219], v58 offset:14336
    ds_read_b128 v[220:223], v58 offset:15360
    ds_read_b128 v[224:227], v58 offset:16384
    ds_read_b128 v[228:231], v58 offset:17408
    ds_read_b128 v[232:235], v58 offset:18432
    ds_read_b128 v[236:239], v58 offset:19456
    v_cmp_gt_u32 vcc, 64, v0
    v_mov_b32 v12, 2146435072
    v_lshrrev_b32 v13, 2, v0
    v_lshlrev_b32 v13, 11, v13
    v_and_b32 v6, 3, v0
    v_lshl_add_u32 v13, v6, 4, v13
    v_cndmask_b32 v12, v12, v13, vcc
    v_mov_b32 v244, s52
    v_mov_b32 v245, s52
    v_mov_b32 v246, s52
    v_mov_b32 v247, s52
    v_and_b32 v9, 1, v1
    v_bfe_u32 v6, v1, 3, 1
    v_lshl_add_u32 v9, v6, 1, v9
    v_bfe_u32 v6, v1, 1, 2
    v_lshl_add_u32 v9, v6, 2, v9
    v_mul_u32_u24 v5, 1280, v9
    v_lshrrev_b32 v6, 4, v1
    v_lshl_add_u32 v5, v6, 3, v5
    v_lshlrev_b32 v9, 4, v9
    v_cmp_gt_u32 vcc, 2, v1
    v_lshlrev_b32 v4, 7, v1
    v_mov_b32 v7, 2146435072
    v_cndmask_b32 v4, v7, v4, vcc
    v_mov_b32 v13, s52
    v_add_u32 v8, s4, v62
    v_add_u32 v2, s5, v62
    v_add_u32 v3, s54, v62
    v_add_u32 v6, s82, v62
    s_mov_b32 s30, 0xbfb8aa3b
    s_waitcnt lgkmcnt(0)
    s_branch L_pollh
L_pollh_go:
    buffer_load_dwordx4 v[96:99], v10, s[20:23], s12 offen sc1
    buffer_load_dwordx4 v[100:103], v11, s[20:23], s12 offen sc1
    buffer_load_dwordx4 v[104:107], v14, s[20:23], s12 offen sc1
    buffer_load_dwordx4 v[108:111], v15, s[20:23], s12 offen sc1
    buffer_load_dwordx4 v[112:115], v10, s[20:23], s13 offen sc1
    buffer_load_dwordx4 v[116:119], v11, s[20:23], s13 offen sc1
    buffer_load_dwordx4 v[120:123], v14, s[20:23], s13 offen sc1
    buffer_load_dwordx4 v[124:127], v15, s[20:23], s13 offen sc1
    buffer_load_dwordx4 v[128:131], v10, s[20:23], s14 offen sc1
    buffer_load_dwordx4 v[132:135], v11, s[20:23], s14 offen sc1
    buffer_load_dwordx4 v[136:139], v14, s[20:23], s14 offen sc1
    buffer_load_dwordx4 v[140:143], v15, s[20:23], s14 offen sc1
    buffer_load_dwordx4 v[144:147], v10, s[20:23], s15 offen sc1
    buffer_load_dwordx4 v[148:151], v11, s[20:23], s15 offen sc1
    buffer_load_dwordx4 v[152:155], v14, s[20:23], s15 offen sc1
    buffer_load_dwordx4 v[156:159], v15, s[20:23], s15 offen sc1
L_go2:
    s_waitcnt vmcnt(15)
    v_mfma_f32_16x16x32_bf16 v[16:19], a[56:59], v[96:99], 0
    v_mfma_f32_16x16x32_bf16 v[20:23], a[60:63], v[96:99], 0
    v_mfma_f32_16x16x32_bf16 v[24:27], a[64:67], v[96:99], 0
    v_mfma_f32_16x16x32_bf16 v[28:31], a[68:71], v[96:99], 0
    v_mfma_f32_16x16x32_bf16 v[32:35], a[72:75], v[96:99], 0
    buffer_load_dwordx4 v[96:99], v10, s[20:23], s16 offen sc1
    s_waitcnt vmcnt(15)
    s_barrier
    buffer_store_dwordx4 v[244:247], v12, s[20:23], s53 offen sc0 sc1
    v_mfma_f32_16x16x32_bf16 v[36:39], a[56:59], v[100:103], 0
    v_mfma_f32_16x16x32_bf16 v[40:43], a[60:63], v[100:103], 0
    v_mfma_f32_16x16x32_bf16 v[44:47], a[64:67], v[100:103], 0
    v_mfma_f32_16x16x32_bf16 v[48:51], a[68:71], v[100:103], 0
    v_mfma_f32_16x16x32_bf16 v[52:55], a[72:75], v[100:103], 0
    buffer_load_dwordx4 v[100:103], v11, s[20:23], s16 offen sc1
    s_waitcnt vmcnt(16)
    v_mfma_f32_16x16x32_bf16 v[56:59], a[56:59], v[104:107], 0
    v_mfma_f32_16x16x32_bf16 v[60:63], a[60:63], v[104:107], 0
    v_mfma_f32_16x16x32_bf16 v[64:67], a[64:67], v[104:107], 0
    v_mfma_f32_16x16x32_bf16 v[68:71], a[68:71], v[104:107], 0
    v_mfma_f32_16x16x32_bf16 v[72:75], a[72:75], v[104:107], 0
    buffer_load_dwordx4 v[104:107], v14, s[20:23], s16 offen sc1
    s_waitcnt vmcnt(16)
    v_mfma_f32_16x16x32_bf16 v[76:79], a[56:59], v[108:111], 0
    v_mfma_f32_16x16x32_bf16 v[80:83], a[60:63], v[108:111], 0
    v_mfma_f32_16x16x32_bf16 v[84:87], a[64:67], v[108:111], 0
    v_mfma_f32_16x16x32_bf16 v[88:91], a[68:71], v[108:111], 0
    v_mfma_f32_16x16x32_bf16 v[92:95], a[72:75], v[108:111], 0
    buffer_load_dwordx4 v[108:111], v15, s[20:23], s16 offen sc1
    s_waitcnt vmcnt(13)
    v_mfma_f32_16x16x32_bf16 v[16:19], a[76:79], v[112:115], v[16:19]
    v_mfma_f32_16x16x32_bf16 v[20:23], a[80:83], v[112:115], v[20:23]
    v_mfma_f32_16x16x32_bf16 v[24:27], a[84:87], v[112:115], v[24:27]
    v_mfma_f32_16x16x32_bf16 v[28:31], a[88:91], v[112:115], v[28:31]
    v_mfma_f32_16x16x32_bf16 v[32:35], a[92:95], v[112:115], v[32:35]
    buffer_load_dwordx4 v[112:115], v10, s[20:23], s17 offen sc1
    v_mfma_f32_16x16x32_bf16 v[36:39], a[76:79], v[116:119], v[36:39]
    v_mfma_f32_16x16x32_bf16 v[40:43], a[80:83], v[116:119], v[40:43]
    v_mfma_f32_16x16x32_bf16 v[44:47], a[84:87], v[116:119], v[44:47]
    v_mfma_f32_16x16x32_bf16 v[48:51], a[88:91], v[116:119], v[48:51]
    v_mfma_f32_16x16x32_bf16 v[52:55], a[92:95], v[116:119], v[52:55]
    buffer_load_dwordx4 v[116:119], v11, s[20:23], s17 offen sc1
    v_mfma_f32_16x16x32_bf16 v[56:59], a[76:79], v[120:123], v[56:59]
    v_mfma_f32_16x16x32_bf16 v[60:63], a[80:83], v[120:123], v[60:63]
    v_mfma_f32_16x16x32_bf16 v[64:67], a[84:87], v[120:123], v[64:67]
    v_mfma_f32_16x16x32_bf16 v[68:71], a[88:91], v[120:123], v[68:71]
    v_mfma_f32_16x16x32_bf16 v[72:75], a[92:95], v[120:123], v[72:75]
    buffer_load_dwordx4 v[120:123], v14, s[20:23], s17 offen sc1
    v_mfma_f32_16x16x32_bf16 v[76:79], a[76:79], v[124:127], v[76:79]
    v_mfma_f32_16x16x32_bf16 v[80:83], a[80:83], v[124:127], v[80:83]
    v_mfma_f32_16x16x32_bf16 v[84:87], a[84:87], v[124:127], v[84:87]
    v_mfma_f32_16x16x32_bf16 v[88:91], a[88:91], v[124:127], v[88:91]
    v_mfma_f32_16x16x32_bf16 v[92:95], a[92:95], v[124:127], v[92:95]
    buffer_load_dwordx4 v[124:127], v15, s[20:23], s17 offen sc1
    s_waitcnt vmcnt(13)
    v_mfma_f32_16x16x32_bf16 v[16:19], a[96:99], v[128:131], v[16:19]
    v_mfma_f32_16x16x32_bf16 v[20:23], a[100:103], v[128:131], v[20:23]
    v_mfma_f32_16x16x32_bf16 v[24:27], a[104:107], v[128:131], v[24:27]
    v_mfma_f32_16x16x32_bf16 v[28:31], a[108:111], v[128:131], v[28:31]
    v_mfma_f32_16x16x32_bf16 v[32:35], a[112:115], v[128:131], v[32:35]
    buffer_load_dwordx4 v[128:131], v10, s[20:23], s18 offen sc1
    v_mfma_f32_16x16x32_bf16 v[36:39], a[96:99], v[132:135], v[36:39]
    v_mfma_f32_16x16x32_bf16 v[40:43], a[100:103], v[132:135], v[40:43]
    v_mfma_f32_16x16x32_bf16 v[44:47], a[104:107], v[132:135], v[44:47]
    v_mfma_f32_16x16x32_bf16 v[48:51], a[108:111], v[132:135], v[48:51]
    v_mfma_f32_16x16x32_bf16 v[52:55], a[112:115], v[132:135], v[52:55]
    buffer_load_dwordx4 v[132:135], v11, s[20:23], s18 offen sc1
    v_mfma_f32_16x16x32_bf16 v[56:59], a[96:99], v[136:139], v[56:59]
    v_mfma_f32_16x16x32_bf16 v[60:63], a[100:103], v[136:139], v[60:63]
    v_mfma_f32_16x16x32_bf16 v[64:67], a[104:107], v[136:139], v[64:67]
    v_mfma_f32_16x16x32_bf16 v[68:71], a[108:111], v[136:139], v[68:71]
    v_mfma_f32_16x16x32_bf16 v[72:75], a[112:115], v[136:139], v[72:75]
    buffer_load_dwordx4 v[136:139], v14, s[20:23], s18 offen sc1
    v_mfma_f32_16x16x32_bf16 v[76:79], a[96:99], v[140:143], v[76:79]
    v_mfma_f32_16x16x32_bf16 v[80:83], a[100:103], v[140:143], v[80:83]
    v_mfma_f32_16x16x32_bf16 v[84:87], a[104:107], v[140:143], v[84:87]
    v_mfma_f32_16x16x32_bf16 v[88:91], a[108:111], v[140:143], v[88:91]
    v_mfma_f32_16x16x32_bf16 v[92:95], a[112:115], v[140:143], v[92:95]
    buffer_load_dwordx4 v[140:143], v15, s[20:23], s18 offen sc1
    s_waitcnt vmcnt(13)
    v_mfma_f32_16x16x32_bf16 v[16:19], a[116:119], v[144:147], v[16:19]
    v_mfma_f32_16x16x32_bf16 v[20:23], a[120:123], v[144:147], v[20:23]
    v_mfma_f32_16x16x32_bf16 v[24:27], a[124:127], v[144:147], v[24:27]
    v_mfma_f32_16x16x32_bf16 v[28:31], a[128:131], v[144:147], v[28:31]
    v_mfma_f32_16x16x32_bf16 v[32:35], a[132:135], v[144:147], v[32:35]
    buffer_load_dwordx4 v[144:147], v10, s[20:23], s19 offen sc1
    v_mfma_f32_16x16x32_bf16 v[36:39], a[116:119], v[148:151], v[36:39]
    v_mfma_f32_16x16x32_bf16 v[40:43], a[120:123], v[148:151], v[40:43]
    v_mfma_f32_16x16x32_bf16 v[44:47], a[124:127], v[148:151], v[44:47]
    v_mfma_f32_16x16x32_bf16 v[48:51], a[128:131], v[148:151], v[48:51]
    v_mfma_f32_16x16x32_bf16 v[52:55], a[132:135], v[148:151], v[52:55]
    buffer_load_dwordx4 v[148:151], v11, s[20:23], s19 offen sc1
    v_mfma_f32_16x16x32_bf16 v[56:59], a[116:119], v[152:155], v[56:59]
    v_mfma_f32_16x16x32_bf16 v[60:63], a[120:123], v[152:155], v[60:63]
    v_mfma_f32_16x16x32_bf16 v[64:67], a[124:127], v[152:155], v[64:67]
    v_mfma_f32_16x16x32_bf16 v[68:71], a[128:131], v[152:155], v[68:71]
    v_mfma_f32_16x16x32_bf16 v[72:75], a[132:135], v[152:155], v[72:75]
    buffer_load_dwordx4 v[152:155], v14, s[20:23], s19 offen sc1
    v_mfma_f32_16x16x32_bf16 v[76:79], a[116:119], v[156:159], v[76:79]
    v_mfma_f32_16x16x32_bf16 v[80:83], a[120:123], v[156:159], v[80:83]
    v_mfma_f32_16x16x32_bf16 v[84:87], a[124:127], v[156:159], v[84:87]
    v_mfma_f32_16x16x32_bf16 v[88:91], a[128:131], v[156:159], v[88:91]
    v_mfma_f32_16x16x32_bf16 v[92:95], a[132:135], v[156:159], v[92:95]
    buffer_load_dwordx4 v[156:159], v15, s[20:23], s19 offen sc1
    s_waitcnt vmcnt(12)
    v_mfma_f32_16x16x32_bf16 v[16:19], a[136:139], v[96:99], v[16:19]
    v_mfma_f32_16x16x32_bf16 v[20:23], a[140:143], v[96:99], v[20:23]
    v_mfma_f32_16x16x32_bf16 v[24:27], a[144:147], v[96:99], v[24:27]
    v_mfma_f32_16x16x32_bf16 v[28:31], a[148:151], v[96:99], v[28:31]
    v_mfma_f32_16x16x32_bf16 v[32:35], a[152:155], v[96:99], v[32:35]
    buffer_load_dwordx4 v[96:99], v10, s[20:23], s32 offen sc1
    v_mfma_f32_16x16x32_bf16 v[36:39], a[136:139], v[100:103], v[36:39]
    v_mfma_f32_16x16x32_bf16 v[40:43], a[140:143], v[100:103], v[40:43]
    v_mfma_f32_16x16x32_bf16 v[44:47], a[144:147], v[100:103], v[44:47]
    v_mfma_f32_16x16x32_bf16 v[48:51], a[148:151], v[100:103], v[48:51]
    v_mfma_f32_16x16x32_bf16 v[52:55], a[152:155], v[100:103], v[52:55]
    buffer_load_dwordx4 v[100:103], v11, s[20:23], s32 offen sc1
    v_mfma_f32_16x16x32_bf16 v[56:59], a[136:139], v[104:107], v[56:59]
    v_mfma_f32_16x16x32_bf16 v[60:63], a[140:143], v[104:107], v[60:63]
    v_mfma_f32_16x16x32_bf16 v[64:67], a[144:147], v[104:107], v[64:67]
    v_mfma_f32_16x16x32_bf16 v[68:71], a[148:151], v[104:107], v[68:71]
    v_mfma_f32_16x16x32_bf16 v[72:75], a[152:155], v[104:107], v[72:75]
    buffer_load_dwordx4 v[104:107], v14, s[20:23], s32 offen sc1
    v_mfma_f32_16x16x32_bf16 v[76:79], a[136:139], v[108:111], v[76:79]
    v_mfma_f32_16x16x32_bf16 v[80:83], a[140:143], v[108:111], v[80:83]
    v_mfma_f32_16x16x32_bf16 v[84:87], a[144:147], v[108:111], v[84:87]
    v_mfma_f32_16x16x32_bf16 v[88:91], a[148:151], v[108:111], v[88:91]
    v_mfma_f32_16x16x32_bf16 v[92:95], a[152:155], v[108:111], v[92:95]
    buffer_load_dwordx4 v[108:111], v15, s[20:23], s32 offen sc1
    s_waitcnt vmcnt(12)
    v_mfma_f32_16x16x32_bf16 v[16:19], a[156:159], v[112:115], v[16:19]
    v_mfma_f32_16x16x32_bf16 v[20:23], a[160:163], v[112:115], v[20:23]
    buffer_load_dword v7, v4, s[20:23], s41 offen sc1 nt
    v_mfma_f32_16x16x32_bf16 v[24:27], a[164:167], v[112:115], v[24:27]
    v_mfma_f32_16x16x32_bf16 v[28:31], a[168:171], v[112:115], v[28:31]
    v_mfma_f32_16x16x32_bf16 v[32:35], a[172:175], v[112:115], v[32:35]
    buffer_load_dwordx4 v[112:115], v10, s[20:23], s33 offen sc1
    v_mfma_f32_16x16x32_bf16 v[36:39], a[156:159], v[116:119], v[36:39]
    v_mfma_f32_16x16x32_bf16 v[40:43], a[160:163], v[116:119], v[40:43]
    v_mfma_f32_16x16x32_bf16 v[44:47], a[164:167], v[116:119], v[44:47]
    v_mfma_f32_16x16x32_bf16 v[48:51], a[168:171], v[116:119], v[48:51]
    v_mfma_f32_16x16x32_bf16 v[52:55], a[172:175], v[116:119], v[52:55]
    buffer_load_dwordx4 v[116:119], v11, s[20:23], s33 offen sc1
    v_mfma_f32_16x16x32_bf16 v[56:59], a[156:159], v[120:123], v[56:59]
    v_mfma_f32_16x16x32_bf16 v[60:63], a[160:163], v[120:123], v[60:63]
    v_mfma_f32_16x16x32_bf16 v[64:67], a[164:167], v[120:123], v[64:67]
    v_mfma_f32_16x16x32_bf16 v[68:71], a[168:171], v[120:123], v[68:71]
    v_mfma_f32_16x16x32_bf16 v[72:75], a[172:175], v[120:123], v[72:75]
    buffer_load_dwordx4 v[120:123], v14, s[20:23], s33 offen sc1
    v_mfma_f32_16x16x32_bf16 v[76:79], a[156:159], v[124:127], v[76:79]
    v_mfma_f32_16x16x32_bf16 v[80:83], a[160:163], v[124:127], v[80:83]
    v_mfma_f32_16x16x32_bf16 v[84:87], a[164:167], v[124:127], v[84:87]
    v_mfma_f32_16x16x32_bf16 v[88:91], a[168:171], v[124:127], v[88:91]
    v_mfma_f32_16x16x32_bf16 v[92:95], a[172:175], v[124:127], v[92:95]
    buffer_load_dwordx4 v[124:127], v15, s[20:23], s33 offen sc1
    s_waitcnt vmcnt(13)
    v_mfma_f32_16x16x32_bf16 v[16:19], a[176:179], v[128:131], v[16:19]
    v_mfma_f32_16x16x32_bf16 v[20:23], a[180:183], v[128:131], v[20:23]
    v_mfma_f32_16x16x32_bf16 v[24:27], a[184:187], v[128:131], v[24:27]
    v_mfma_f32_16x16x32_bf16 v[28:31], a[188:191], v[128:131], v[28:31]
    v_mfma_f32_16x16x32_bf16 v[32:35], a[192:195], v[128:131], v[32:35]
    buffer_load_dwordx4 v[128:131], v10, s[20:23], s34 offen sc1
    v_mfma_f32_16x16x32_bf16 v[36:39], a[176:179], v[132:135], v[36:39]
    v_mfma_f32_16x16x32_bf16 v[40:43], a[180:183], v[132:135], v[40:43]
    v_mfma_f32_16x16x32_bf16 v[44:47], a[184:187], v[132:135], v[44:47]
    v_mfma_f32_16x16x32_bf16 v[48:51], a[188:191], v[132:135], v[48:51]
    v_mfma_f32_16x16x32_bf16 v[52:55], a[192:195], v[132:135], v[52:55]
    buffer_load_dwordx4 v[132:135], v11, s[20:23], s34 offen sc1
    v_mfma_f32_16x16x32_bf16 v[56:59], a[176:179], v[136:139], v[56:59]
    v_mfma_f32_16x16x32_bf16 v[60:63], a[180:183], v[136:139], v[60:63]
    v_mfma_f32_16x16x32_bf16 v[64:67], a[184:187], v[136:139], v[64:67]
    v_mfma_f32_16x16x32_bf16 v[68:71], a[188:191], v[136:139], v[68:71]
    v_mfma_f32_16x16x32_bf16 v[72:75], a[192:195], v[136:139], v[72:75]
    buffer_load_dwordx4 v[136:139], v14, s[20:23], s34 offen sc1
    v_mfma_f32_16x16x32_bf16 v[76:79], a[176:179], v[140:143], v[76:79]
    v_mfma_f32_16x16x32_bf16 v[80:83], a[180:183], v[140:143], v[80:83]
    v_mfma_f32_16x16x32_bf16 v[84:87], a[184:187], v[140:143], v[84:87]
    v_mfma_f32_16x16x32_bf16 v[88:91], a[188:191], v[140:143], v[88:91]
    v_mfma_f32_16x16x32_bf16 v[92:95], a[192:195], v[140:143], v[92:95]
    buffer_load_dwordx4 v[140:143], v15, s[20:23], s34 offen sc1
    s_waitcnt vmcnt(13)
    v_mfma_f32_16x16x32_bf16 v[16:19], a[196:199], v[144:147], v[16:19]
    v_mfma_f32_16x16x32_bf16 v[20:23], a[200:203], v[144:147], v[20:23]
    buffer_load_dword v250, v9, s[20:23], s42 offen offset:12 sc1
    v_mfma_f32_16x16x32_bf16 v[24:27], a[204:207], v[144:147], v[24:27]
    v_mfma_f32_16x16x32_bf16 v[28:31], a[208:211], v[144:147], v[28:31]
    v_mfma_f32_16x16x32_bf16 v[32:35], a[212:215], v[144:147], v[32:35]
    buffer_load_dwordx4 v[144:147], v10, s[20:23], s35 offen sc1
    v_mfma_f32_16x16x32_bf16 v[36:39], a[196:199], v[148:151], v[36:39]
    v_mfma_f32_16x16x32_bf16 v[40:43], a[200:203], v[148:151], v[40:43]
    v_mfma_f32_16x16x32_bf16 v[44:47], a[204:207], v[148:151], v[44:47]
    v_mfma_f32_16x16x32_bf16 v[48:51], a[208:211], v[148:151], v[48:51]
    v_mfma_f32_16x16x32_bf16 v[52:55], a[212:215], v[148:151], v[52:55]
    buffer_load_dwordx4 v[148:151], v11, s[20:23], s35 offen sc1
    v_mfma_f32_16x16x32_bf16 v[56:59], a[196:199], v[152:155], v[56:59]
    v_mfma_f32_16x16x32_bf16 v[60:63], a[200:203], v[152:155], v[60:63]
    v_mfma_f32_16x16x32_bf16 v[64:67], a[204:207], v[152:155], v[64:67]
    v_mfma_f32_16x16x32_bf16 v[68:71], a[208:211], v[152:155], v[68:71]
    v_mfma_f32_16x16x32_bf16 v[72:75], a[212:215], v[152:155], v[72:75]
    buffer_load_dwordx4 v[152:155], v14, s[20:23], s35 offen sc1
    v_mfma_f32_16x16x32_bf16 v[76:79], a[196:199], v[156:159], v[76:79]
    v_mfma_f32_16x16x32_bf16 v[80:83], a[200:203], v[156:159], v[80:83]
    v_mfma_f32_16x16x32_bf16 v[84:87], a[204:207], v[156:159], v[84:87]
    v_mfma_f32_16x16x32_bf16 v[88:91], a[208:211], v[156:159], v[88:91]
    v_mfma_f32_16x16x32_bf16 v[92:95], a[212:215], v[156:159], v[92:95]
    buffer_load_dwordx4 v[156:159], v15, s[20:23], s35 offen sc1
    s_waitcnt vmcnt(13)
    v_cmp_ne_u32 vcc, s52, v7
    s_and_b32 vcc_lo, vcc_lo, 3
    s_cbranch_scc1 L_pollo
L_pollo_go:
    v_mfma_f32_16x16x32_bf16 v[16:19], v[160:163], v[96:99], v[16:19]
    v_mfma_f32_16x16x32_bf16 v[20:23], v[164:167], v[96:99], v[20:23]
    v_mfma_f32_16x16x32_bf16 v[24:27], v[168:171], v[96:99], v[24:27]
    v_mfma_f32_16x16x32_bf16 v[28:31], v[172:175], v[96:99], v[28:31]
    v_mfma_f32_16x16x32_bf16 v[32:35], v[176:179], v[96:99], v[32:35]
    buffer_load_dwordx4 v[96:99], v10, s[20:23], s36 offen sc1
    v_lshlrev_b32 v4, 4, v1
    v_add_u32 v9, 1024, v4
    v_mfma_f32_16x16x32_bf16 v[36:39], v[160:163], v[100:103], v[36:39]
    v_mfma_f32_16x16x32_bf16 v[40:43], v[164:167], v[100:103], v[40:43]
    v_mfma_f32_16x16x32_bf16 v[44:47], v[168:171], v[100:103], v[44:47]
    v_mfma_f32_16x16x32_bf16 v[48:51], v[172:175], v[100:103], v[48:51]
    v_mfma_f32_16x16x32_bf16 v[52:55], v[176:179], v[100:103], v[52:55]
    buffer_load_dwordx4 v[100:103], v11, s[20:23], s36 offen sc1
    v_mfma_f32_16x16x32_bf16 v[56:59], v[160:163], v[104:107], v[56:59]
    v_mfma_f32_16x16x32_bf16 v[60:63], v[164:167], v[104:107], v[60:63]
    v_mfma_f32_16x16x32_bf16 v[64:67], v[168:171], v[104:107], v[64:67]
    v_mfma_f32_16x16x32_bf16 v[68:71], v[172:175], v[104:107], v[68:71]
    v_mfma_f32_16x16x32_bf16 v[72:75], v[176:179], v[104:107], v[72:75]
    buffer_load_dwordx4 v[104:107], v14, s[20:23], s36 offen sc1
    v_mfma_f32_16x16x32_bf16 v[76:79], v[160:163], v[108:111], v[76:79]
    v_mfma_f32_16x16x32_bf16 v[80:83], v[164:167], v[108:111], v[80:83]
    v_mfma_f32_16x16x32_bf16 v[84:87], v[168:171], v[108:111], v[84:87]
    v_mfma_f32_16x16x32_bf16 v[88:91], v[172:175], v[108:111], v[88:91]
    v_mfma_f32_16x16x32_bf16 v[92:95], v[176:179], v[108:111], v[92:95]
    buffer_load_dwordx4 v[108:111], v15, s[20:23], s36 offen sc1
    s_waitcnt vmcnt(15)
    v_mfma_f32_16x16x32_bf16 v[36:39], v[180:183], v[116:119], v[36:39]
    v_mfma_f32_16x16x32_bf16 v[40:43], v[184:187], v[116:119], v[40:43]
    v_mfma_f32_16x16x32_bf16 v[44:47], v[188:191], v[116:119], v[44:47]
    v_mfma_f32_16x16x32_bf16 v[48:51], v[192:195], v[116:119], v[48:51]
    v_mfma_f32_16x16x32_bf16 v[52:55], v[196:199], v[116:119], v[52:55]
    buffer_load_dwordx4 v[116:119], v11, s[20:23], s37 offen sc1
    s_waitcnt vmcnt(12)
    v_mfma_f32_16x16x32_bf16 v[36:39], v[200:203], v[132:135], v[36:39]
    v_mfma_f32_16x16x32_bf16 v[40:43], v[204:207], v[132:135], v[40:43]
    v_mfma_f32_16x16x32_bf16 v[44:47], v[208:211], v[132:135], v[44:47]
    v_mfma_f32_16x16x32_bf16 v[48:51], v[212:215], v[132:135], v[48:51]
    v_mfma_f32_16x16x32_bf16 v[52:55], v[216:219], v[132:135], v[52:55]
    buffer_load_dwordx4 v[132:135], v11, s[20:23], s38 offen sc1
    s_waitcnt vmcnt(8)
    v_mfma_f32_16x16x32_bf16 v[36:39], v[220:223], v[148:151], v[36:39]
    v_mfma_f32_16x16x32_bf16 v[40:43], v[224:227], v[148:151], v[40:43]
    v_mfma_f32_16x16x32_bf16 v[44:47], v[228:231], v[148:151], v[44:47]
    v_mfma_f32_16x16x32_bf16 v[48:51], v[232:235], v[148:151], v[48:51]
    v_mfma_f32_16x16x32_bf16 v[52:55], v[236:239], v[148:151], v[52:55]
    buffer_load_dwordx4 v[148:151], v11, s[20:23], s39 offen sc1
    v_mfma_f32_16x16x32_bf16 v[56:59], v[180:183], v[120:123], v[56:59]
    v_mfma_f32_16x16x32_bf16 v[60:63], v[184:187], v[120:123], v[60:63]
    v_mfma_f32_16x16x32_bf16 v[64:67], v[188:191], v[120:123], v[64:67]
    ds_write_b128 v2, v[36:39] offset:0
    v_mfma_f32_16x16x32_bf16 v[68:71], v[192:195], v[120:123], v[68:71]
    v_mfma_f32_16x16x32_bf16 v[72:75], v[196:199], v[120:123], v[72:75]
    buffer_load_dwordx4 v[120:123], v14, s[20:23], s37 offen sc1
    v_mfma_f32_16x16x32_bf16 v[56:59], v[200:203], v[136:139], v[56:59]
    ds_write_b128 v2, v[40:43] offset:1024
    v_mfma_f32_16x16x32_bf16 v[60:63], v[204:207], v[136:139], v[60:63]
    v_mfma_f32_16x16x32_bf16 v[64:67], v[208:211], v[136:139], v[64:67]
    ds_write_b128 v2, v[44:47] offset:2048
    v_mfma_f32_16x16x32_bf16 v[68:71], v[212:215], v[136:139], v[68:71]
    v_mfma_f32_16x16x32_bf16 v[72:75], v[216:219], v[136:139], v[72:75]
    buffer_load_dwordx4 v[136:139], v14, s[20:23], s38 offen sc1
    s_waitcnt vmcnt(10)
    v_mfma_f32_16x16x32_bf16 v[56:59], v[220:223], v[152:155], v[56:59]
    ds_write_b128 v2, v[48:51] offset:3072
    v_mfma_f32_16x16x32_bf16 v[60:63], v[224:227], v[152:155], v[60:63]
    v_mfma_f32_16x16x32_bf16 v[64:67], v[228:231], v[152:155], v[64:67]
    ds_write_b128 v2, v[52:55] offset:4096
    v_mfma_f32_16x16x32_bf16 v[68:71], v[232:235], v[152:155], v[68:71]
    v_mfma_f32_16x16x32_bf16 v[72:75], v[236:239], v[152:155], v[72:75]
    buffer_load_dwordx4 v[152:155], v14, s[20:23], s39 offen sc1
    v_mfma_f32_16x16x32_bf16 v[76:79], v[180:183], v[124:127], v[76:79]
    v_mfma_f32_16x16x32_bf16 v[80:83], v[184:187], v[124:127], v[80:83]
    v_mfma_f32_16x16x32_bf16 v[84:87], v[188:191], v[124:127], v[84:87]
    ds_write_b128 v3, v[56:59] offset:0
    v_mfma_f32_16x16x32_bf16 v[88:91], v[192:195], v[124:127], v[88:91]
    v_mfma_f32_16x16x32_bf16 v[92:95], v[196:199], v[124:127], v[92:95]
    buffer_load_dwordx4 v[124:127], v15, s[20:23], s37 offen sc1
    v_mfma_f32_16x16x32_bf16 v[76:79], v[200:203], v[140:143], v[76:79]
    ds_write_b128 v3, v[60:63] offset:1024
    v_mfma_f32_16x16x32_bf16 v[80:83], v[204:207], v[140:143], v[80:83]
    v_mfma_f32_16x16x32_bf16 v[84:87], v[208:211], v[140:143], v[84:87]
    ds_write_b128 v3, v[64:67] offset:2048
    v_mfma_f32_16x16x32_bf16 v[88:91], v[212:215], v[140:143], v[88:91]
    v_mfma_f32_16x16x32_bf16 v[92:95], v[216:219], v[140:143], v[92:95]
    buffer_load_dwordx4 v[140:143], v15, s[20:23], s38 offen sc1
    s_waitcnt vmcnt(12)
    v_mfma_f32_16x16x32_bf16 v[76:79], v[220:223], v[156:159], v[76:79]
    ds_write_b128 v3, v[68:71] offset:3072
    v_mfma_f32_16x16x32_bf16 v[80:83], v[224:227], v[156:159], v[80:83]
    s_cmp_ge_u32 s7, 3
    s_cselect_b32 s31, 5, 0
    s_sub_i32 s31, 2, s31
    s_mul_i32 s31, s31, 40960
    s_add_u32 s31, s31, s50
    buffer_load_dwordx4 a[0:3], v4, s[20:23], s31 offen sc1
    v_mfma_f32_16x16x32_bf16 v[84:87], v[228:231], v[156:159], v[84:87]
    ds_write_b128 v3, v[72:75] offset:4096
    v_mfma_f32_16x16x32_bf16 v[88:91], v[232:235], v[156:159], v[88:91]
    buffer_load_dwordx4 a[4:7], v9, s[20:23], s31 offen offset:0 sc1
    v_mfma_f32_16x16x32_bf16 v[92:95], v[236:239], v[156:159], v[92:95]
    buffer_load_dwordx4 v[156:159], v15, s[20:23], s39 offen sc1
    v_mfma_f32_16x16x32_bf16 v[16:19], v[180:183], v[112:115], v[16:19]
    v_mfma_f32_16x16x32_bf16 v[20:23], v[184:187], v[112:115], v[20:23]
    buffer_load_dwordx4 a[8:11], v9, s[20:23], s31 offen offset:1024 sc1
    v_mfma_f32_16x16x32_bf16 v[24:27], v[188:191], v[112:115], v[24:27]
    ds_write_b128 v6, v[76:79] offset:0
    v_mfma_f32_16x16x32_bf16 v[28:31], v[192:195], v[112:115], v[28:31]
    buffer_load_dwordx4 a[12:15], v9, s[20:23], s31 offen offset:2048 sc1
    v_mfma_f32_16x16x32_bf16 v[32:35], v[196:199], v[112:115], v[32:35]
    buffer_load_dwordx4 v[112:115], v10, s[20:23], s37 offen sc1
    v_mfma_f32_16x16x32_bf16 v[16:19], v[200:203], v[128:131], v[16:19]
    ds_write_b128 v6, v[80:83] offset:1024
    v_mfma_f32_16x16x32_bf16 v[20:23], v[204:207], v[128:131], v[20:23]
    buffer_load_dwordx4 a[16:19], v9, s[20:23], s31 offen offset:3072 sc1
    v_mfma_f32_16x16x32_bf16 v[24:27], v[208:211], v[128:131], v[24:27]
    ds_write_b128 v6, v[84:87] offset:2048
    v_mfma_f32_16x16x32_bf16 v[28:31], v[212:215], v[128:131], v[28:31]
    v_mfma_f32_16x16x32_bf16 v[32:35], v[216:219], v[128:131], v[32:35]
    buffer_load_dwordx4 v[128:131], v10, s[20:23], s38 offen sc1
    v_mfma_f32_16x16x32_bf16 v[16:19], v[220:223], v[144:147], v[16:19]
    ds_write_b128 v6, v[88:91] offset:3072
    v_mfma_f32_16x16x32_bf16 v[20:23], v[224:227], v[144:147], v[20:23]
    v_mfma_f32_16x16x32_bf16 v[24:27], v[228:231], v[144:147], v[24:27]
    ds_write_b128 v6, v[92:95] offset:4096
    v_mfma_f32_16x16x32_bf16 v[28:31], v[232:235], v[144:147], v[28:31]
    v_mfma_f32_16x16x32_bf16 v[32:35], v[236:239], v[144:147], v[32:35]
    buffer_load_dwordx4 v[144:147], v10, s[20:23], s39 offen sc1
    s_waitcnt vmcnt(19)
    v_mfma_f32_16x16x32_bf16 a[76:79], a[216:219], v[100:103], 0
    v_mul_f32 v251, s30, v250
    v_rcp_f32 v250, v250
    v_mfma_f32_16x16x32_bf16 a[80:83], a[220:223], v[100:103], 0
    s_cmp_ge_u32 s7, 2
    s_cselect_b32 s31, 5, 0
    s_sub_i32 s31, 3, s31
    s_mul_i32 s31, s31, 40960
    s_add_u32 s31, s31, s50
    buffer_load_dwordx4 a[20:23], v4, s[20:23], s31 offen sc1
    v_mfma_f32_16x16x32_bf16 a[84:87], a[224:227], v[100:103], 0
    v_mfma_f32_16x16x32_bf16 a[88:91], a[228:231], v[100:103], 0
    buffer_load_dwordx4 a[24:27], v9, s[20:23], s31 offen offset:0 sc1
    v_mfma_f32_16x16x32_bf16 a[92:95], a[232:235], v[100:103], 0
    buffer_load_dwordx4 v[100:103], v11, s[20:23], s40 offen sc1
    s_waitcnt vmcnt(21)
    v_mfma_f32_16x16x32_bf16 a[96:99], a[216:219], v[104:107], 0
    s_waitcnt lgkmcnt(0)
    s_barrier
    v_mfma_f32_16x16x32_bf16 a[100:103], a[220:223], v[104:107], 0
    buffer_load_dwordx4 a[28:31], v9, s[20:23], s31 offen offset:1024 sc1
    v_mfma_f32_16x16x32_bf16 a[104:107], a[224:227], v[104:107], 0
    ds_read_b128 v[36:39], v8 offset:0
    ds_read_b128 v[40:43], v8 offset:1024
    v_mfma_f32_16x16x32_bf16 a[108:111], a[228:231], v[104:107], 0
    buffer_load_dwordx4 a[32:35], v9, s[20:23], s31 offen offset:2048 sc1
    v_mfma_f32_16x16x32_bf16 a[112:115], a[232:235], v[104:107], 0
    buffer_load_dwordx4 v[104:107], v14, s[20:23], s40 offen sc1
    s_waitcnt vmcnt(23)
    v_mfma_f32_16x16x32_bf16 a[116:119], a[216:219], v[108:111], 0
    ds_read_b128 v[44:47], v8 offset:2048
    ds_read_b128 v[48:51], v8 offset:3072
    v_mfma_f32_16x16x32_bf16 a[120:123], a[220:223], v[108:111], 0
    buffer_load_dwordx4 a[36:39], v9, s[20:23], s31 offen offset:3072 sc1
    v_mfma_f32_16x16x32_bf16 a[124:127], a[224:227], v[108:111], 0
    ds_read_b128 v[52:55], v8 offset:4096
    ds_read_b128 v[56:59], v8 offset:10240
    v_mfma_f32_16x16x32_bf16 a[128:131], a[228:231], v[108:111], 0
    ds_read_b128 v[60:63], v8 offset:11264
    ds_read_b128 v[64:67], v8 offset:12288
    v_mfma_f32_16x16x32_bf16 a[132:135], a[232:235], v[108:111], 0
    buffer_load_dwordx4 v[108:111], v15, s[20:23], s40 offen sc1
    v_mfma_f32_16x16x32_bf16 v[220:223], a[216:219], v[96:99], 0
    ds_read_b128 v[68:71], v8 offset:13312
    ds_read_b128 v[72:75], v8 offset:14336
    v_mfma_f32_16x16x32_bf16 v[224:227], a[220:223], v[96:99], 0
    s_cmp_ge_u32 s7, 1
    s_cselect_b32 s31, 5, 0
    s_sub_i32 s31, 4, s31
    s_mul_i32 s31, s31, 40960
    s_add_u32 s31, s31, s50
    buffer_load_dwordx4 a[40:43], v4, s[20:23], s31 offen sc1
    v_mfma_f32_16x16x32_bf16 v[228:231], a[224:227], v[96:99], 0
    ds_read_b128 v[76:79], v8 offset:20480
    ds_read_b128 v[80:83], v8 offset:21504
    v_mfma_f32_16x16x32_bf16 v[232:235], a[228:231], v[96:99], 0
    buffer_load_dwordx4 a[44:47], v9, s[20:23], s31 offen offset:0 sc1
    v_mfma_f32_16x16x32_bf16 v[236:239], a[232:235], v[96:99], 0
    buffer_load_dwordx4 v[96:99], v10, s[20:23], s40 offen sc1
    s_waitcnt vmcnt(27)
    v_mfma_f32_16x16x32_bf16 a[76:79], a[236:239], v[116:119], a[76:79]
    ds_read_b128 v[84:87], v8 offset:22528
    ds_read_b128 v[88:91], v8 offset:23552
    v_mfma_f32_16x16x32_bf16 a[80:83], a[240:243], v[116:119], a[80:83]
    buffer_load_dwordx4 a[48:51], v9, s[20:23], s31 offen offset:1024 sc1
    v_mfma_f32_16x16x32_bf16 a[84:87], a[244:247], v[116:119], a[84:87]
    ds_read_b128 v[92:95], v8 offset:24576
    s_lshl_b32 s29, s24, 8
    v_mfma_f32_16x16x32_bf16 a[88:91], a[248:251], v[116:119], a[88:91]
    buffer_load_dwordx4 a[52:55], v9, s[20:23], s31 offen offset:2048 sc1
    v_mfma_f32_16x16x32_bf16 a[92:95], a[252:255], v[116:119], a[92:95]
    s_add_u32 s29, s29, s2
    s_cmp_eq_u32 s29, 0
    s_cselect_b32 s29, 0, 2146435072
    s_waitcnt vmcnt(26)
    v_mfma_f32_16x16x32_bf16 a[96:99], a[236:239], v[120:123], a[96:99]
    v_mfma_f32_16x16x32_bf16 a[100:103], a[240:243], v[120:123], a[100:103]
    buffer_load_dwordx4 v[252:255], v9, s[20:23], s31 offen offset:3072 sc1
    v_mfma_f32_16x16x32_bf16 a[104:107], a[244:247], v[120:123], a[104:107]
    v_mov_b32 v7, s29
    s_mov_b32 s29, 12632064
    v_mfma_f32_16x16x32_bf16 a[108:111], a[248:251], v[120:123], a[108:111]
    buffer_store_dword v13, v7, s[20:23], s29 offen sc0 sc1
    v_mfma_f32_16x16x32_bf16 a[112:115], a[252:255], v[120:123], a[112:115]
    s_waitcnt vmcnt(25)
    v_mfma_f32_16x16x32_bf16 a[116:119], a[236:239], v[124:127], a[116:119]
    s_waitcnt lgkmcnt(0)
    v_mfma_f32_16x16x32_bf16 a[120:123], a[240:243], v[124:127], a[120:123]
    v_add_f32 v16, v16, v36
    v_add_f32 v17, v17, v37
    v_mfma_f32_16x16x32_bf16 a[124:127], a[244:247], v[124:127], a[124:127]
    v_add_f32 v56, v56, v76
    v_add_f32 v57, v57, v77
    v_mfma_f32_16x16x32_bf16 a[128:131], a[248:251], v[124:127], a[128:131]
    v_add_f32 v18, v18, v38
    v_add_f32 v19, v19, v39
    v_mfma_f32_16x16x32_bf16 a[132:135], a[252:255], v[124:127], a[132:135]
    v_add_f32 v58, v58, v78
    v_add_f32 v59, v59, v79
    s_waitcnt vmcnt(18)
    v_mfma_f32_16x16x32_bf16 v[220:223], a[236:239], v[112:115], v[220:223]
    v_add_f32 v20, v20, v40
    v_add_f32 v21, v21, v41
    v_mfma_f32_16x16x32_bf16 v[224:227], a[240:243], v[112:115], v[224:227]
    v_add_f32 v60, v60, v80
    v_add_f32 v61, v61, v81
    v_mfma_f32_16x16x32_bf16 v[228:231], a[244:247], v[112:115], v[228:231]
    v_add_f32 v22, v22, v42
    v_add_f32 v23, v23, v43
    v_mfma_f32_16x16x32_bf16 v[232:235], a[248:251], v[112:115], v[232:235]
    v_add_f32 v62, v62, v82
    v_add_f32 v63, v63, v83
    v_mfma_f32_16x16x32_bf16 v[236:239], a[252:255], v[112:115], v[236:239]
    v_add_f32 v24, v24, v44
    v_add_f32 v25, v25, v45
    s_waitcnt vmcnt(17)
    v_mfma_f32_16x16x32_bf16 a[76:79], a[0:3], v[132:135], a[76:79]
    v_add_f32 v64, v64, v84
    v_add_f32 v65, v65, v85
    v_mfma_f32_16x16x32_bf16 a[80:83], a[4:7], v[132:135], a[80:83]
    v_add_f32 v26, v26, v46
    v_add_f32 v27, v27, v47
    v_mfma_f32_16x16x32_bf16 a[84:87], a[8:11], v[132:135], a[84:87]
    v_add_f32 v66, v66, v86
    v_add_f32 v67, v67, v87
    v_mfma_f32_16x16x32_bf16 a[88:91], a[12:15], v[132:135], a[88:91]
    v_add_f32 v28, v28, v48
    v_add_f32 v29, v29, v49
    v_mfma_f32_16x16x32_bf16 a[92:95], a[16:19], v[132:135], a[92:95]
    v_add_f32 v68, v68, v88
    v_add_f32 v69, v69, v89
    v_mfma_f32_16x16x32_bf16 a[96:99], a[0:3], v[136:139], a[96:99]
    v_add_f32 v30, v30, v50
    v_add_f32 v31, v31, v51
    v_mfma_f32_16x16x32_bf16 a[100:103], a[4:7], v[136:139], a[100:103]
    buffer_load_dwordx2 v[240:241], v5, s[8:11], s48 offen offset:0
    v_mfma_f32_16x16x32_bf16 a[104:107], a[8:11], v[136:139], a[104:107]
    v_add_f32 v70, v70, v90
    v_add_f32 v71, v71, v91
    v_mfma_f32_16x16x32_bf16 a[108:111], a[12:15], v[136:139], a[108:111]
    buffer_load_dwordx2 v[242:243], v5, s[8:11], s48 offen offset:32
    v_mfma_f32_16x16x32_bf16 a[112:115], a[16:19], v[136:139], a[112:115]
    v_add_f32 v32, v32, v52
    v_add_f32 v33, v33, v53
    v_mfma_f32_16x16x32_bf16 a[116:119], a[0:3], v[140:143], a[116:119]
    v_add_f32 v72, v72, v92
    v_add_f32 v73, v73, v93
    v_mfma_f32_16x16x32_bf16 a[120:123], a[4:7], v[140:143], a[120:123]
    buffer_load_dwordx2 v[244:245], v5, s[8:11], s48 offen offset:64
    v_mfma_f32_16x16x32_bf16 a[124:127], a[8:11], v[140:143], a[124:127]
    v_add_f32 v34, v34, v54
    v_add_f32 v35, v35, v55
    v_mfma_f32_16x16x32_bf16 a[128:131], a[12:15], v[140:143], a[128:131]
    buffer_load_dwordx2 v[246:247], v5, s[8:11], s48 offen offset:96
    v_mfma_f32_16x16x32_bf16 a[132:135], a[16:19], v[140:143], a[132:135]
    v_add_f32 v74, v74, v94
    v_add_f32 v75, v75, v95
    s_waitcnt vmcnt(20)
    v_mfma_f32_16x16x32_bf16 v[220:223], a[0:3], v[128:131], v[220:223]
    v_add_f32 v16, v16, v56
    v_add_f32 v17, v17, v57
    v_mfma_f32_16x16x32_bf16 v[224:227], a[4:7], v[128:131], v[224:227]
    buffer_load_dwordx2 v[248:249], v5, s[8:11], s48 offen offset:128
    v_mfma_f32_16x16x32_bf16 v[228:231], a[8:11], v[128:131], v[228:231]
    v_add_f32 v18, v18, v58
    v_add_f32 v19, v19, v59
    v_mfma_f32_16x16x32_bf16 v[232:235], a[12:15], v[128:131], v[232:235]
    v_add_f32 v20, v20, v60
    v_add_f32 v21, v21, v61
    v_mfma_f32_16x16x32_bf16 v[236:239], a[16:19], v[128:131], v[236:239]
    v_add_f32 v22, v22, v62
    v_add_f32 v23, v23, v63
    s_waitcnt vmcnt(13)
    v_mfma_f32_16x16x32_bf16 a[76:79], a[20:23], v[148:151], a[76:79]
    v_add_f32 v24, v24, v64
    v_add_f32 v25, v25, v65
    v_mfma_f32_16x16x32_bf16 a[80:83], a[24:27], v[148:151], a[80:83]
    v_add_f32 v26, v26, v66
    v_add_f32 v27, v27, v67
    v_mfma_f32_16x16x32_bf16 a[84:87], a[28:31], v[148:151], a[84:87]
    v_add_f32 v28, v28, v68
    v_add_f32 v29, v29, v69
    v_mfma_f32_16x16x32_bf16 a[88:91], a[32:35], v[148:151], a[88:91]
    v_add_f32 v30, v30, v70
    v_add_f32 v31, v31, v71
    v_mfma_f32_16x16x32_bf16 a[92:95], a[36:39], v[148:151], a[92:95]
    v_add_f32 v32, v32, v72
    v_add_f32 v33, v33, v73
    s_waitcnt vmcnt(6)
    v_mfma_f32_16x16x32_bf16 a[76:79], a[40:43], v[100:103], a[76:79]
    v_add_f32 v34, v34, v74
    v_add_f32 v35, v35, v75
    v_mfma_f32_16x16x32_bf16 a[80:83], a[44:47], v[100:103], a[80:83]
    v_mul_f32 v36, v16, v251
    v_mul_f32 v37, v17, v251
    v_mfma_f32_16x16x32_bf16 a[84:87], a[48:51], v[100:103], a[84:87]
    v_mul_f32 v38, v18, v251
    v_mul_f32 v39, v19, v251
    v_mfma_f32_16x16x32_bf16 a[88:91], a[52:55], v[100:103], a[88:91]
    v_mul_f32 v40, v20, v251
    v_mul_f32 v41, v21, v251
    v_mfma_f32_16x16x32_bf16 a[92:95], v[252:255], v[100:103], a[92:95]
    v_mul_f32 v42, v22, v251
    v_mul_f32 v43, v23, v251
    v_mfma_f32_16x16x32_bf16 a[96:99], a[20:23], v[152:155], a[96:99]
    v_mul_f32 v44, v24, v251
    v_mul_f32 v45, v25, v251
    v_mfma_f32_16x16x32_bf16 a[100:103], a[24:27], v[152:155], a[100:103]
    v_mul_f32 v46, v26, v251
    v_mul_f32 v47, v27, v251
    v_mfma_f32_16x16x32_bf16 a[104:107], a[28:31], v[152:155], a[104:107]
    ds_write_b128 v2, a[76:79] offset:5120
    v_mfma_f32_16x16x32_bf16 a[108:111], a[32:35], v[152:155], a[108:111]
    v_mul_f32 v48, v28, v251
    v_mul_f32 v49, v29, v251
    v_mfma_f32_16x16x32_bf16 a[112:115], a[36:39], v[152:155], a[112:115]
    ds_write_b128 v2, a[80:83] offset:6144
    v_mfma_f32_16x16x32_bf16 a[96:99], a[40:43], v[104:107], a[96:99]
    v_mul_f32 v50, v30, v251
    v_mul_f32 v51, v31, v251
    v_mfma_f32_16x16x32_bf16 a[100:103], a[44:47], v[104:107], a[100:103]
    ds_write_b128 v2, a[84:87] offset:7168
    v_mfma_f32_16x16x32_bf16 a[104:107], a[48:51], v[104:107], a[104:107]
    v_mul_f32 v52, v32, v251
    v_mul_f32 v53, v33, v251
    v_mfma_f32_16x16x32_bf16 a[108:111], a[52:55], v[104:107], a[108:111]
    ds_write_b128 v2, a[88:91] offset:8192
    v_mfma_f32_16x16x32_bf16 a[112:115], v[252:255], v[104:107], a[112:115]
    v_mul_f32 v54, v34, v251
    v_mul_f32 v55, v35, v251
    v_mfma_f32_16x16x32_bf16 a[116:119], a[20:23], v[156:159], a[116:119]
    ds_write_b128 v2, a[92:95] offset:9216
    v_mfma_f32_16x16x32_bf16 a[120:123], a[24:27], v[156:159], a[120:123]
    v_exp_f32 v36, v36
    v_mfma_f32_16x16x32_bf16 a[124:127], a[28:31], v[156:159], a[124:127]
    ds_write_b128 v3, a[96:99] offset:5120
    v_mfma_f32_16x16x32_bf16 a[128:131], a[32:35], v[156:159], a[128:131]
    v_exp_f32 v37, v37
    v_mfma_f32_16x16x32_bf16 a[132:135], a[36:39], v[156:159], a[132:135]
    ds_write_b128 v3, a[100:103] offset:6144
    v_mfma_f32_16x16x32_bf16 a[116:119], a[40:43], v[108:111], a[116:119]
    v_exp_f32 v38, v38
    v_mfma_f32_16x16x32_bf16 a[120:123], a[44:47], v[108:111], a[120:123]
    ds_write_b128 v3, a[104:107] offset:7168
    v_mfma_f32_16x16x32_bf16 a[124:127], a[48:51], v[108:111], a[124:127]
    v_exp_f32 v39, v39
    v_mfma_f32_16x16x32_bf16 a[128:131], a[52:55], v[108:111], a[128:131]
    ds_write_b128 v3, a[108:111] offset:8192
    v_mfma_f32_16x16x32_bf16 a[132:135], v[252:255], v[108:111], a[132:135]
    v_exp_f32 v40, v40
    v_mfma_f32_16x16x32_bf16 v[220:223], a[20:23], v[144:147], v[220:223]
    ds_write_b128 v3, a[112:115] offset:9216
    v_mfma_f32_16x16x32_bf16 v[224:227], a[24:27], v[144:147], v[224:227]
    v_exp_f32 v41, v41
    v_mfma_f32_16x16x32_bf16 v[228:231], a[28:31], v[144:147], v[228:231]
    ds_write_b128 v6, a[116:119] offset:5120
    v_mfma_f32_16x16x32_bf16 v[232:235], a[32:35], v[144:147], v[232:235]
    v_exp_f32 v42, v42
    v_mfma_f32_16x16x32_bf16 v[236:239], a[36:39], v[144:147], v[236:239]
    ds_write_b128 v6, a[120:123] offset:6144
    v_mfma_f32_16x16x32_bf16 v[220:223], a[40:43], v[96:99], v[220:223]
    v_exp_f32 v43, v43
    v_mfma_f32_16x16x32_bf16 v[224:227], a[44:47], v[96:99], v[224:227]
    ds_write_b128 v6, a[124:127] offset:7168
    v_mfma_f32_16x16x32_bf16 v[228:231], a[48:51], v[96:99], v[228:231]
    v_exp_f32 v44, v44
    v_mfma_f32_16x16x32_bf16 v[232:235], a[52:55], v[96:99], v[232:235]
    ds_write_b128 v6, a[128:131] offset:8192
    v_mfma_f32_16x16x32_bf16 v[236:239], v[252:255], v[96:99], v[236:239]
    v_exp_f32 v45, v45
    ds_write_b128 v6, a[132:135] offset:9216
    v_exp_f32 v46, v46
    v_exp_f32 v47, v47
    v_exp_f32 v48, v48
    v_exp_f32 v49, v49
    s_waitcnt lgkmcnt(0)
    s_barrier
    ds_read_b128 v[96:99], v8 offset:5120
    ds_read_b128 v[100:103], v8 offset:6144
    ds_read_b128 v[104:107], v8 offset:7168
    ds_read_b128 v[108:111], v8 offset:8192
    ds_read_b128 v[112:115], v8 offset:9216
    ds_read_b128 v[116:119], v8 offset:15360
    ds_read_b128 v[120:123], v8 offset:16384
    ds_read_b128 v[124:127], v8 offset:17408
    ds_read_b128 v[128:131], v8 offset:18432
    ds_read_b128 v[132:135], v8 offset:19456
    ds_read_b128 v[136:139], v8 offset:25600
    ds_read_b128 v[140:143], v8 offset:26624
    ds_read_b128 v[144:147], v8 offset:27648
    ds_read_b128 v[148:151], v8 offset:28672
    ds_read_b128 v[152:155], v8 offset:29696
    v_exp_f32 v50, v50
    v_exp_f32 v51, v51
    v_exp_f32 v52, v52
    v_exp_f32 v53, v53
    v_exp_f32 v54, v54
    v_exp_f32 v55, v55
    s_nop 0
    v_pk_fma_f32 v[36:37], v[36:37], v[250:251], v[250:251] op_sel:[0,0,0] op_sel_hi:[1,0,0]
    v_pk_fma_f32 v[38:39], v[38:39], v[250:251], v[250:251] op_sel:[0,0,0] op_sel_hi:[1,0,0]
    v_pk_fma_f32 v[40:41], v[40:41], v[250:251], v[250:251] op_sel:[0,0,0] op_sel_hi:[1,0,0]
    v_pk_fma_f32 v[42:43], v[42:43], v[250:251], v[250:251] op_sel:[0,0,0] op_sel_hi:[1,0,0]
    v_pk_fma_f32 v[44:45], v[44:45], v[250:251], v[250:251] op_sel:[0,0,0] op_sel_hi:[1,0,0]
    v_pk_fma_f32 v[46:47], v[46:47], v[250:251], v[250:251] op_sel:[0,0,0] op_sel_hi:[1,0,0]
    v_pk_fma_f32 v[48:49], v[48:49], v[250:251], v[250:251] op_sel:[0,0,0] op_sel_hi:[1,0,0]
    v_pk_fma_f32 v[50:51], v[50:51], v[250:251], v[250:251] op_sel:[0,0,0] op_sel_hi:[1,0,0]
    v_pk_fma_f32 v[52:53], v[52:53], v[250:251], v[250:251] op_sel:[0,0,0] op_sel_hi:[1,0,0]
    v_pk_fma_f32 v[54:55], v[54:55], v[250:251], v[250:251] op_sel:[0,0,0] op_sel_hi:[1,0,0]
    v_rcp_f32 v36, v36
    v_rcp_f32 v37, v37
    v_rcp_f32 v38, v38
    v_rcp_f32 v39, v39
    v_rcp_f32 v40, v40
    v_rcp_f32 v41, v41
    v_rcp_f32 v42, v42
    v_rcp_f32 v43, v43
    v_rcp_f32 v44, v44
    v_rcp_f32 v45, v45
    v_rcp_f32 v46, v46
    v_rcp_f32 v47, v47
    v_rcp_f32 v48, v48
    v_rcp_f32 v49, v49
    v_rcp_f32 v50, v50
    v_rcp_f32 v51, v51
    v_rcp_f32 v52, v52
    v_rcp_f32 v53, v53
    v_rcp_f32 v54, v54
    v_rcp_f32 v55, v55
    s_nop 0
    v_pk_mul_f32 v[180:181], v[16:17], v[36:37]
    v_pk_mul_f32 v[182:183], v[18:19], v[38:39]
    v_pk_mul_f32 v[184:185], v[20:21], v[40:41]
    v_pk_mul_f32 v[186:187], v[22:23], v[42:43]
    v_pk_mul_f32 v[188:189], v[24:25], v[44:45]
    v_pk_mul_f32 v[190:191], v[26:27], v[46:47]
    v_pk_mul_f32 v[192:193], v[28:29], v[48:49]
    v_pk_mul_f32 v[194:195], v[30:31], v[50:51]
    v_pk_mul_f32 v[196:197], v[32:33], v[52:53]
    v_pk_mul_f32 v[198:199], v[34:35], v[54:55]
    s_waitcnt vmcnt(0)
    v_lshlrev_b32 v160, 16, v240
    v_and_b32 v161, s45, v240
    v_lshlrev_b32 v162, 16, v241
    v_and_b32 v163, s45, v241
    v_lshlrev_b32 v164, 16, v242
    v_and_b32 v165, s45, v242
    v_lshlrev_b32 v166, 16, v243
    v_and_b32 v167, s45, v243
    v_lshlrev_b32 v168, 16, v244
    v_and_b32 v169, s45, v244
    v_lshlrev_b32 v170, 16, v245
    v_and_b32 v171, s45, v245
    v_lshlrev_b32 v172, 16, v246
    v_and_b32 v173, s45, v246
    v_lshlrev_b32 v174, 16, v247
    v_and_b32 v175, s45, v247
    v_lshlrev_b32 v176, 16, v248
    v_and_b32 v177, s45, v248
    v_lshlrev_b32 v178, 16, v249
    v_and_b32 v179, s45, v249
    s_waitcnt lgkmcnt(0)
    v_pk_add_f32 v[96:97], v[96:97], v[220:221]
    v_pk_add_f32 v[116:117], v[116:117], v[136:137]
    v_pk_add_f32 v[98:99], v[98:99], v[222:223]
    v_pk_add_f32 v[118:119], v[118:119], v[138:139]
    v_pk_add_f32 v[100:101], v[100:101], v[224:225]
    v_pk_add_f32 v[120:121], v[120:121], v[140:141]
    v_pk_add_f32 v[102:103], v[102:103], v[226:227]
    v_pk_add_f32 v[122:123], v[122:123], v[142:143]
    v_pk_add_f32 v[104:105], v[104:105], v[228:229]
    v_pk_add_f32 v[124:125], v[124:125], v[144:145]
    v_pk_add_f32 v[106:107], v[106:107], v[230:231]
    v_pk_add_f32 v[126:127], v[126:127], v[146:147]
    v_pk_add_f32 v[108:109], v[108:109], v[232:233]
    v_pk_add_f32 v[128:129], v[128:129], v[148:149]
    v_pk_add_f32 v[110:111], v[110:111], v[234:235]
    v_pk_add_f32 v[130:131], v[130:131], v[150:151]
    v_pk_add_f32 v[112:113], v[112:113], v[236:237]
    v_pk_add_f32 v[132:133], v[132:133], v[152:153]
    v_pk_add_f32 v[114:115], v[114:115], v[238:239]
    v_pk_add_f32 v[134:135], v[134:135], v[154:155]
    v_pk_add_f32 v[96:97], v[96:97], v[116:117]
    v_pk_add_f32 v[98:99], v[98:99], v[118:119]
    v_pk_add_f32 v[100:101], v[100:101], v[120:121]
    v_pk_add_f32 v[102:103], v[102:103], v[122:123]
    v_pk_add_f32 v[104:105], v[104:105], v[124:125]
    v_pk_add_f32 v[106:107], v[106:107], v[126:127]
    v_pk_add_f32 v[108:109], v[108:109], v[128:129]
    v_pk_add_f32 v[110:111], v[110:111], v[130:131]
    v_pk_add_f32 v[112:113], v[112:113], v[132:133]
    v_pk_add_f32 v[114:115], v[114:115], v[134:135]
    v_pk_fma_f32 v[160:161], v[96:97], v[180:181], v[160:161]
    v_pk_fma_f32 v[162:163], v[98:99], v[182:183], v[162:163]
    v_cvt_pk_bf16_f32 v200, v160, v161
    v_cvt_pk_bf16_f32 v201, v162, v163
    buffer_store_dwordx2 v[200:201], v5, s[56:59], s48 offen offset:0
    v_pk_fma_f32 v[164:165], v[100:101], v[184:185], v[164:165]
    v_pk_fma_f32 v[166:167], v[102:103], v[186:187], v[166:167]
    v_cvt_pk_bf16_f32 v202, v164, v165
    v_cvt_pk_bf16_f32 v203, v166, v167
    buffer_store_dwordx2 v[202:203], v5, s[56:59], s48 offen offset:32
    v_pk_fma_f32 v[168:169], v[104:105], v[188:189], v[168:169]
    v_pk_fma_f32 v[170:171], v[106:107], v[190:191], v[170:171]
    v_cvt_pk_bf16_f32 v204, v168, v169
    v_cvt_pk_bf16_f32 v205, v170, v171
    buffer_store_dwordx2 v[204:205], v5, s[56:59], s48 offen offset:64
    v_pk_fma_f32 v[172:173], v[108:109], v[192:193], v[172:173]
    v_pk_fma_f32 v[174:175], v[110:111], v[194:195], v[174:175]
    v_cvt_pk_bf16_f32 v206, v172, v173
    v_cvt_pk_bf16_f32 v207, v174, v175
    buffer_store_dwordx2 v[206:207], v5, s[56:59], s48 offen offset:96
    v_pk_fma_f32 v[176:177], v[112:113], v[196:197], v[176:177]
    v_pk_fma_f32 v[178:179], v[114:115], v[198:199], v[178:179]
    v_cvt_pk_bf16_f32 v208, v176, v177
    v_cvt_pk_bf16_f32 v209, v178, v179
    buffer_store_dwordx2 v[208:209], v5, s[56:59], s48 offen offset:128
L_done:
    s_endpgm
LA_slow:
    s_mov_b32 s49, 100000
LA_spin:
    s_sleep 4
    buffer_load_dword v48, v52, s[20:23], s82 offen sc1 nt
    s_waitcnt vmcnt(0)
    v_cmp_ne_u32 vcc, s52, v48
    s_and_b64 vcc, vcc, s[4:5]
    s_cbranch_scc0 LA_ok
    s_sub_u32 s49, s49, 1
    s_cmp_gt_i32 s49, 0
    s_cbranch_scc1 LA_spin
    s_branch LA_ok
LA_sloww:
    s_mov_b32 s49, 100000
LA_spinw:
    s_sleep 4
    buffer_load_dword v60, v23, s[20:23], s3 offen sc1 nt
    s_waitcnt vmcnt(0)
    v_cmp_ne_u32 vcc, s52, v60
    s_and_b32 vcc_lo, vcc_lo, 0x0fff0fff
    s_cbranch_scc0 LA_okw
    s_sub_u32 s49, s49, 1
    s_cmp_gt_i32 s49, 0
    s_cbranch_scc1 LA_spinw
    s_branch LA_okw

L_pollo:
    buffer_load_dword v7, v4, s[20:23], s41 offen offset:0 sc1 nt
    s_waitcnt vmcnt(0)
    v_cmp_ne_u32 vcc, s52, v7
    s_and_b32 vcc_lo, vcc_lo, 3
    s_cbranch_scc0 L_pollo_go
    s_sleep 1
    s_sub_u32 s49, s49, 1
    s_cmp_gt_i32 s49, 0
    s_cbranch_scc1 L_pollo

    s_branch L_pollo_go
L_pollh:
    buffer_load_dword v7, v4, s[20:23], s41 offen offset:1024 sc1 nt
    s_waitcnt vmcnt(0)
    v_cmp_ne_u32 vcc, s52, v7
    s_and_b32 vcc_lo, vcc_lo, 3
    s_cbranch_scc0 L_pollh_go
    s_sleep 1
    s_sub_u32 s49, s49, 1
    s_cmp_gt_i32 s49, 0
    s_cbranch_scc1 L_pollh

    s_branch L_pollh_go
L_end:
    s_endpgm
.section .rodata,"a"
.p2align 6
.amdhsa_kernel recurrent_scan__sliding_local_dilated__glu_gated_reglu__prompt_kernel
  .amdhsa_next_free_vgpr 512
  .amdhsa_next_free_sgpr 102
  .amdhsa_accum_offset 256
  .amdhsa_group_segment_fixed_size 0
  .amdhsa_kernarg_size 80
  .amdhsa_user_sgpr_count 2
  .amdhsa_user_sgpr_kernarg_segment_ptr 1
  .amdhsa_system_sgpr_workgroup_id_x 1
.end_amdhsa_kernel
```
